```python
import torch

def _softmax(x, axis=-1):
    return torch.softmax(x, dim=axis)
def _gelu(x):
    return torch.nn.functional.gelu(x, approximate="tanh")
def _silu(x):
    return torch.nn.functional.silu(x)
def _sigmoid(x):
    return torch.sigmoid(x)
def _layernorm(x, axis=-1, eps=1e-5):
    m = x.mean(dim=axis, keepdim=True)
    v = x.var(dim=axis, keepdim=True, unbiased=False)
    return (x - m) / torch.sqrt(v + eps)
def _scatter_add(tgt, idx, src, axis=0):
    return tgt.clone().index_add_(axis, idx, src)
def _segment_sum(src, seg, n):
    out = torch.zeros((n,) + src.shape[1:], dtype=src.dtype)
    return out.index_add_(0, seg, src)
def _pad(x, pw):
    flat = tuple(v for pair in reversed(pw) for v in pair)
    return torch.nn.functional.pad(x, flat)

kernel_name = 'parallel_sum__mha_block__mixer_channel_mlp__prompt'

def setup_inputs():

    _w = (lambda a: (lambda t: t.to(torch.bfloat16) if t.is_floating_point() else t)(torch.as_tensor(a)))
    def _A_setup():
        B, S, D, H = 1, 2048, 640, 32
        return {
            "x": _w((lambda *s: torch.randn(*s, dtype=torch.bfloat16) * 0.05)(B, S, D)),
            "wqkv": _w((lambda *s: torch.randn(*s, dtype=torch.bfloat16) * 0.05)(D, 3 * D)),
            "wo": _w((lambda *s: torch.randn(*s, dtype=torch.bfloat16) * 0.05)(D, D)),
        }
    _A_in = _A_setup()

    def _B_setup():
        B, S, D, F = 1, 2048, 640, 1536
        return {
            "x": _w((lambda *s: torch.randn(*s, dtype=torch.bfloat16) * 0.05)(B, S, D)),
            "w1": _w((lambda *s: torch.randn(*s, dtype=torch.bfloat16) * 3.2)(D, F) * (D ** -0.5)),
            "b1": _w((lambda *s: torch.randn(*s, dtype=torch.bfloat16) * 1.6)(F)),
            "w2": _w((lambda *s: torch.randn(*s, dtype=torch.bfloat16) * 0.1)(F, D) * (F ** -0.5)),
            "b2": _w((lambda *s: torch.randn(*s, dtype=torch.bfloat16) * 0.2)(D)),
        }
    _B_in = _B_setup()

    return {
        "A_x": _A_in["x"],
        "A_wqkv": _A_in["wqkv"],
        "A_wo": _A_in["wo"],
        "B_x": _B_in["x"],
        "B_w1": _B_in["w1"],
        "B_b1": _B_in["b1"],
        "B_w2": _B_in["w2"],
        "B_b2": _B_in["b2"],
    }

def reference(A_x, A_wqkv, A_wo, B_x, B_w1, B_b1, B_w2, B_b2):
    def _A_ref(x, wqkv, wo):
        B, S, D = x.shape
        H = 32
        Dh = D // H
        qkv = (lambda x, *d: x.permute(*d))((x @ wqkv).reshape(B, S, 3, H, Dh), 2, 0, 3, 1, 4)
        q, k, v = qkv[0], qkv[1], qkv[2]
        scores = torch.einsum("bhqd,bhkd->bhqk", q, k) * (Dh ** -0.5)
        p = _softmax(scores, axis=-1)
        o = torch.einsum("bhqk,bhkd->bhqd", p, v)
        return (lambda x, *d: x.permute(*d))(o, 0, 2, 1, 3).reshape(B, S, D) @ wo

    def _B_ref(x, w1, b1, w2, b2):
        y = _layernorm(x, axis=-1)
        h = _gelu(torch.einsum("bsd,df->bsf", y, w1) + b1)
        return torch.einsum("bsf,fd->bsd", h, w2) + b2

    x = A_x
    xn = _layernorm(x, axis=-1)
    return x + _A_ref(xn, A_wqkv, A_wo) + _B_ref(xn, B_w1, B_b1, B_w2, B_b2)
```

```asm
; @launch kernel=k1_gemm_kernel grid=(256,1,1) block=(512,1,1) lds=155648
; @launch kernel=k2_attn_kernel grid=(256,1,1) block=(768,1,1) lds=152576
.amdgcn_target "amdgcn-amd-amdhsa--gfx950"
.text
.globl k1_gemm_kernel
.p2align 8
.type k1_gemm_kernel,@function
k1_gemm_kernel:

    s_cmp_ge_u32 s2, 256
    s_cbranch_scc1 K1_END
    s_load_dwordx2 s[4:5], s[0:1], 8
    s_load_dwordx2 s[6:7], s[0:1], 80
    s_load_dwordx2 s[8:9], s[0:1], 32
    s_load_dwordx2 s[10:11], s[0:1], 40
    s_load_dwordx2 s[50:51], s[0:1], 0
    s_load_dwordx2 s[52:53], s[0:1], 72
    s_load_dwordx2 s[54:55], s[0:1], 16
    s_load_dwordx2 s[56:57], s[0:1], 48
    v_lshrrev_b32 v2, 6, v0
    v_and_b32 v1, 63, v0
    s_and_b32 s38, s2, 7
    s_mul_i32 s38, s38, 27
    s_lshr_b32 s39, s2, 3
    s_sub_u32 s39, s39, 5
    s_add_u32 s38, s38, s39
    s_cmp_ge_u32 s38, 108
    s_cselect_b32 s39, 108, 0
    s_cselect_b32 s34, 4, 0
    s_sub_u32 s38, s38, s39
    s_lshr_b32 s35, s38, 2
    s_and_b32 s38, s38, 3
    s_add_u32 s34, s34, s38
    v_readfirstlane_b32 s3, v2
    s_and_b32 s36, s3, 3
    s_lshr_b32 s37, s3, 2
    s_waitcnt lgkmcnt(0)

    s_mov_b32 s20, s6
    s_and_b32 s21, s7, 0xffff
    s_mov_b32 s22, 26214400
    s_mov_b32 s23, 0x20000
    s_cmp_lt_u32 s2, 40
    s_cbranch_scc1 K1_SIDE
    s_mul_i32 s39, s34, 327680
    s_add_u32 s12, s50, s39
    s_addc_u32 s13, s51, 0
    s_and_b32 s13, s13, 0xffff
    s_mov_b32 s14, 327680
    s_mov_b32 s15, 0x20000
    s_cmp_lt_u32 s35, 24
    s_cselect_b32 s64, s37, 0
    s_sub_u32 s39, s35, 24
    s_lshl_b32 s39, s39, 1
    s_add_u32 s39, s39, 24
    s_add_u32 s39, s39, s37
    s_cmp_lt_u32 s35, 24
    s_cselect_b32 s65, s35, s39
    s_cmp_eq_u32 s64, 0
    s_cselect_b32 s16, s4, s8
    s_cselect_b32 s17, s5, s9
    s_mov_b32 s28, 3072
    s_cselect_b32 s28, 3840, s28
    s_mov_b32 s18, 1966080
    s_cselect_b32 s18, 2457600, s18
    s_cselect_b32 s66, 0, 1920
    s_lshl_b32 s39, s65, 7
    s_add_u32 s16, s16, s39
    s_addc_u32 s17, s17, 0
    s_and_b32 s17, s17, 0xffff
    s_sub_u32 s18, s18, s39
    s_mov_b32 s19, 0x20000
    s_lshl_b32 s39, s65, 6
    s_add_u32 s66, s66, s39
    s_lshl_b32 s31, s28, 6
    s_lshl_b32 s32, s3, 12
    s_lshl_b32 s33, s3, 11
    s_add_u32 s33, s33, 98304
    v_lshrrev_b32 v3, 5, v1
    v_lshrrev_b32 v52, 3, v1
    v_and_b32 v53, 7, v1
    v_lshrrev_b32 v54, 4, v1
    s_lshl_b32 s39, s3, 5
    s_movk_i32 s40, 1280
    v_add_u32 v55, s39, v52
    v_mul_lo_u32 v55, v55, s40
    v_xor_b32 v56, v53, v54
    v_xor_b32 v57, 4, v56
    v_lshl_add_u32 v4, v56, 4, v55
    v_lshl_add_u32 v5, v57, 4, v55
    v_add_u32 v5, 9216, v5
    v_add_u32 v6, 18432, v4
    v_add_u32 v7, 18432, v5
    v_and_b32 v56, 1, v54
    v_lshlrev_b32 v56, 2, v56
    v_xor_b32 v56, v53, v56
    s_lshl_b32 s39, s36, 4
    v_add_u32 v55, s39, v52
    v_mul_lo_u32 v55, v55, s28
    v_lshl_add_u32 v8, v56, 4, v55
    s_lshl_b32 s39, s28, 3
    s_sub_u32 s39, s39, 1024
    v_add_u32 v9, s39, v8
    s_mov_b32 s29, 0
    s_mov_b32 s30, 0

    s_add_u32 m0, s32, 0
    s_nop 0
    buffer_load_dwordx4 v4, s[12:15], s29 offen offset:0 lds
    buffer_load_dwordx4 v5, s[12:15], s29 offen offset:1024 lds
    s_add_u32 m0, s32, 0
    s_nop 0
    buffer_load_dwordx4 v6, s[12:15], s29 offen offset:2048 lds
    buffer_load_dwordx4 v7, s[12:15], s29 offen offset:3072 lds
    s_add_u32 s29, s29, 128
    s_add_u32 m0, s33, 0
    s_nop 0
    buffer_load_dwordx4 v8, s[16:19], s30 offen offset:0 lds
    buffer_load_dwordx4 v9, s[16:19], s30 offen offset:1024 lds
    s_add_u32 s30, s30, s31
    s_barrier
    s_add_u32 m0, s32, 32768
    s_nop 0
    buffer_load_dwordx4 v4, s[12:15], s29 offen offset:0 lds
    buffer_load_dwordx4 v5, s[12:15], s29 offen offset:1024 lds
    s_add_u32 m0, s32, 32768
    s_nop 0
    buffer_load_dwordx4 v6, s[12:15], s29 offen offset:2048 lds
    buffer_load_dwordx4 v7, s[12:15], s29 offen offset:3072 lds
    s_add_u32 s29, s29, 128
    s_add_u32 m0, s33, 16384
    s_nop 0
    buffer_load_dwordx4 v8, s[16:19], s30 offen offset:0 lds
    buffer_load_dwordx4 v9, s[16:19], s30 offen offset:1024 lds
    s_add_u32 s30, s30, s31
    v_and_b32 v52, 31, v1
    s_lshl_b32 s39, s36, 6
    s_lshl_b32 s40, s37, 5
    s_add_u32 s39, s39, s40
    v_add_u32 v53, s39, v52
    v_lshlrev_b32 v53, 7, v53
    v_lshrrev_b32 v54, 1, v52
    v_and_b32 v54, 7, v54

    v_add_u32 v55, 0, v3
    v_xor_b32 v55, v55, v54
    v_lshl_add_u32 v10, v55, 4, v53
    v_xor_b32 v200, 0x1000, v10
    v_add_u32 v14, 0x10000, v10
    v_add_u32 v204, 0x10000, v200

    v_add_u32 v55, 2, v3
    v_xor_b32 v55, v55, v54
    v_lshl_add_u32 v11, v55, 4, v53
    v_xor_b32 v201, 0x1000, v11
    v_add_u32 v15, 0x10000, v11
    v_add_u32 v205, 0x10000, v201

    v_add_u32 v55, 4, v3
    v_xor_b32 v55, v55, v54
    v_lshl_add_u32 v12, v55, 4, v53
    v_xor_b32 v202, 0x1000, v12
    v_add_u32 v16, 0x10000, v12
    v_add_u32 v206, 0x10000, v202

    v_add_u32 v55, 6, v3
    v_xor_b32 v55, v55, v54
    v_lshl_add_u32 v13, v55, 4, v53
    v_xor_b32 v203, 0x1000, v13
    v_add_u32 v17, 0x10000, v13
    v_add_u32 v207, 0x10000, v203

    v_lshrrev_b32 v52, 4, v1
    v_and_b32 v53, 15, v1
    v_lshrrev_b32 v54, 2, v53
    v_lshrrev_b32 v55, 1, v52
    v_lshl_add_u32 v55, v55, 3, v54
    v_lshlrev_b32 v55, 7, v55
    v_and_b32 v56, 1, v53
    v_lshl_add_u32 v55, v56, 3, v55
    s_lshl_b32 s39, s37, 13
    s_add_u32 s39, s39, 98304
    v_add_u32 v55, s39, v55
    v_and_b32 v56, 1, v52
    v_lshlrev_b32 v56, 1, v56
    v_bfe_u32 v57, v53, 1, 1
    v_add_u32 v56, v56, v57
    v_bfe_u32 v54, v53, 3, 1
    v_lshlrev_b32 v54, 2, v54

    v_add_u32 v57, 0, v56
    v_xor_b32 v57, v57, v54
    v_lshl_add_u32 v18, v57, 4, v55

    v_add_u32 v57, 4, v56
    v_xor_b32 v57, v57, v54
    v_lshl_add_u32 v19, v57, 4, v55

    v_mov_b32 v64, 0
    v_mov_b32 v65, 0
    v_mov_b32 v66, 0
    v_mov_b32 v67, 0
    v_mov_b32 v68, 0
    v_mov_b32 v69, 0
    v_mov_b32 v70, 0
    v_mov_b32 v71, 0
    v_mov_b32 v72, 0
    v_mov_b32 v73, 0
    v_mov_b32 v74, 0
    v_mov_b32 v75, 0
    v_mov_b32 v76, 0
    v_mov_b32 v77, 0
    v_mov_b32 v78, 0
    v_mov_b32 v79, 0
    v_mov_b32 v80, 0
    v_mov_b32 v81, 0
    v_mov_b32 v82, 0
    v_mov_b32 v83, 0
    v_mov_b32 v84, 0
    v_mov_b32 v85, 0
    v_mov_b32 v86, 0
    v_mov_b32 v87, 0
    v_mov_b32 v88, 0
    v_mov_b32 v89, 0
    v_mov_b32 v90, 0
    v_mov_b32 v91, 0
    v_mov_b32 v92, 0
    v_mov_b32 v93, 0
    v_mov_b32 v94, 0
    v_mov_b32 v95, 0
    v_mov_b32 v96, 0
    v_mov_b32 v97, 0
    v_mov_b32 v98, 0
    v_mov_b32 v99, 0
    v_mov_b32 v100, 0
    v_mov_b32 v101, 0
    v_mov_b32 v102, 0
    v_mov_b32 v103, 0
    v_mov_b32 v104, 0
    v_mov_b32 v105, 0
    v_mov_b32 v106, 0
    v_mov_b32 v107, 0
    v_mov_b32 v108, 0
    v_mov_b32 v109, 0
    v_mov_b32 v110, 0
    v_mov_b32 v111, 0
    v_mov_b32 v112, 0
    v_mov_b32 v113, 0
    v_mov_b32 v114, 0
    v_mov_b32 v115, 0
    v_mov_b32 v116, 0
    v_mov_b32 v117, 0
    v_mov_b32 v118, 0
    v_mov_b32 v119, 0
    v_mov_b32 v120, 0
    v_mov_b32 v121, 0
    v_mov_b32 v122, 0
    v_mov_b32 v123, 0
    v_mov_b32 v124, 0
    v_mov_b32 v125, 0
    v_mov_b32 v126, 0
    v_mov_b32 v127, 0
    v_mov_b32 v208, 0
    v_mov_b32 v209, 0
    v_mov_b32 v210, 0
    v_mov_b32 v211, 0
    v_mov_b32 v212, 0
    v_mov_b32 v213, 0
    v_mov_b32 v214, 0
    v_mov_b32 v215, 0
    s_lshl_b32 s58, s34, 8
    s_lshl_b32 s39, s36, 6
    s_add_u32 s58, s58, s39
    s_lshl_b32 s39, s37, 5
    s_add_u32 s58, s58, s39
    s_xor_b32 s59, s58, 32
    s_lshl_b32 s58, s58, 2
    s_lshl_b32 s59, s59, 2
    s_cmp_eq_u32 s64, 0
    s_cselect_b32 s39, 0, 16384
    s_add_u32 s58, s58, s39
    s_add_u32 s59, s59, s39
    s_add_u32 s61, s58, 8192
    s_add_u32 s63, s59, 8192
    v_and_b32 v220, 31, v1
    v_lshlrev_b32 v220, 2, v220
    v_lshlrev_b32 v221, 4, v3
    v_mov_b32 v222, 0
    s_mov_b32 s62, 0
    s_cmp_lt_u32 s66, 1280
    s_cbranch_scc1 K1_MAIN_N
    s_cmp_ge_u32 s66, 1920
    s_cbranch_scc1 K1_MAIN_N

K1_MAIN_V:
    s_mov_b32 s48, 0
    s_mov_b32 s49, -1
    s_waitcnt vmcnt(6)
    s_barrier
    ds_read_b128 v[20:23], v10 offset:0
    ds_read_b128 v[24:27], v200 offset:0
    ds_read_b64_tr_b16 v[28:29], v18 offset:0
    ds_read_b64_tr_b16 v[30:31], v18 offset:512
    ds_read_b64_tr_b16 v[32:33], v19 offset:0
    ds_read_b64_tr_b16 v[34:35], v19 offset:512
    ds_read_b128 v[36:39], v11 offset:0
    ds_read_b128 v[40:43], v201 offset:0
    ds_read_b64_tr_b16 v[44:45], v18 offset:2048
    ds_read_b64_tr_b16 v[46:47], v18 offset:2560
    ds_read_b64_tr_b16 v[48:49], v19 offset:2048
    ds_read_b64_tr_b16 v[50:51], v19 offset:2560
    s_waitcnt lgkmcnt(6)
    v_mfma_f32_32x32x16_bf16 v[64:79], v[20:23], v[28:31], v[64:79]
    v_mfma_f32_32x32x16_bf16 v[80:95], v[20:23], v[32:35], v[80:95]
    v_mfma_f32_32x32x16_bf16 v[96:111], v[24:27], v[28:31], v[96:111]
    v_mfma_f32_32x32x16_bf16 v[112:127], v[24:27], v[32:35], v[112:127]
    s_cmp_lg_u32 s36, 0
    s_cbranch_scc1 K1_CS_1
    v_lshlrev_b32 v218, 16, v28
    v_and_b32 v219, 0xffff0000, v28
    v_add_f32 v212, v212, v218
    v_add_f32 v213, v213, v219
    v_lshlrev_b32 v218, 16, v29
    v_and_b32 v219, 0xffff0000, v29
    v_add_f32 v212, v212, v218
    v_add_f32 v213, v213, v219
    v_lshlrev_b32 v218, 16, v30
    v_and_b32 v219, 0xffff0000, v30
    v_add_f32 v212, v212, v218
    v_add_f32 v213, v213, v219
    v_lshlrev_b32 v218, 16, v31
    v_and_b32 v219, 0xffff0000, v31
    v_add_f32 v212, v212, v218
    v_add_f32 v213, v213, v219
    v_lshlrev_b32 v218, 16, v32
    v_and_b32 v219, 0xffff0000, v32
    v_add_f32 v214, v214, v218
    v_add_f32 v215, v215, v219
    v_lshlrev_b32 v218, 16, v33
    v_and_b32 v219, 0xffff0000, v33
    v_add_f32 v214, v214, v218
    v_add_f32 v215, v215, v219
    v_lshlrev_b32 v218, 16, v34
    v_and_b32 v219, 0xffff0000, v34
    v_add_f32 v214, v214, v218
    v_add_f32 v215, v215, v219
    v_lshlrev_b32 v218, 16, v35
    v_and_b32 v219, 0xffff0000, v35
    v_add_f32 v214, v214, v218
    v_add_f32 v215, v215, v219
K1_CS_1:
    s_add_u32 m0, s32, 65536
    s_nop 0
    buffer_load_dwordx4 v4, s[12:15], s29 offen offset:0 lds
    buffer_load_dwordx4 v5, s[12:15], s29 offen offset:1024 lds
    ds_read_b128 v[20:23], v12 offset:0
    ds_read_b128 v[24:27], v202 offset:0
    ds_read_b64_tr_b16 v[28:29], v18 offset:4096
    ds_read_b64_tr_b16 v[30:31], v18 offset:4608
    ds_read_b64_tr_b16 v[32:33], v19 offset:4096
    ds_read_b64_tr_b16 v[34:35], v19 offset:4608
    s_waitcnt lgkmcnt(6)
    v_mfma_f32_32x32x16_bf16 v[64:79], v[36:39], v[44:47], v[64:79]
    v_mfma_f32_32x32x16_bf16 v[80:95], v[36:39], v[48:51], v[80:95]
    v_mfma_f32_32x32x16_bf16 v[96:111], v[40:43], v[44:47], v[96:111]
    v_mfma_f32_32x32x16_bf16 v[112:127], v[40:43], v[48:51], v[112:127]
    s_cmp_lg_u32 s36, 1
    s_cbranch_scc1 K1_CS_2
    v_lshlrev_b32 v218, 16, v44
    v_and_b32 v219, 0xffff0000, v44
    v_add_f32 v212, v212, v218
    v_add_f32 v213, v213, v219
    v_lshlrev_b32 v218, 16, v45
    v_and_b32 v219, 0xffff0000, v45
    v_add_f32 v212, v212, v218
    v_add_f32 v213, v213, v219
    v_lshlrev_b32 v218, 16, v46
    v_and_b32 v219, 0xffff0000, v46
    v_add_f32 v212, v212, v218
    v_add_f32 v213, v213, v219
    v_lshlrev_b32 v218, 16, v47
    v_and_b32 v219, 0xffff0000, v47
    v_add_f32 v212, v212, v218
    v_add_f32 v213, v213, v219
    v_lshlrev_b32 v218, 16, v48
    v_and_b32 v219, 0xffff0000, v48
    v_add_f32 v214, v214, v218
    v_add_f32 v215, v215, v219
    v_lshlrev_b32 v218, 16, v49
    v_and_b32 v219, 0xffff0000, v49
    v_add_f32 v214, v214, v218
    v_add_f32 v215, v215, v219
    v_lshlrev_b32 v218, 16, v50
    v_and_b32 v219, 0xffff0000, v50
    v_add_f32 v214, v214, v218
    v_add_f32 v215, v215, v219
    v_lshlrev_b32 v218, 16, v51
    v_and_b32 v219, 0xffff0000, v51
    v_add_f32 v214, v214, v218
    v_add_f32 v215, v215, v219
K1_CS_2:
    s_add_u32 m0, s32, 65536
    s_nop 0
    buffer_load_dwordx4 v6, s[12:15], s29 offen offset:2048 lds
    buffer_load_dwordx4 v7, s[12:15], s29 offen offset:3072 lds
    s_add_u32 s29, s29, 128
    ds_read_b128 v[36:39], v13 offset:0
    ds_read_b128 v[40:43], v203 offset:0
    ds_read_b64_tr_b16 v[44:45], v18 offset:6144
    ds_read_b64_tr_b16 v[46:47], v18 offset:6656
    ds_read_b64_tr_b16 v[48:49], v19 offset:6144
    ds_read_b64_tr_b16 v[50:51], v19 offset:6656
    s_waitcnt lgkmcnt(6)
    v_mfma_f32_32x32x16_bf16 v[64:79], v[20:23], v[28:31], v[64:79]
    v_mfma_f32_32x32x16_bf16 v[80:95], v[20:23], v[32:35], v[80:95]
    v_mfma_f32_32x32x16_bf16 v[96:111], v[24:27], v[28:31], v[96:111]
    v_mfma_f32_32x32x16_bf16 v[112:127], v[24:27], v[32:35], v[112:127]
    s_cmp_lg_u32 s36, 2
    s_cbranch_scc1 K1_CS_3
    v_lshlrev_b32 v218, 16, v28
    v_and_b32 v219, 0xffff0000, v28
    v_add_f32 v212, v212, v218
    v_add_f32 v213, v213, v219
    v_lshlrev_b32 v218, 16, v29
    v_and_b32 v219, 0xffff0000, v29
    v_add_f32 v212, v212, v218
    v_add_f32 v213, v213, v219
    v_lshlrev_b32 v218, 16, v30
    v_and_b32 v219, 0xffff0000, v30
    v_add_f32 v212, v212, v218
    v_add_f32 v213, v213, v219
    v_lshlrev_b32 v218, 16, v31
    v_and_b32 v219, 0xffff0000, v31
    v_add_f32 v212, v212, v218
    v_add_f32 v213, v213, v219
    v_lshlrev_b32 v218, 16, v32
    v_and_b32 v219, 0xffff0000, v32
    v_add_f32 v214, v214, v218
    v_add_f32 v215, v215, v219
    v_lshlrev_b32 v218, 16, v33
    v_and_b32 v219, 0xffff0000, v33
    v_add_f32 v214, v214, v218
    v_add_f32 v215, v215, v219
    v_lshlrev_b32 v218, 16, v34
    v_and_b32 v219, 0xffff0000, v34
    v_add_f32 v214, v214, v218
    v_add_f32 v215, v215, v219
    v_lshlrev_b32 v218, 16, v35
    v_and_b32 v219, 0xffff0000, v35
    v_add_f32 v214, v214, v218
    v_add_f32 v215, v215, v219
K1_CS_3:
    s_add_u32 m0, s33, 32768
    s_nop 0
    buffer_load_dwordx4 v8, s[16:19], s30 offen offset:0 lds
    buffer_load_dwordx4 v9, s[16:19], s30 offen offset:1024 lds
    s_add_u32 s30, s30, s31
    s_waitcnt vmcnt(6) lgkmcnt(0)
    s_barrier
    ds_read_b128 v[20:23], v10 offset:32768
    ds_read_b128 v[24:27], v200 offset:32768
    ds_read_b64_tr_b16 v[28:29], v18 offset:16384
    ds_read_b64_tr_b16 v[30:31], v18 offset:16896
    ds_read_b64_tr_b16 v[32:33], v19 offset:16384
    ds_read_b64_tr_b16 v[34:35], v19 offset:16896
    v_mfma_f32_32x32x16_bf16 v[64:79], v[36:39], v[44:47], v[64:79]
    v_mfma_f32_32x32x16_bf16 v[80:95], v[36:39], v[48:51], v[80:95]
    v_mfma_f32_32x32x16_bf16 v[96:111], v[40:43], v[44:47], v[96:111]
    v_mfma_f32_32x32x16_bf16 v[112:127], v[40:43], v[48:51], v[112:127]
    s_cmp_lg_u32 s36, 3
    s_cbranch_scc1 K1_CS_4
    v_lshlrev_b32 v218, 16, v44
    v_and_b32 v219, 0xffff0000, v44
    v_add_f32 v212, v212, v218
    v_add_f32 v213, v213, v219
    v_lshlrev_b32 v218, 16, v45
    v_and_b32 v219, 0xffff0000, v45
    v_add_f32 v212, v212, v218
    v_add_f32 v213, v213, v219
    v_lshlrev_b32 v218, 16, v46
    v_and_b32 v219, 0xffff0000, v46
    v_add_f32 v212, v212, v218
    v_add_f32 v213, v213, v219
    v_lshlrev_b32 v218, 16, v47
    v_and_b32 v219, 0xffff0000, v47
    v_add_f32 v212, v212, v218
    v_add_f32 v213, v213, v219
    v_lshlrev_b32 v218, 16, v48
    v_and_b32 v219, 0xffff0000, v48
    v_add_f32 v214, v214, v218
    v_add_f32 v215, v215, v219
    v_lshlrev_b32 v218, 16, v49
    v_and_b32 v219, 0xffff0000, v49
    v_add_f32 v214, v214, v218
    v_add_f32 v215, v215, v219
    v_lshlrev_b32 v218, 16, v50
    v_and_b32 v219, 0xffff0000, v50
    v_add_f32 v214, v214, v218
    v_add_f32 v215, v215, v219
    v_lshlrev_b32 v218, 16, v51
    v_and_b32 v219, 0xffff0000, v51
    v_add_f32 v214, v214, v218
    v_add_f32 v215, v215, v219
K1_CS_4:
    ds_read_b128 v[36:39], v11 offset:32768
    ds_read_b128 v[40:43], v201 offset:32768
    ds_read_b64_tr_b16 v[44:45], v18 offset:18432
    ds_read_b64_tr_b16 v[46:47], v18 offset:18944
    ds_read_b64_tr_b16 v[48:49], v19 offset:18432
    ds_read_b64_tr_b16 v[50:51], v19 offset:18944
    s_waitcnt lgkmcnt(6)
    v_mfma_f32_32x32x16_bf16 v[64:79], v[20:23], v[28:31], v[64:79]
    v_mfma_f32_32x32x16_bf16 v[80:95], v[20:23], v[32:35], v[80:95]
    v_mfma_f32_32x32x16_bf16 v[96:111], v[24:27], v[28:31], v[96:111]
    v_mfma_f32_32x32x16_bf16 v[112:127], v[24:27], v[32:35], v[112:127]
    s_cmp_lg_u32 s36, 0
    s_cbranch_scc1 K1_CS_5
    v_lshlrev_b32 v218, 16, v28
    v_and_b32 v219, 0xffff0000, v28
    v_add_f32 v212, v212, v218
    v_add_f32 v213, v213, v219
    v_lshlrev_b32 v218, 16, v29
    v_and_b32 v219, 0xffff0000, v29
    v_add_f32 v212, v212, v218
    v_add_f32 v213, v213, v219
    v_lshlrev_b32 v218, 16, v30
    v_and_b32 v219, 0xffff0000, v30
    v_add_f32 v212, v212, v218
    v_add_f32 v213, v213, v219
    v_lshlrev_b32 v218, 16, v31
    v_and_b32 v219, 0xffff0000, v31
    v_add_f32 v212, v212, v218
    v_add_f32 v213, v213, v219
    v_lshlrev_b32 v218, 16, v32
    v_and_b32 v219, 0xffff0000, v32
    v_add_f32 v214, v214, v218
    v_add_f32 v215, v215, v219
    v_lshlrev_b32 v218, 16, v33
    v_and_b32 v219, 0xffff0000, v33
    v_add_f32 v214, v214, v218
    v_add_f32 v215, v215, v219
    v_lshlrev_b32 v218, 16, v34
    v_and_b32 v219, 0xffff0000, v34
    v_add_f32 v214, v214, v218
    v_add_f32 v215, v215, v219
    v_lshlrev_b32 v218, 16, v35
    v_and_b32 v219, 0xffff0000, v35
    v_add_f32 v214, v214, v218
    v_add_f32 v215, v215, v219
K1_CS_5:
    s_add_u32 m0, s32, 0
    s_nop 0
    buffer_load_dwordx4 v4, s[12:15], s29 offen offset:0 lds
    buffer_load_dwordx4 v5, s[12:15], s29 offen offset:1024 lds
    ds_read_b128 v[20:23], v12 offset:32768
    ds_read_b128 v[24:27], v202 offset:32768
    ds_read_b64_tr_b16 v[28:29], v18 offset:20480
    ds_read_b64_tr_b16 v[30:31], v18 offset:20992
    ds_read_b64_tr_b16 v[32:33], v19 offset:20480
    ds_read_b64_tr_b16 v[34:35], v19 offset:20992
    s_waitcnt lgkmcnt(6)
    v_mfma_f32_32x32x16_bf16 v[64:79], v[36:39], v[44:47], v[64:79]
    v_mfma_f32_32x32x16_bf16 v[80:95], v[36:39], v[48:51], v[80:95]
    v_mfma_f32_32x32x16_bf16 v[96:111], v[40:43], v[44:47], v[96:111]
    v_mfma_f32_32x32x16_bf16 v[112:127], v[40:43], v[48:51], v[112:127]
    s_cmp_lg_u32 s36, 1
    s_cbranch_scc1 K1_CS_6
    v_lshlrev_b32 v218, 16, v44
    v_and_b32 v219, 0xffff0000, v44
    v_add_f32 v212, v212, v218
    v_add_f32 v213, v213, v219
    v_lshlrev_b32 v218, 16, v45
    v_and_b32 v219, 0xffff0000, v45
    v_add_f32 v212, v212, v218
    v_add_f32 v213, v213, v219
    v_lshlrev_b32 v218, 16, v46
    v_and_b32 v219, 0xffff0000, v46
    v_add_f32 v212, v212, v218
    v_add_f32 v213, v213, v219
    v_lshlrev_b32 v218, 16, v47
    v_and_b32 v219, 0xffff0000, v47
    v_add_f32 v212, v212, v218
    v_add_f32 v213, v213, v219
    v_lshlrev_b32 v218, 16, v48
    v_and_b32 v219, 0xffff0000, v48
    v_add_f32 v214, v214, v218
    v_add_f32 v215, v215, v219
    v_lshlrev_b32 v218, 16, v49
    v_and_b32 v219, 0xffff0000, v49
    v_add_f32 v214, v214, v218
    v_add_f32 v215, v215, v219
    v_lshlrev_b32 v218, 16, v50
    v_and_b32 v219, 0xffff0000, v50
    v_add_f32 v214, v214, v218
    v_add_f32 v215, v215, v219
    v_lshlrev_b32 v218, 16, v51
    v_and_b32 v219, 0xffff0000, v51
    v_add_f32 v214, v214, v218
    v_add_f32 v215, v215, v219
K1_CS_6:
    s_add_u32 m0, s32, 0
    s_nop 0
    buffer_load_dwordx4 v6, s[12:15], s29 offen offset:2048 lds
    buffer_load_dwordx4 v7, s[12:15], s29 offen offset:3072 lds
    s_add_u32 s29, s29, 128
    ds_read_b128 v[36:39], v13 offset:32768
    ds_read_b128 v[40:43], v203 offset:32768
    ds_read_b64_tr_b16 v[44:45], v18 offset:22528
    ds_read_b64_tr_b16 v[46:47], v18 offset:23040
    ds_read_b64_tr_b16 v[48:49], v19 offset:22528
    ds_read_b64_tr_b16 v[50:51], v19 offset:23040
    s_waitcnt lgkmcnt(6)
    v_mfma_f32_32x32x16_bf16 v[64:79], v[20:23], v[28:31], v[64:79]
    v_mfma_f32_32x32x16_bf16 v[80:95], v[20:23], v[32:35], v[80:95]
    v_mfma_f32_32x32x16_bf16 v[96:111], v[24:27], v[28:31], v[96:111]
    v_mfma_f32_32x32x16_bf16 v[112:127], v[24:27], v[32:35], v[112:127]
    s_cmp_lg_u32 s36, 2
    s_cbranch_scc1 K1_CS_7
    v_lshlrev_b32 v218, 16, v28
    v_and_b32 v219, 0xffff0000, v28
    v_add_f32 v212, v212, v218
    v_add_f32 v213, v213, v219
    v_lshlrev_b32 v218, 16, v29
    v_and_b32 v219, 0xffff0000, v29
    v_add_f32 v212, v212, v218
    v_add_f32 v213, v213, v219
    v_lshlrev_b32 v218, 16, v30
    v_and_b32 v219, 0xffff0000, v30
    v_add_f32 v212, v212, v218
    v_add_f32 v213, v213, v219
    v_lshlrev_b32 v218, 16, v31
    v_and_b32 v219, 0xffff0000, v31
    v_add_f32 v212, v212, v218
    v_add_f32 v213, v213, v219
    v_lshlrev_b32 v218, 16, v32
    v_and_b32 v219, 0xffff0000, v32
    v_add_f32 v214, v214, v218
    v_add_f32 v215, v215, v219
    v_lshlrev_b32 v218, 16, v33
    v_and_b32 v219, 0xffff0000, v33
    v_add_f32 v214, v214, v218
    v_add_f32 v215, v215, v219
    v_lshlrev_b32 v218, 16, v34
    v_and_b32 v219, 0xffff0000, v34
    v_add_f32 v214, v214, v218
    v_add_f32 v215, v215, v219
    v_lshlrev_b32 v218, 16, v35
    v_and_b32 v219, 0xffff0000, v35
    v_add_f32 v214, v214, v218
    v_add_f32 v215, v215, v219
K1_CS_7:
    s_add_u32 m0, s33, 0
    s_nop 0
    buffer_load_dwordx4 v8, s[16:19], s30 offen offset:0 lds
    buffer_load_dwordx4 v9, s[16:19], s30 offen offset:1024 lds
    s_add_u32 s30, s30, s31
    s_waitcnt vmcnt(6) lgkmcnt(0)
    s_barrier
    ds_read_b128 v[20:23], v14 offset:0
    ds_read_b128 v[24:27], v204 offset:0
    ds_read_b64_tr_b16 v[28:29], v18 offset:32768
    ds_read_b64_tr_b16 v[30:31], v18 offset:33280
    ds_read_b64_tr_b16 v[32:33], v19 offset:32768
    ds_read_b64_tr_b16 v[34:35], v19 offset:33280
    v_mfma_f32_32x32x16_bf16 v[64:79], v[36:39], v[44:47], v[64:79]
    v_mfma_f32_32x32x16_bf16 v[80:95], v[36:39], v[48:51], v[80:95]
    v_mfma_f32_32x32x16_bf16 v[96:111], v[40:43], v[44:47], v[96:111]
    v_mfma_f32_32x32x16_bf16 v[112:127], v[40:43], v[48:51], v[112:127]
    s_cmp_lg_u32 s36, 3
    s_cbranch_scc1 K1_CS_8
    v_lshlrev_b32 v218, 16, v44
    v_and_b32 v219, 0xffff0000, v44
    v_add_f32 v212, v212, v218
    v_add_f32 v213, v213, v219
    v_lshlrev_b32 v218, 16, v45
    v_and_b32 v219, 0xffff0000, v45
    v_add_f32 v212, v212, v218
    v_add_f32 v213, v213, v219
    v_lshlrev_b32 v218, 16, v46
    v_and_b32 v219, 0xffff0000, v46
    v_add_f32 v212, v212, v218
    v_add_f32 v213, v213, v219
    v_lshlrev_b32 v218, 16, v47
    v_and_b32 v219, 0xffff0000, v47
    v_add_f32 v212, v212, v218
    v_add_f32 v213, v213, v219
    v_lshlrev_b32 v218, 16, v48
    v_and_b32 v219, 0xffff0000, v48
    v_add_f32 v214, v214, v218
    v_add_f32 v215, v215, v219
    v_lshlrev_b32 v218, 16, v49
    v_and_b32 v219, 0xffff0000, v49
    v_add_f32 v214, v214, v218
    v_add_f32 v215, v215, v219
    v_lshlrev_b32 v218, 16, v50
    v_and_b32 v219, 0xffff0000, v50
    v_add_f32 v214, v214, v218
    v_add_f32 v215, v215, v219
    v_lshlrev_b32 v218, 16, v51
    v_and_b32 v219, 0xffff0000, v51
    v_add_f32 v214, v214, v218
    v_add_f32 v215, v215, v219
K1_CS_8:
    ds_read_b128 v[36:39], v15 offset:0
    ds_read_b128 v[40:43], v205 offset:0
    ds_read_b64_tr_b16 v[44:45], v18 offset:34816
    ds_read_b64_tr_b16 v[46:47], v18 offset:35328
    ds_read_b64_tr_b16 v[48:49], v19 offset:34816
    ds_read_b64_tr_b16 v[50:51], v19 offset:35328
    s_waitcnt lgkmcnt(6)
    v_mfma_f32_32x32x16_bf16 v[64:79], v[20:23], v[28:31], v[64:79]
    v_mfma_f32_32x32x16_bf16 v[80:95], v[20:23], v[32:35], v[80:95]
    v_mfma_f32_32x32x16_bf16 v[96:111], v[24:27], v[28:31], v[96:111]
    v_mfma_f32_32x32x16_bf16 v[112:127], v[24:27], v[32:35], v[112:127]
    s_cmp_lg_u32 s36, 0
    s_cbranch_scc1 K1_CS_9
    v_lshlrev_b32 v218, 16, v28
    v_and_b32 v219, 0xffff0000, v28
    v_add_f32 v212, v212, v218
    v_add_f32 v213, v213, v219
    v_lshlrev_b32 v218, 16, v29
    v_and_b32 v219, 0xffff0000, v29
    v_add_f32 v212, v212, v218
    v_add_f32 v213, v213, v219
    v_lshlrev_b32 v218, 16, v30
    v_and_b32 v219, 0xffff0000, v30
    v_add_f32 v212, v212, v218
    v_add_f32 v213, v213, v219
    v_lshlrev_b32 v218, 16, v31
    v_and_b32 v219, 0xffff0000, v31
    v_add_f32 v212, v212, v218
    v_add_f32 v213, v213, v219
    v_lshlrev_b32 v218, 16, v32
    v_and_b32 v219, 0xffff0000, v32
    v_add_f32 v214, v214, v218
    v_add_f32 v215, v215, v219
    v_lshlrev_b32 v218, 16, v33
    v_and_b32 v219, 0xffff0000, v33
    v_add_f32 v214, v214, v218
    v_add_f32 v215, v215, v219
    v_lshlrev_b32 v218, 16, v34
    v_and_b32 v219, 0xffff0000, v34
    v_add_f32 v214, v214, v218
    v_add_f32 v215, v215, v219
    v_lshlrev_b32 v218, 16, v35
    v_and_b32 v219, 0xffff0000, v35
    v_add_f32 v214, v214, v218
    v_add_f32 v215, v215, v219
K1_CS_9:
    s_add_u32 m0, s32, 32768
    s_nop 0
    buffer_load_dwordx4 v4, s[12:15], s29 offen offset:0 lds
    buffer_load_dwordx4 v5, s[12:15], s29 offen offset:1024 lds
    ds_read_b128 v[20:23], v16 offset:0
    ds_read_b128 v[24:27], v206 offset:0
    ds_read_b64_tr_b16 v[28:29], v18 offset:36864
    ds_read_b64_tr_b16 v[30:31], v18 offset:37376
    ds_read_b64_tr_b16 v[32:33], v19 offset:36864
    ds_read_b64_tr_b16 v[34:35], v19 offset:37376
    s_waitcnt lgkmcnt(6)
    v_mfma_f32_32x32x16_bf16 v[64:79], v[36:39], v[44:47], v[64:79]
    v_mfma_f32_32x32x16_bf16 v[80:95], v[36:39], v[48:51], v[80:95]
    v_mfma_f32_32x32x16_bf16 v[96:111], v[40:43], v[44:47], v[96:111]
    v_mfma_f32_32x32x16_bf16 v[112:127], v[40:43], v[48:51], v[112:127]
    s_cmp_lg_u32 s36, 1
    s_cbranch_scc1 K1_CS_10
    v_lshlrev_b32 v218, 16, v44
    v_and_b32 v219, 0xffff0000, v44
    v_add_f32 v212, v212, v218
    v_add_f32 v213, v213, v219
    v_lshlrev_b32 v218, 16, v45
    v_and_b32 v219, 0xffff0000, v45
    v_add_f32 v212, v212, v218
    v_add_f32 v213, v213, v219
    v_lshlrev_b32 v218, 16, v46
    v_and_b32 v219, 0xffff0000, v46
    v_add_f32 v212, v212, v218
    v_add_f32 v213, v213, v219
    v_lshlrev_b32 v218, 16, v47
    v_and_b32 v219, 0xffff0000, v47
    v_add_f32 v212, v212, v218
    v_add_f32 v213, v213, v219
    v_lshlrev_b32 v218, 16, v48
    v_and_b32 v219, 0xffff0000, v48
    v_add_f32 v214, v214, v218
    v_add_f32 v215, v215, v219
    v_lshlrev_b32 v218, 16, v49
    v_and_b32 v219, 0xffff0000, v49
    v_add_f32 v214, v214, v218
    v_add_f32 v215, v215, v219
    v_lshlrev_b32 v218, 16, v50
    v_and_b32 v219, 0xffff0000, v50
    v_add_f32 v214, v214, v218
    v_add_f32 v215, v215, v219
    v_lshlrev_b32 v218, 16, v51
    v_and_b32 v219, 0xffff0000, v51
    v_add_f32 v214, v214, v218
    v_add_f32 v215, v215, v219
K1_CS_10:
    s_add_u32 m0, s32, 32768
    s_nop 0
    buffer_load_dwordx4 v6, s[12:15], s29 offen offset:2048 lds
    buffer_load_dwordx4 v7, s[12:15], s29 offen offset:3072 lds
    s_add_u32 s29, s29, 128
    ds_read_b128 v[36:39], v17 offset:0
    ds_read_b128 v[40:43], v207 offset:0
    ds_read_b64_tr_b16 v[44:45], v18 offset:38912
    ds_read_b64_tr_b16 v[46:47], v18 offset:39424
    ds_read_b64_tr_b16 v[48:49], v19 offset:38912
    ds_read_b64_tr_b16 v[50:51], v19 offset:39424
    s_waitcnt lgkmcnt(6)
    v_mfma_f32_32x32x16_bf16 v[64:79], v[20:23], v[28:31], v[64:79]
    v_mfma_f32_32x32x16_bf16 v[80:95], v[20:23], v[32:35], v[80:95]
    v_mfma_f32_32x32x16_bf16 v[96:111], v[24:27], v[28:31], v[96:111]
    v_mfma_f32_32x32x16_bf16 v[112:127], v[24:27], v[32:35], v[112:127]
    s_cmp_lg_u32 s36, 2
    s_cbranch_scc1 K1_CS_11
    v_lshlrev_b32 v218, 16, v28
    v_and_b32 v219, 0xffff0000, v28
    v_add_f32 v212, v212, v218
    v_add_f32 v213, v213, v219
    v_lshlrev_b32 v218, 16, v29
    v_and_b32 v219, 0xffff0000, v29
    v_add_f32 v212, v212, v218
    v_add_f32 v213, v213, v219
    v_lshlrev_b32 v218, 16, v30
    v_and_b32 v219, 0xffff0000, v30
    v_add_f32 v212, v212, v218
    v_add_f32 v213, v213, v219
    v_lshlrev_b32 v218, 16, v31
    v_and_b32 v219, 0xffff0000, v31
    v_add_f32 v212, v212, v218
    v_add_f32 v213, v213, v219
    v_lshlrev_b32 v218, 16, v32
    v_and_b32 v219, 0xffff0000, v32
    v_add_f32 v214, v214, v218
    v_add_f32 v215, v215, v219
    v_lshlrev_b32 v218, 16, v33
    v_and_b32 v219, 0xffff0000, v33
    v_add_f32 v214, v214, v218
    v_add_f32 v215, v215, v219
    v_lshlrev_b32 v218, 16, v34
    v_and_b32 v219, 0xffff0000, v34
    v_add_f32 v214, v214, v218
    v_add_f32 v215, v215, v219
    v_lshlrev_b32 v218, 16, v35
    v_and_b32 v219, 0xffff0000, v35
    v_add_f32 v214, v214, v218
    v_add_f32 v215, v215, v219
K1_CS_11:
    s_add_u32 m0, s33, 16384
    s_nop 0
    buffer_load_dwordx4 v8, s[16:19], s30 offen offset:0 lds
    buffer_load_dwordx4 v9, s[16:19], s30 offen offset:1024 lds
    s_add_u32 s30, s30, s31
    s_waitcnt vmcnt(6) lgkmcnt(0)
    s_barrier
    ds_read_b128 v[20:23], v10 offset:0
    ds_read_b128 v[24:27], v200 offset:0
    ds_read_b64_tr_b16 v[28:29], v18 offset:0
    ds_read_b64_tr_b16 v[30:31], v18 offset:512
    ds_read_b64_tr_b16 v[32:33], v19 offset:0
    ds_read_b64_tr_b16 v[34:35], v19 offset:512
    v_mfma_f32_32x32x16_bf16 v[64:79], v[36:39], v[44:47], v[64:79]
    v_mfma_f32_32x32x16_bf16 v[80:95], v[36:39], v[48:51], v[80:95]
    v_mfma_f32_32x32x16_bf16 v[96:111], v[40:43], v[44:47], v[96:111]
    v_mfma_f32_32x32x16_bf16 v[112:127], v[40:43], v[48:51], v[112:127]
    s_cmp_lg_u32 s36, 3
    s_cbranch_scc1 K1_CS_12
    v_lshlrev_b32 v218, 16, v44
    v_and_b32 v219, 0xffff0000, v44
    v_add_f32 v212, v212, v218
    v_add_f32 v213, v213, v219
    v_lshlrev_b32 v218, 16, v45
    v_and_b32 v219, 0xffff0000, v45
    v_add_f32 v212, v212, v218
    v_add_f32 v213, v213, v219
    v_lshlrev_b32 v218, 16, v46
    v_and_b32 v219, 0xffff0000, v46
    v_add_f32 v212, v212, v218
    v_add_f32 v213, v213, v219
    v_lshlrev_b32 v218, 16, v47
    v_and_b32 v219, 0xffff0000, v47
    v_add_f32 v212, v212, v218
    v_add_f32 v213, v213, v219
    v_lshlrev_b32 v218, 16, v48
    v_and_b32 v219, 0xffff0000, v48
    v_add_f32 v214, v214, v218
    v_add_f32 v215, v215, v219
    v_lshlrev_b32 v218, 16, v49
    v_and_b32 v219, 0xffff0000, v49
    v_add_f32 v214, v214, v218
    v_add_f32 v215, v215, v219
    v_lshlrev_b32 v218, 16, v50
    v_and_b32 v219, 0xffff0000, v50
    v_add_f32 v214, v214, v218
    v_add_f32 v215, v215, v219
    v_lshlrev_b32 v218, 16, v51
    v_and_b32 v219, 0xffff0000, v51
    v_add_f32 v214, v214, v218
    v_add_f32 v215, v215, v219
K1_CS_12:
    ds_read_b128 v[36:39], v11 offset:0
    ds_read_b128 v[40:43], v201 offset:0
    ds_read_b64_tr_b16 v[44:45], v18 offset:2048
    ds_read_b64_tr_b16 v[46:47], v18 offset:2560
    ds_read_b64_tr_b16 v[48:49], v19 offset:2048
    ds_read_b64_tr_b16 v[50:51], v19 offset:2560
    s_waitcnt lgkmcnt(6)
    v_mfma_f32_32x32x16_bf16 v[64:79], v[20:23], v[28:31], v[64:79]
    v_mfma_f32_32x32x16_bf16 v[80:95], v[20:23], v[32:35], v[80:95]
    v_mfma_f32_32x32x16_bf16 v[96:111], v[24:27], v[28:31], v[96:111]
    v_mfma_f32_32x32x16_bf16 v[112:127], v[24:27], v[32:35], v[112:127]
    s_cmp_lg_u32 s36, 0
    s_cbranch_scc1 K1_CS_13
    v_lshlrev_b32 v218, 16, v28
    v_and_b32 v219, 0xffff0000, v28
    v_add_f32 v212, v212, v218
    v_add_f32 v213, v213, v219
    v_lshlrev_b32 v218, 16, v29
    v_and_b32 v219, 0xffff0000, v29
    v_add_f32 v212, v212, v218
    v_add_f32 v213, v213, v219
    v_lshlrev_b32 v218, 16, v30
    v_and_b32 v219, 0xffff0000, v30
    v_add_f32 v212, v212, v218
    v_add_f32 v213, v213, v219
    v_lshlrev_b32 v218, 16, v31
    v_and_b32 v219, 0xffff0000, v31
    v_add_f32 v212, v212, v218
    v_add_f32 v213, v213, v219
    v_lshlrev_b32 v218, 16, v32
    v_and_b32 v219, 0xffff0000, v32
    v_add_f32 v214, v214, v218
    v_add_f32 v215, v215, v219
    v_lshlrev_b32 v218, 16, v33
    v_and_b32 v219, 0xffff0000, v33
    v_add_f32 v214, v214, v218
    v_add_f32 v215, v215, v219
    v_lshlrev_b32 v218, 16, v34
    v_and_b32 v219, 0xffff0000, v34
    v_add_f32 v214, v214, v218
    v_add_f32 v215, v215, v219
    v_lshlrev_b32 v218, 16, v35
    v_and_b32 v219, 0xffff0000, v35
    v_add_f32 v214, v214, v218
    v_add_f32 v215, v215, v219
K1_CS_13:
    s_add_u32 m0, s32, 65536
    s_nop 0
    buffer_load_dwordx4 v4, s[12:15], s29 offen offset:0 lds
    buffer_load_dwordx4 v5, s[12:15], s29 offen offset:1024 lds
    ds_read_b128 v[20:23], v12 offset:0
    ds_read_b128 v[24:27], v202 offset:0
    ds_read_b64_tr_b16 v[28:29], v18 offset:4096
    ds_read_b64_tr_b16 v[30:31], v18 offset:4608
    ds_read_b64_tr_b16 v[32:33], v19 offset:4096
    ds_read_b64_tr_b16 v[34:35], v19 offset:4608
    s_waitcnt lgkmcnt(6)
    v_mfma_f32_32x32x16_bf16 v[64:79], v[36:39], v[44:47], v[64:79]
    v_mfma_f32_32x32x16_bf16 v[80:95], v[36:39], v[48:51], v[80:95]
    v_mfma_f32_32x32x16_bf16 v[96:111], v[40:43], v[44:47], v[96:111]
    v_mfma_f32_32x32x16_bf16 v[112:127], v[40:43], v[48:51], v[112:127]
    s_cmp_lg_u32 s36, 1
    s_cbranch_scc1 K1_CS_14
    v_lshlrev_b32 v218, 16, v44
    v_and_b32 v219, 0xffff0000, v44
    v_add_f32 v212, v212, v218
    v_add_f32 v213, v213, v219
    v_lshlrev_b32 v218, 16, v45
    v_and_b32 v219, 0xffff0000, v45
    v_add_f32 v212, v212, v218
    v_add_f32 v213, v213, v219
    v_lshlrev_b32 v218, 16, v46
    v_and_b32 v219, 0xffff0000, v46
    v_add_f32 v212, v212, v218
    v_add_f32 v213, v213, v219
    v_lshlrev_b32 v218, 16, v47
    v_and_b32 v219, 0xffff0000, v47
    v_add_f32 v212, v212, v218
    v_add_f32 v213, v213, v219
    v_lshlrev_b32 v218, 16, v48
    v_and_b32 v219, 0xffff0000, v48
    v_add_f32 v214, v214, v218
    v_add_f32 v215, v215, v219
    v_lshlrev_b32 v218, 16, v49
    v_and_b32 v219, 0xffff0000, v49
    v_add_f32 v214, v214, v218
    v_add_f32 v215, v215, v219
    v_lshlrev_b32 v218, 16, v50
    v_and_b32 v219, 0xffff0000, v50
    v_add_f32 v214, v214, v218
    v_add_f32 v215, v215, v219
    v_lshlrev_b32 v218, 16, v51
    v_and_b32 v219, 0xffff0000, v51
    v_add_f32 v214, v214, v218
    v_add_f32 v215, v215, v219
K1_CS_14:
    s_add_u32 m0, s32, 65536
    s_nop 0
    buffer_load_dwordx4 v6, s[12:15], s29 offen offset:2048 lds
    buffer_load_dwordx4 v7, s[12:15], s29 offen offset:3072 lds
    s_add_u32 s29, s29, 128
    ds_read_b128 v[36:39], v13 offset:0
    ds_read_b128 v[40:43], v203 offset:0
    ds_read_b64_tr_b16 v[44:45], v18 offset:6144
    ds_read_b64_tr_b16 v[46:47], v18 offset:6656
    ds_read_b64_tr_b16 v[48:49], v19 offset:6144
    ds_read_b64_tr_b16 v[50:51], v19 offset:6656
    s_waitcnt lgkmcnt(6)
    v_mfma_f32_32x32x16_bf16 v[64:79], v[20:23], v[28:31], v[64:79]
    v_mfma_f32_32x32x16_bf16 v[80:95], v[20:23], v[32:35], v[80:95]
    v_mfma_f32_32x32x16_bf16 v[96:111], v[24:27], v[28:31], v[96:111]
    v_mfma_f32_32x32x16_bf16 v[112:127], v[24:27], v[32:35], v[112:127]
    s_cmp_lg_u32 s36, 2
    s_cbranch_scc1 K1_CS_15
    v_lshlrev_b32 v218, 16, v28
    v_and_b32 v219, 0xffff0000, v28
    v_add_f32 v212, v212, v218
    v_add_f32 v213, v213, v219
    v_lshlrev_b32 v218, 16, v29
    v_and_b32 v219, 0xffff0000, v29
    v_add_f32 v212, v212, v218
    v_add_f32 v213, v213, v219
    v_lshlrev_b32 v218, 16, v30
    v_and_b32 v219, 0xffff0000, v30
    v_add_f32 v212, v212, v218
    v_add_f32 v213, v213, v219
    v_lshlrev_b32 v218, 16, v31
    v_and_b32 v219, 0xffff0000, v31
    v_add_f32 v212, v212, v218
    v_add_f32 v213, v213, v219
    v_lshlrev_b32 v218, 16, v32
    v_and_b32 v219, 0xffff0000, v32
    v_add_f32 v214, v214, v218
    v_add_f32 v215, v215, v219
    v_lshlrev_b32 v218, 16, v33
    v_and_b32 v219, 0xffff0000, v33
    v_add_f32 v214, v214, v218
    v_add_f32 v215, v215, v219
    v_lshlrev_b32 v218, 16, v34
    v_and_b32 v219, 0xffff0000, v34
    v_add_f32 v214, v214, v218
    v_add_f32 v215, v215, v219
    v_lshlrev_b32 v218, 16, v35
    v_and_b32 v219, 0xffff0000, v35
    v_add_f32 v214, v214, v218
    v_add_f32 v215, v215, v219
K1_CS_15:
    s_add_u32 m0, s33, 32768
    s_nop 0
    buffer_load_dwordx4 v8, s[16:19], s30 offen offset:0 lds
    buffer_load_dwordx4 v9, s[16:19], s30 offen offset:1024 lds
    s_add_u32 s30, s30, s31
    s_waitcnt vmcnt(6) lgkmcnt(0)
    s_barrier
    ds_read_b128 v[20:23], v10 offset:32768
    ds_read_b128 v[24:27], v200 offset:32768
    ds_read_b64_tr_b16 v[28:29], v18 offset:16384
    ds_read_b64_tr_b16 v[30:31], v18 offset:16896
    ds_read_b64_tr_b16 v[32:33], v19 offset:16384
    ds_read_b64_tr_b16 v[34:35], v19 offset:16896
    v_mfma_f32_32x32x16_bf16 v[64:79], v[36:39], v[44:47], v[64:79]
    v_mfma_f32_32x32x16_bf16 v[80:95], v[36:39], v[48:51], v[80:95]
    v_mfma_f32_32x32x16_bf16 v[96:111], v[40:43], v[44:47], v[96:111]
    v_mfma_f32_32x32x16_bf16 v[112:127], v[40:43], v[48:51], v[112:127]
    s_cmp_lg_u32 s36, 3
    s_cbranch_scc1 K1_CS_16
    v_lshlrev_b32 v218, 16, v44
    v_and_b32 v219, 0xffff0000, v44
    v_add_f32 v212, v212, v218
    v_add_f32 v213, v213, v219
    v_lshlrev_b32 v218, 16, v45
    v_and_b32 v219, 0xffff0000, v45
    v_add_f32 v212, v212, v218
    v_add_f32 v213, v213, v219
    v_lshlrev_b32 v218, 16, v46
    v_and_b32 v219, 0xffff0000, v46
    v_add_f32 v212, v212, v218
    v_add_f32 v213, v213, v219
    v_lshlrev_b32 v218, 16, v47
    v_and_b32 v219, 0xffff0000, v47
    v_add_f32 v212, v212, v218
    v_add_f32 v213, v213, v219
    v_lshlrev_b32 v218, 16, v48
    v_and_b32 v219, 0xffff0000, v48
    v_add_f32 v214, v214, v218
    v_add_f32 v215, v215, v219
    v_lshlrev_b32 v218, 16, v49
    v_and_b32 v219, 0xffff0000, v49
    v_add_f32 v214, v214, v218
    v_add_f32 v215, v215, v219
    v_lshlrev_b32 v218, 16, v50
    v_and_b32 v219, 0xffff0000, v50
    v_add_f32 v214, v214, v218
    v_add_f32 v215, v215, v219
    v_lshlrev_b32 v218, 16, v51
    v_and_b32 v219, 0xffff0000, v51
    v_add_f32 v214, v214, v218
    v_add_f32 v215, v215, v219
K1_CS_16:
    ds_read_b128 v[36:39], v11 offset:32768
    ds_read_b128 v[40:43], v201 offset:32768
    ds_read_b64_tr_b16 v[44:45], v18 offset:18432
    ds_read_b64_tr_b16 v[46:47], v18 offset:18944
    ds_read_b64_tr_b16 v[48:49], v19 offset:18432
    ds_read_b64_tr_b16 v[50:51], v19 offset:18944
    s_waitcnt lgkmcnt(6)
    v_mfma_f32_32x32x16_bf16 v[64:79], v[20:23], v[28:31], v[64:79]
    v_mfma_f32_32x32x16_bf16 v[80:95], v[20:23], v[32:35], v[80:95]
    v_mfma_f32_32x32x16_bf16 v[96:111], v[24:27], v[28:31], v[96:111]
    v_mfma_f32_32x32x16_bf16 v[112:127], v[24:27], v[32:35], v[112:127]
    s_cmp_lg_u32 s36, 0
    s_cbranch_scc1 K1_CS_17
    v_lshlrev_b32 v218, 16, v28
    v_and_b32 v219, 0xffff0000, v28
    v_add_f32 v212, v212, v218
    v_add_f32 v213, v213, v219
    v_lshlrev_b32 v218, 16, v29
    v_and_b32 v219, 0xffff0000, v29
    v_add_f32 v212, v212, v218
    v_add_f32 v213, v213, v219
    v_lshlrev_b32 v218, 16, v30
    v_and_b32 v219, 0xffff0000, v30
    v_add_f32 v212, v212, v218
    v_add_f32 v213, v213, v219
    v_lshlrev_b32 v218, 16, v31
    v_and_b32 v219, 0xffff0000, v31
    v_add_f32 v212, v212, v218
    v_add_f32 v213, v213, v219
    v_lshlrev_b32 v218, 16, v32
    v_and_b32 v219, 0xffff0000, v32
    v_add_f32 v214, v214, v218
    v_add_f32 v215, v215, v219
    v_lshlrev_b32 v218, 16, v33
    v_and_b32 v219, 0xffff0000, v33
    v_add_f32 v214, v214, v218
    v_add_f32 v215, v215, v219
    v_lshlrev_b32 v218, 16, v34
    v_and_b32 v219, 0xffff0000, v34
    v_add_f32 v214, v214, v218
    v_add_f32 v215, v215, v219
    v_lshlrev_b32 v218, 16, v35
    v_and_b32 v219, 0xffff0000, v35
    v_add_f32 v214, v214, v218
    v_add_f32 v215, v215, v219
K1_CS_17:
    s_add_u32 m0, s32, 0
    s_nop 0
    buffer_load_dwordx4 v4, s[12:15], s29 offen offset:0 lds
    buffer_load_dwordx4 v5, s[12:15], s29 offen offset:1024 lds
    ds_read_b128 v[20:23], v12 offset:32768
    ds_read_b128 v[24:27], v202 offset:32768
    ds_read_b64_tr_b16 v[28:29], v18 offset:20480
    ds_read_b64_tr_b16 v[30:31], v18 offset:20992
    ds_read_b64_tr_b16 v[32:33], v19 offset:20480
    ds_read_b64_tr_b16 v[34:35], v19 offset:20992
    s_waitcnt lgkmcnt(6)
    v_mfma_f32_32x32x16_bf16 v[64:79], v[36:39], v[44:47], v[64:79]
    v_mfma_f32_32x32x16_bf16 v[80:95], v[36:39], v[48:51], v[80:95]
    v_mfma_f32_32x32x16_bf16 v[96:111], v[40:43], v[44:47], v[96:111]
    v_mfma_f32_32x32x16_bf16 v[112:127], v[40:43], v[48:51], v[112:127]
    s_cmp_lg_u32 s36, 1
    s_cbranch_scc1 K1_CS_18
    v_lshlrev_b32 v218, 16, v44
    v_and_b32 v219, 0xffff0000, v44
    v_add_f32 v212, v212, v218
    v_add_f32 v213, v213, v219
    v_lshlrev_b32 v218, 16, v45
    v_and_b32 v219, 0xffff0000, v45
    v_add_f32 v212, v212, v218
    v_add_f32 v213, v213, v219
    v_lshlrev_b32 v218, 16, v46
    v_and_b32 v219, 0xffff0000, v46
    v_add_f32 v212, v212, v218
    v_add_f32 v213, v213, v219
    v_lshlrev_b32 v218, 16, v47
    v_and_b32 v219, 0xffff0000, v47
    v_add_f32 v212, v212, v218
    v_add_f32 v213, v213, v219
    v_lshlrev_b32 v218, 16, v48
    v_and_b32 v219, 0xffff0000, v48
    v_add_f32 v214, v214, v218
    v_add_f32 v215, v215, v219
    v_lshlrev_b32 v218, 16, v49
    v_and_b32 v219, 0xffff0000, v49
    v_add_f32 v214, v214, v218
    v_add_f32 v215, v215, v219
    v_lshlrev_b32 v218, 16, v50
    v_and_b32 v219, 0xffff0000, v50
    v_add_f32 v214, v214, v218
    v_add_f32 v215, v215, v219
    v_lshlrev_b32 v218, 16, v51
    v_and_b32 v219, 0xffff0000, v51
    v_add_f32 v214, v214, v218
    v_add_f32 v215, v215, v219
K1_CS_18:
    s_add_u32 m0, s32, 0
    s_nop 0
    buffer_load_dwordx4 v6, s[12:15], s29 offen offset:2048 lds
    buffer_load_dwordx4 v7, s[12:15], s29 offen offset:3072 lds
    s_add_u32 s29, s29, 128
    ds_read_b128 v[36:39], v13 offset:32768
    ds_read_b128 v[40:43], v203 offset:32768
    ds_read_b64_tr_b16 v[44:45], v18 offset:22528
    ds_read_b64_tr_b16 v[46:47], v18 offset:23040
    ds_read_b64_tr_b16 v[48:49], v19 offset:22528
    ds_read_b64_tr_b16 v[50:51], v19 offset:23040
    s_waitcnt lgkmcnt(6)
    v_mfma_f32_32x32x16_bf16 v[64:79], v[20:23], v[28:31], v[64:79]
    v_mfma_f32_32x32x16_bf16 v[80:95], v[20:23], v[32:35], v[80:95]
    v_mfma_f32_32x32x16_bf16 v[96:111], v[24:27], v[28:31], v[96:111]
    v_mfma_f32_32x32x16_bf16 v[112:127], v[24:27], v[32:35], v[112:127]
    s_cmp_lg_u32 s36, 2
    s_cbranch_scc1 K1_CS_19
    v_lshlrev_b32 v218, 16, v28
    v_and_b32 v219, 0xffff0000, v28
    v_add_f32 v212, v212, v218
    v_add_f32 v213, v213, v219
    v_lshlrev_b32 v218, 16, v29
    v_and_b32 v219, 0xffff0000, v29
    v_add_f32 v212, v212, v218
    v_add_f32 v213, v213, v219
    v_lshlrev_b32 v218, 16, v30
    v_and_b32 v219, 0xffff0000, v30
    v_add_f32 v212, v212, v218
    v_add_f32 v213, v213, v219
    v_lshlrev_b32 v218, 16, v31
    v_and_b32 v219, 0xffff0000, v31
    v_add_f32 v212, v212, v218
    v_add_f32 v213, v213, v219
    v_lshlrev_b32 v218, 16, v32
    v_and_b32 v219, 0xffff0000, v32
    v_add_f32 v214, v214, v218
    v_add_f32 v215, v215, v219
    v_lshlrev_b32 v218, 16, v33
    v_and_b32 v219, 0xffff0000, v33
    v_add_f32 v214, v214, v218
    v_add_f32 v215, v215, v219
    v_lshlrev_b32 v218, 16, v34
    v_and_b32 v219, 0xffff0000, v34
    v_add_f32 v214, v214, v218
    v_add_f32 v215, v215, v219
    v_lshlrev_b32 v218, 16, v35
    v_and_b32 v219, 0xffff0000, v35
    v_add_f32 v214, v214, v218
    v_add_f32 v215, v215, v219
K1_CS_19:
    s_add_u32 m0, s33, 0
    s_nop 0
    buffer_load_dwordx4 v8, s[16:19], s30 offen offset:0 lds
    buffer_load_dwordx4 v9, s[16:19], s30 offen offset:1024 lds
    s_add_u32 s30, s30, s31
    s_waitcnt vmcnt(6) lgkmcnt(0)
    s_barrier
    ds_read_b128 v[20:23], v14 offset:0
    ds_read_b128 v[24:27], v204 offset:0
    ds_read_b64_tr_b16 v[28:29], v18 offset:32768
    ds_read_b64_tr_b16 v[30:31], v18 offset:33280
    ds_read_b64_tr_b16 v[32:33], v19 offset:32768
    ds_read_b64_tr_b16 v[34:35], v19 offset:33280
    v_mfma_f32_32x32x16_bf16 v[64:79], v[36:39], v[44:47], v[64:79]
    v_mfma_f32_32x32x16_bf16 v[80:95], v[36:39], v[48:51], v[80:95]
    v_mfma_f32_32x32x16_bf16 v[96:111], v[40:43], v[44:47], v[96:111]
    v_mfma_f32_32x32x16_bf16 v[112:127], v[40:43], v[48:51], v[112:127]
    s_cmp_lg_u32 s36, 3
    s_cbranch_scc1 K1_CS_20
    v_lshlrev_b32 v218, 16, v44
    v_and_b32 v219, 0xffff0000, v44
    v_add_f32 v212, v212, v218
    v_add_f32 v213, v213, v219
    v_lshlrev_b32 v218, 16, v45
    v_and_b32 v219, 0xffff0000, v45
    v_add_f32 v212, v212, v218
    v_add_f32 v213, v213, v219
    v_lshlrev_b32 v218, 16, v46
    v_and_b32 v219, 0xffff0000, v46
    v_add_f32 v212, v212, v218
    v_add_f32 v213, v213, v219
    v_lshlrev_b32 v218, 16, v47
    v_and_b32 v219, 0xffff0000, v47
    v_add_f32 v212, v212, v218
    v_add_f32 v213, v213, v219
    v_lshlrev_b32 v218, 16, v48
    v_and_b32 v219, 0xffff0000, v48
    v_add_f32 v214, v214, v218
    v_add_f32 v215, v215, v219
    v_lshlrev_b32 v218, 16, v49
    v_and_b32 v219, 0xffff0000, v49
    v_add_f32 v214, v214, v218
    v_add_f32 v215, v215, v219
    v_lshlrev_b32 v218, 16, v50
    v_and_b32 v219, 0xffff0000, v50
    v_add_f32 v214, v214, v218
    v_add_f32 v215, v215, v219
    v_lshlrev_b32 v218, 16, v51
    v_and_b32 v219, 0xffff0000, v51
    v_add_f32 v214, v214, v218
    v_add_f32 v215, v215, v219
K1_CS_20:
    ds_read_b128 v[36:39], v15 offset:0
    ds_read_b128 v[40:43], v205 offset:0
    ds_read_b64_tr_b16 v[44:45], v18 offset:34816
    ds_read_b64_tr_b16 v[46:47], v18 offset:35328
    ds_read_b64_tr_b16 v[48:49], v19 offset:34816
    ds_read_b64_tr_b16 v[50:51], v19 offset:35328
    s_waitcnt lgkmcnt(6)
    v_mfma_f32_32x32x16_bf16 v[64:79], v[20:23], v[28:31], v[64:79]
    v_mfma_f32_32x32x16_bf16 v[80:95], v[20:23], v[32:35], v[80:95]
    v_mfma_f32_32x32x16_bf16 v[96:111], v[24:27], v[28:31], v[96:111]
    v_mfma_f32_32x32x16_bf16 v[112:127], v[24:27], v[32:35], v[112:127]
    s_cmp_lg_u32 s36, 0
    s_cbranch_scc1 K1_CS_21
    v_lshlrev_b32 v218, 16, v28
    v_and_b32 v219, 0xffff0000, v28
    v_add_f32 v212, v212, v218
    v_add_f32 v213, v213, v219
    v_lshlrev_b32 v218, 16, v29
    v_and_b32 v219, 0xffff0000, v29
    v_add_f32 v212, v212, v218
    v_add_f32 v213, v213, v219
    v_lshlrev_b32 v218, 16, v30
    v_and_b32 v219, 0xffff0000, v30
    v_add_f32 v212, v212, v218
    v_add_f32 v213, v213, v219
    v_lshlrev_b32 v218, 16, v31
    v_and_b32 v219, 0xffff0000, v31
    v_add_f32 v212, v212, v218
    v_add_f32 v213, v213, v219
    v_lshlrev_b32 v218, 16, v32
    v_and_b32 v219, 0xffff0000, v32
    v_add_f32 v214, v214, v218
    v_add_f32 v215, v215, v219
    v_lshlrev_b32 v218, 16, v33
    v_and_b32 v219, 0xffff0000, v33
    v_add_f32 v214, v214, v218
    v_add_f32 v215, v215, v219
    v_lshlrev_b32 v218, 16, v34
    v_and_b32 v219, 0xffff0000, v34
    v_add_f32 v214, v214, v218
    v_add_f32 v215, v215, v219
    v_lshlrev_b32 v218, 16, v35
    v_and_b32 v219, 0xffff0000, v35
    v_add_f32 v214, v214, v218
    v_add_f32 v215, v215, v219
K1_CS_21:
    s_add_u32 m0, s32, 32768
    s_nop 0
    buffer_load_dwordx4 v4, s[12:15], s29 offen offset:0 lds
    buffer_load_dwordx4 v5, s[12:15], s29 offen offset:1024 lds
    ds_read_b128 v[20:23], v16 offset:0
    ds_read_b128 v[24:27], v206 offset:0
    ds_read_b64_tr_b16 v[28:29], v18 offset:36864
    ds_read_b64_tr_b16 v[30:31], v18 offset:37376
    ds_read_b64_tr_b16 v[32:33], v19 offset:36864
    ds_read_b64_tr_b16 v[34:35], v19 offset:37376
    s_waitcnt lgkmcnt(6)
    v_mfma_f32_32x32x16_bf16 v[64:79], v[36:39], v[44:47], v[64:79]
    v_mfma_f32_32x32x16_bf16 v[80:95], v[36:39], v[48:51], v[80:95]
    v_mfma_f32_32x32x16_bf16 v[96:111], v[40:43], v[44:47], v[96:111]
    v_mfma_f32_32x32x16_bf16 v[112:127], v[40:43], v[48:51], v[112:127]
    s_cmp_lg_u32 s36, 1
    s_cbranch_scc1 K1_CS_22
    v_lshlrev_b32 v218, 16, v44
    v_and_b32 v219, 0xffff0000, v44
    v_add_f32 v212, v212, v218
    v_add_f32 v213, v213, v219
    v_lshlrev_b32 v218, 16, v45
    v_and_b32 v219, 0xffff0000, v45
    v_add_f32 v212, v212, v218
    v_add_f32 v213, v213, v219
    v_lshlrev_b32 v218, 16, v46
    v_and_b32 v219, 0xffff0000, v46
    v_add_f32 v212, v212, v218
    v_add_f32 v213, v213, v219
    v_lshlrev_b32 v218, 16, v47
    v_and_b32 v219, 0xffff0000, v47
    v_add_f32 v212, v212, v218
    v_add_f32 v213, v213, v219
    v_lshlrev_b32 v218, 16, v48
    v_and_b32 v219, 0xffff0000, v48
    v_add_f32 v214, v214, v218
    v_add_f32 v215, v215, v219
    v_lshlrev_b32 v218, 16, v49
    v_and_b32 v219, 0xffff0000, v49
    v_add_f32 v214, v214, v218
    v_add_f32 v215, v215, v219
    v_lshlrev_b32 v218, 16, v50
    v_and_b32 v219, 0xffff0000, v50
    v_add_f32 v214, v214, v218
    v_add_f32 v215, v215, v219
    v_lshlrev_b32 v218, 16, v51
    v_and_b32 v219, 0xffff0000, v51
    v_add_f32 v214, v214, v218
    v_add_f32 v215, v215, v219
K1_CS_22:
    s_add_u32 m0, s32, 32768
    s_nop 0
    buffer_load_dwordx4 v6, s[12:15], s29 offen offset:2048 lds
    buffer_load_dwordx4 v7, s[12:15], s29 offen offset:3072 lds
    s_add_u32 s29, s29, 128
    ds_read_b128 v[36:39], v17 offset:0
    ds_read_b128 v[40:43], v207 offset:0
    ds_read_b64_tr_b16 v[44:45], v18 offset:38912
    ds_read_b64_tr_b16 v[46:47], v18 offset:39424
    ds_read_b64_tr_b16 v[48:49], v19 offset:38912
    ds_read_b64_tr_b16 v[50:51], v19 offset:39424
    s_waitcnt lgkmcnt(6)
    v_mfma_f32_32x32x16_bf16 v[64:79], v[20:23], v[28:31], v[64:79]
    v_mfma_f32_32x32x16_bf16 v[80:95], v[20:23], v[32:35], v[80:95]
    v_mfma_f32_32x32x16_bf16 v[96:111], v[24:27], v[28:31], v[96:111]
    v_mfma_f32_32x32x16_bf16 v[112:127], v[24:27], v[32:35], v[112:127]
    s_cmp_lg_u32 s36, 2
    s_cbranch_scc1 K1_CS_23
    v_lshlrev_b32 v218, 16, v28
    v_and_b32 v219, 0xffff0000, v28
    v_add_f32 v212, v212, v218
    v_add_f32 v213, v213, v219
    v_lshlrev_b32 v218, 16, v29
    v_and_b32 v219, 0xffff0000, v29
    v_add_f32 v212, v212, v218
    v_add_f32 v213, v213, v219
    v_lshlrev_b32 v218, 16, v30
    v_and_b32 v219, 0xffff0000, v30
    v_add_f32 v212, v212, v218
    v_add_f32 v213, v213, v219
    v_lshlrev_b32 v218, 16, v31
    v_and_b32 v219, 0xffff0000, v31
    v_add_f32 v212, v212, v218
    v_add_f32 v213, v213, v219
    v_lshlrev_b32 v218, 16, v32
    v_and_b32 v219, 0xffff0000, v32
    v_add_f32 v214, v214, v218
    v_add_f32 v215, v215, v219
    v_lshlrev_b32 v218, 16, v33
    v_and_b32 v219, 0xffff0000, v33
    v_add_f32 v214, v214, v218
    v_add_f32 v215, v215, v219
    v_lshlrev_b32 v218, 16, v34
    v_and_b32 v219, 0xffff0000, v34
    v_add_f32 v214, v214, v218
    v_add_f32 v215, v215, v219
    v_lshlrev_b32 v218, 16, v35
    v_and_b32 v219, 0xffff0000, v35
    v_add_f32 v214, v214, v218
    v_add_f32 v215, v215, v219
K1_CS_23:
    s_add_u32 m0, s33, 16384
    s_nop 0
    buffer_load_dwordx4 v8, s[16:19], s30 offen offset:0 lds
    buffer_load_dwordx4 v9, s[16:19], s30 offen offset:1024 lds
    s_add_u32 s30, s30, s31
    s_waitcnt vmcnt(6) lgkmcnt(0)
    s_barrier
    ds_read_b128 v[20:23], v10 offset:0
    ds_read_b128 v[24:27], v200 offset:0
    ds_read_b64_tr_b16 v[28:29], v18 offset:0
    ds_read_b64_tr_b16 v[30:31], v18 offset:512
    ds_read_b64_tr_b16 v[32:33], v19 offset:0
    ds_read_b64_tr_b16 v[34:35], v19 offset:512
    v_mfma_f32_32x32x16_bf16 v[64:79], v[36:39], v[44:47], v[64:79]
    v_mfma_f32_32x32x16_bf16 v[80:95], v[36:39], v[48:51], v[80:95]
    v_mfma_f32_32x32x16_bf16 v[96:111], v[40:43], v[44:47], v[96:111]
    v_mfma_f32_32x32x16_bf16 v[112:127], v[40:43], v[48:51], v[112:127]
    s_cmp_lg_u32 s36, 3
    s_cbranch_scc1 K1_CS_24
    v_lshlrev_b32 v218, 16, v44
    v_and_b32 v219, 0xffff0000, v44
    v_add_f32 v212, v212, v218
    v_add_f32 v213, v213, v219
    v_lshlrev_b32 v218, 16, v45
    v_and_b32 v219, 0xffff0000, v45
    v_add_f32 v212, v212, v218
    v_add_f32 v213, v213, v219
    v_lshlrev_b32 v218, 16, v46
    v_and_b32 v219, 0xffff0000, v46
    v_add_f32 v212, v212, v218
    v_add_f32 v213, v213, v219
    v_lshlrev_b32 v218, 16, v47
    v_and_b32 v219, 0xffff0000, v47
    v_add_f32 v212, v212, v218
    v_add_f32 v213, v213, v219
    v_lshlrev_b32 v218, 16, v48
    v_and_b32 v219, 0xffff0000, v48
    v_add_f32 v214, v214, v218
    v_add_f32 v215, v215, v219
    v_lshlrev_b32 v218, 16, v49
    v_and_b32 v219, 0xffff0000, v49
    v_add_f32 v214, v214, v218
    v_add_f32 v215, v215, v219
    v_lshlrev_b32 v218, 16, v50
    v_and_b32 v219, 0xffff0000, v50
    v_add_f32 v214, v214, v218
    v_add_f32 v215, v215, v219
    v_lshlrev_b32 v218, 16, v51
    v_and_b32 v219, 0xffff0000, v51
    v_add_f32 v214, v214, v218
    v_add_f32 v215, v215, v219
K1_CS_24:
    ds_read_b128 v[36:39], v11 offset:0
    ds_read_b128 v[40:43], v201 offset:0
    ds_read_b64_tr_b16 v[44:45], v18 offset:2048
    ds_read_b64_tr_b16 v[46:47], v18 offset:2560
    ds_read_b64_tr_b16 v[48:49], v19 offset:2048
    ds_read_b64_tr_b16 v[50:51], v19 offset:2560
    s_waitcnt lgkmcnt(6)
    v_mfma_f32_32x32x16_bf16 v[64:79], v[20:23], v[28:31], v[64:79]
    v_mfma_f32_32x32x16_bf16 v[80:95], v[20:23], v[32:35], v[80:95]
    v_mfma_f32_32x32x16_bf16 v[96:111], v[24:27], v[28:31], v[96:111]
    v_mfma_f32_32x32x16_bf16 v[112:127], v[24:27], v[32:35], v[112:127]
    s_cmp_lg_u32 s36, 0
    s_cbranch_scc1 K1_CS_25
    v_lshlrev_b32 v218, 16, v28
    v_and_b32 v219, 0xffff0000, v28
    v_add_f32 v212, v212, v218
    v_add_f32 v213, v213, v219
    v_lshlrev_b32 v218, 16, v29
    v_and_b32 v219, 0xffff0000, v29
    v_add_f32 v212, v212, v218
    v_add_f32 v213, v213, v219
    v_lshlrev_b32 v218, 16, v30
    v_and_b32 v219, 0xffff0000, v30
    v_add_f32 v212, v212, v218
    v_add_f32 v213, v213, v219
    v_lshlrev_b32 v218, 16, v31
    v_and_b32 v219, 0xffff0000, v31
    v_add_f32 v212, v212, v218
    v_add_f32 v213, v213, v219
    v_lshlrev_b32 v218, 16, v32
    v_and_b32 v219, 0xffff0000, v32
    v_add_f32 v214, v214, v218
    v_add_f32 v215, v215, v219
    v_lshlrev_b32 v218, 16, v33
    v_and_b32 v219, 0xffff0000, v33
    v_add_f32 v214, v214, v218
    v_add_f32 v215, v215, v219
    v_lshlrev_b32 v218, 16, v34
    v_and_b32 v219, 0xffff0000, v34
    v_add_f32 v214, v214, v218
    v_add_f32 v215, v215, v219
    v_lshlrev_b32 v218, 16, v35
    v_and_b32 v219, 0xffff0000, v35
    v_add_f32 v214, v214, v218
    v_add_f32 v215, v215, v219
K1_CS_25:
    s_add_u32 m0, s32, 65536
    s_nop 0
    buffer_load_dwordx4 v4, s[12:15], s29 offen offset:0 lds
    buffer_load_dwordx4 v5, s[12:15], s29 offen offset:1024 lds
    ds_read_b128 v[20:23], v12 offset:0
    ds_read_b128 v[24:27], v202 offset:0
    ds_read_b64_tr_b16 v[28:29], v18 offset:4096
    ds_read_b64_tr_b16 v[30:31], v18 offset:4608
    ds_read_b64_tr_b16 v[32:33], v19 offset:4096
    ds_read_b64_tr_b16 v[34:35], v19 offset:4608
    s_waitcnt lgkmcnt(6)
    v_mfma_f32_32x32x16_bf16 v[64:79], v[36:39], v[44:47], v[64:79]
    v_mfma_f32_32x32x16_bf16 v[80:95], v[36:39], v[48:51], v[80:95]
    v_mfma_f32_32x32x16_bf16 v[96:111], v[40:43], v[44:47], v[96:111]
    v_mfma_f32_32x32x16_bf16 v[112:127], v[40:43], v[48:51], v[112:127]
    s_cmp_lg_u32 s36, 1
    s_cbranch_scc1 K1_CS_26
    v_lshlrev_b32 v218, 16, v44
    v_and_b32 v219, 0xffff0000, v44
    v_add_f32 v212, v212, v218
    v_add_f32 v213, v213, v219
    v_lshlrev_b32 v218, 16, v45
    v_and_b32 v219, 0xffff0000, v45
    v_add_f32 v212, v212, v218
    v_add_f32 v213, v213, v219
    v_lshlrev_b32 v218, 16, v46
    v_and_b32 v219, 0xffff0000, v46
    v_add_f32 v212, v212, v218
    v_add_f32 v213, v213, v219
    v_lshlrev_b32 v218, 16, v47
    v_and_b32 v219, 0xffff0000, v47
    v_add_f32 v212, v212, v218
    v_add_f32 v213, v213, v219
    v_lshlrev_b32 v218, 16, v48
    v_and_b32 v219, 0xffff0000, v48
    v_add_f32 v214, v214, v218
    v_add_f32 v215, v215, v219
    v_lshlrev_b32 v218, 16, v49
    v_and_b32 v219, 0xffff0000, v49
    v_add_f32 v214, v214, v218
    v_add_f32 v215, v215, v219
    v_lshlrev_b32 v218, 16, v50
    v_and_b32 v219, 0xffff0000, v50
    v_add_f32 v214, v214, v218
    v_add_f32 v215, v215, v219
    v_lshlrev_b32 v218, 16, v51
    v_and_b32 v219, 0xffff0000, v51
    v_add_f32 v214, v214, v218
    v_add_f32 v215, v215, v219
K1_CS_26:
    s_add_u32 m0, s32, 65536
    s_nop 0
    buffer_load_dwordx4 v6, s[12:15], s29 offen offset:2048 lds
    buffer_load_dwordx4 v7, s[12:15], s29 offen offset:3072 lds
    s_add_u32 s29, s29, 128
    ds_read_b128 v[36:39], v13 offset:0
    ds_read_b128 v[40:43], v203 offset:0
    ds_read_b64_tr_b16 v[44:45], v18 offset:6144
    ds_read_b64_tr_b16 v[46:47], v18 offset:6656
    ds_read_b64_tr_b16 v[48:49], v19 offset:6144
    ds_read_b64_tr_b16 v[50:51], v19 offset:6656
    s_waitcnt lgkmcnt(6)
    v_mfma_f32_32x32x16_bf16 v[64:79], v[20:23], v[28:31], v[64:79]
    v_mfma_f32_32x32x16_bf16 v[80:95], v[20:23], v[32:35], v[80:95]
    v_mfma_f32_32x32x16_bf16 v[96:111], v[24:27], v[28:31], v[96:111]
    v_mfma_f32_32x32x16_bf16 v[112:127], v[24:27], v[32:35], v[112:127]
    s_cmp_lg_u32 s36, 2
    s_cbranch_scc1 K1_CS_27
    v_lshlrev_b32 v218, 16, v28
    v_and_b32 v219, 0xffff0000, v28
    v_add_f32 v212, v212, v218
    v_add_f32 v213, v213, v219
    v_lshlrev_b32 v218, 16, v29
    v_and_b32 v219, 0xffff0000, v29
    v_add_f32 v212, v212, v218
    v_add_f32 v213, v213, v219
    v_lshlrev_b32 v218, 16, v30
    v_and_b32 v219, 0xffff0000, v30
    v_add_f32 v212, v212, v218
    v_add_f32 v213, v213, v219
    v_lshlrev_b32 v218, 16, v31
    v_and_b32 v219, 0xffff0000, v31
    v_add_f32 v212, v212, v218
    v_add_f32 v213, v213, v219
    v_lshlrev_b32 v218, 16, v32
    v_and_b32 v219, 0xffff0000, v32
    v_add_f32 v214, v214, v218
    v_add_f32 v215, v215, v219
    v_lshlrev_b32 v218, 16, v33
    v_and_b32 v219, 0xffff0000, v33
    v_add_f32 v214, v214, v218
    v_add_f32 v215, v215, v219
    v_lshlrev_b32 v218, 16, v34
    v_and_b32 v219, 0xffff0000, v34
    v_add_f32 v214, v214, v218
    v_add_f32 v215, v215, v219
    v_lshlrev_b32 v218, 16, v35
    v_and_b32 v219, 0xffff0000, v35
    v_add_f32 v214, v214, v218
    v_add_f32 v215, v215, v219
K1_CS_27:
    s_add_u32 m0, s33, 32768
    s_nop 0
    buffer_load_dwordx4 v8, s[16:19], s30 offen offset:0 lds
    buffer_load_dwordx4 v9, s[16:19], s30 offen offset:1024 lds
    s_add_u32 s30, s30, s31
    s_waitcnt vmcnt(6) lgkmcnt(0)
    s_barrier
    ds_read_b128 v[20:23], v10 offset:32768
    ds_read_b128 v[24:27], v200 offset:32768
    ds_read_b64_tr_b16 v[28:29], v18 offset:16384
    ds_read_b64_tr_b16 v[30:31], v18 offset:16896
    ds_read_b64_tr_b16 v[32:33], v19 offset:16384
    ds_read_b64_tr_b16 v[34:35], v19 offset:16896
    v_mfma_f32_32x32x16_bf16 v[64:79], v[36:39], v[44:47], v[64:79]
    v_mfma_f32_32x32x16_bf16 v[80:95], v[36:39], v[48:51], v[80:95]
    v_mfma_f32_32x32x16_bf16 v[96:111], v[40:43], v[44:47], v[96:111]
    v_mfma_f32_32x32x16_bf16 v[112:127], v[40:43], v[48:51], v[112:127]
    s_cmp_lg_u32 s36, 3
    s_cbranch_scc1 K1_CS_28
    v_lshlrev_b32 v218, 16, v44
    v_and_b32 v219, 0xffff0000, v44
    v_add_f32 v212, v212, v218
    v_add_f32 v213, v213, v219
    v_lshlrev_b32 v218, 16, v45
    v_and_b32 v219, 0xffff0000, v45
    v_add_f32 v212, v212, v218
    v_add_f32 v213, v213, v219
    v_lshlrev_b32 v218, 16, v46
    v_and_b32 v219, 0xffff0000, v46
    v_add_f32 v212, v212, v218
    v_add_f32 v213, v213, v219
    v_lshlrev_b32 v218, 16, v47
    v_and_b32 v219, 0xffff0000, v47
    v_add_f32 v212, v212, v218
    v_add_f32 v213, v213, v219
    v_lshlrev_b32 v218, 16, v48
    v_and_b32 v219, 0xffff0000, v48
    v_add_f32 v214, v214, v218
    v_add_f32 v215, v215, v219
    v_lshlrev_b32 v218, 16, v49
    v_and_b32 v219, 0xffff0000, v49
    v_add_f32 v214, v214, v218
    v_add_f32 v215, v215, v219
    v_lshlrev_b32 v218, 16, v50
    v_and_b32 v219, 0xffff0000, v50
    v_add_f32 v214, v214, v218
    v_add_f32 v215, v215, v219
    v_lshlrev_b32 v218, 16, v51
    v_and_b32 v219, 0xffff0000, v51
    v_add_f32 v214, v214, v218
    v_add_f32 v215, v215, v219
K1_CS_28:
    ds_read_b128 v[36:39], v11 offset:32768
    ds_read_b128 v[40:43], v201 offset:32768
    ds_read_b64_tr_b16 v[44:45], v18 offset:18432
    ds_read_b64_tr_b16 v[46:47], v18 offset:18944
    ds_read_b64_tr_b16 v[48:49], v19 offset:18432
    ds_read_b64_tr_b16 v[50:51], v19 offset:18944
    s_waitcnt lgkmcnt(6)
    v_mfma_f32_32x32x16_bf16 v[64:79], v[20:23], v[28:31], v[64:79]
    v_mfma_f32_32x32x16_bf16 v[80:95], v[20:23], v[32:35], v[80:95]
    v_mfma_f32_32x32x16_bf16 v[96:111], v[24:27], v[28:31], v[96:111]
    v_mfma_f32_32x32x16_bf16 v[112:127], v[24:27], v[32:35], v[112:127]
    s_cmp_lg_u32 s36, 0
    s_cbranch_scc1 K1_CS_29
    v_lshlrev_b32 v218, 16, v28
    v_and_b32 v219, 0xffff0000, v28
    v_add_f32 v212, v212, v218
    v_add_f32 v213, v213, v219
    v_lshlrev_b32 v218, 16, v29
    v_and_b32 v219, 0xffff0000, v29
    v_add_f32 v212, v212, v218
    v_add_f32 v213, v213, v219
    v_lshlrev_b32 v218, 16, v30
    v_and_b32 v219, 0xffff0000, v30
    v_add_f32 v212, v212, v218
    v_add_f32 v213, v213, v219
    v_lshlrev_b32 v218, 16, v31
    v_and_b32 v219, 0xffff0000, v31
    v_add_f32 v212, v212, v218
    v_add_f32 v213, v213, v219
    v_lshlrev_b32 v218, 16, v32
    v_and_b32 v219, 0xffff0000, v32
    v_add_f32 v214, v214, v218
    v_add_f32 v215, v215, v219
    v_lshlrev_b32 v218, 16, v33
    v_and_b32 v219, 0xffff0000, v33
    v_add_f32 v214, v214, v218
    v_add_f32 v215, v215, v219
    v_lshlrev_b32 v218, 16, v34
    v_and_b32 v219, 0xffff0000, v34
    v_add_f32 v214, v214, v218
    v_add_f32 v215, v215, v219
    v_lshlrev_b32 v218, 16, v35
    v_and_b32 v219, 0xffff0000, v35
    v_add_f32 v214, v214, v218
    v_add_f32 v215, v215, v219
K1_CS_29:
    s_add_u32 m0, s32, 0
    s_nop 0
    buffer_load_dwordx4 v4, s[12:15], s29 offen offset:0 lds
    buffer_load_dwordx4 v5, s[12:15], s29 offen offset:1024 lds
    ds_read_b128 v[20:23], v12 offset:32768
    ds_read_b128 v[24:27], v202 offset:32768
    ds_read_b64_tr_b16 v[28:29], v18 offset:20480
    ds_read_b64_tr_b16 v[30:31], v18 offset:20992
    ds_read_b64_tr_b16 v[32:33], v19 offset:20480
    ds_read_b64_tr_b16 v[34:35], v19 offset:20992
    s_waitcnt lgkmcnt(6)
    v_mfma_f32_32x32x16_bf16 v[64:79], v[36:39], v[44:47], v[64:79]
    v_mfma_f32_32x32x16_bf16 v[80:95], v[36:39], v[48:51], v[80:95]
    v_mfma_f32_32x32x16_bf16 v[96:111], v[40:43], v[44:47], v[96:111]
    v_mfma_f32_32x32x16_bf16 v[112:127], v[40:43], v[48:51], v[112:127]
    s_cmp_lg_u32 s36, 1
    s_cbranch_scc1 K1_CS_30
    v_lshlrev_b32 v218, 16, v44
    v_and_b32 v219, 0xffff0000, v44
    v_add_f32 v212, v212, v218
    v_add_f32 v213, v213, v219
    v_lshlrev_b32 v218, 16, v45
    v_and_b32 v219, 0xffff0000, v45
    v_add_f32 v212, v212, v218
    v_add_f32 v213, v213, v219
    v_lshlrev_b32 v218, 16, v46
    v_and_b32 v219, 0xffff0000, v46
    v_add_f32 v212, v212, v218
    v_add_f32 v213, v213, v219
    v_lshlrev_b32 v218, 16, v47
    v_and_b32 v219, 0xffff0000, v47
    v_add_f32 v212, v212, v218
    v_add_f32 v213, v213, v219
    v_lshlrev_b32 v218, 16, v48
    v_and_b32 v219, 0xffff0000, v48
    v_add_f32 v214, v214, v218
    v_add_f32 v215, v215, v219
    v_lshlrev_b32 v218, 16, v49
    v_and_b32 v219, 0xffff0000, v49
    v_add_f32 v214, v214, v218
    v_add_f32 v215, v215, v219
    v_lshlrev_b32 v218, 16, v50
    v_and_b32 v219, 0xffff0000, v50
    v_add_f32 v214, v214, v218
    v_add_f32 v215, v215, v219
    v_lshlrev_b32 v218, 16, v51
    v_and_b32 v219, 0xffff0000, v51
    v_add_f32 v214, v214, v218
    v_add_f32 v215, v215, v219
K1_CS_30:
    s_add_u32 m0, s32, 0
    s_nop 0
    buffer_load_dwordx4 v6, s[12:15], s29 offen offset:2048 lds
    buffer_load_dwordx4 v7, s[12:15], s29 offen offset:3072 lds
    s_add_u32 s29, s29, 128
    ds_read_b128 v[36:39], v13 offset:32768
    ds_read_b128 v[40:43], v203 offset:32768
    ds_read_b64_tr_b16 v[44:45], v18 offset:22528
    ds_read_b64_tr_b16 v[46:47], v18 offset:23040
    ds_read_b64_tr_b16 v[48:49], v19 offset:22528
    ds_read_b64_tr_b16 v[50:51], v19 offset:23040
    s_waitcnt lgkmcnt(6)
    v_mfma_f32_32x32x16_bf16 v[64:79], v[20:23], v[28:31], v[64:79]
    v_mfma_f32_32x32x16_bf16 v[80:95], v[20:23], v[32:35], v[80:95]
    v_mfma_f32_32x32x16_bf16 v[96:111], v[24:27], v[28:31], v[96:111]
    v_mfma_f32_32x32x16_bf16 v[112:127], v[24:27], v[32:35], v[112:127]
    s_cmp_lg_u32 s36, 2
    s_cbranch_scc1 K1_CS_31
    v_lshlrev_b32 v218, 16, v28
    v_and_b32 v219, 0xffff0000, v28
    v_add_f32 v212, v212, v218
    v_add_f32 v213, v213, v219
    v_lshlrev_b32 v218, 16, v29
    v_and_b32 v219, 0xffff0000, v29
    v_add_f32 v212, v212, v218
    v_add_f32 v213, v213, v219
    v_lshlrev_b32 v218, 16, v30
    v_and_b32 v219, 0xffff0000, v30
    v_add_f32 v212, v212, v218
    v_add_f32 v213, v213, v219
    v_lshlrev_b32 v218, 16, v31
    v_and_b32 v219, 0xffff0000, v31
    v_add_f32 v212, v212, v218
    v_add_f32 v213, v213, v219
    v_lshlrev_b32 v218, 16, v32
    v_and_b32 v219, 0xffff0000, v32
    v_add_f32 v214, v214, v218
    v_add_f32 v215, v215, v219
    v_lshlrev_b32 v218, 16, v33
    v_and_b32 v219, 0xffff0000, v33
    v_add_f32 v214, v214, v218
    v_add_f32 v215, v215, v219
    v_lshlrev_b32 v218, 16, v34
    v_and_b32 v219, 0xffff0000, v34
    v_add_f32 v214, v214, v218
    v_add_f32 v215, v215, v219
    v_lshlrev_b32 v218, 16, v35
    v_and_b32 v219, 0xffff0000, v35
    v_add_f32 v214, v214, v218
    v_add_f32 v215, v215, v219
K1_CS_31:
    s_add_u32 m0, s33, 0
    s_nop 0
    buffer_load_dwordx4 v8, s[16:19], s30 offen offset:0 lds
    buffer_load_dwordx4 v9, s[16:19], s30 offen offset:1024 lds
    s_add_u32 s30, s30, s31
    s_waitcnt vmcnt(6) lgkmcnt(0)
    s_barrier
    global_load_dword v223, v222, s[52:53] sc1
    ds_read_b128 v[20:23], v14 offset:0
    ds_read_b128 v[24:27], v204 offset:0
    ds_read_b64_tr_b16 v[28:29], v18 offset:32768
    ds_read_b64_tr_b16 v[30:31], v18 offset:33280
    ds_read_b64_tr_b16 v[32:33], v19 offset:32768
    ds_read_b64_tr_b16 v[34:35], v19 offset:33280
    v_mfma_f32_32x32x16_bf16 v[64:79], v[36:39], v[44:47], v[64:79]
    v_mfma_f32_32x32x16_bf16 v[80:95], v[36:39], v[48:51], v[80:95]
    v_mfma_f32_32x32x16_bf16 v[96:111], v[40:43], v[44:47], v[96:111]
    v_mfma_f32_32x32x16_bf16 v[112:127], v[40:43], v[48:51], v[112:127]
    s_cmp_lg_u32 s36, 3
    s_cbranch_scc1 K1_CS_32
    v_lshlrev_b32 v218, 16, v44
    v_and_b32 v219, 0xffff0000, v44
    v_add_f32 v212, v212, v218
    v_add_f32 v213, v213, v219
    v_lshlrev_b32 v218, 16, v45
    v_and_b32 v219, 0xffff0000, v45
    v_add_f32 v212, v212, v218
    v_add_f32 v213, v213, v219
    v_lshlrev_b32 v218, 16, v46
    v_and_b32 v219, 0xffff0000, v46
    v_add_f32 v212, v212, v218
    v_add_f32 v213, v213, v219
    v_lshlrev_b32 v218, 16, v47
    v_and_b32 v219, 0xffff0000, v47
    v_add_f32 v212, v212, v218
    v_add_f32 v213, v213, v219
    v_lshlrev_b32 v218, 16, v48
    v_and_b32 v219, 0xffff0000, v48
    v_add_f32 v214, v214, v218
    v_add_f32 v215, v215, v219
    v_lshlrev_b32 v218, 16, v49
    v_and_b32 v219, 0xffff0000, v49
    v_add_f32 v214, v214, v218
    v_add_f32 v215, v215, v219
    v_lshlrev_b32 v218, 16, v50
    v_and_b32 v219, 0xffff0000, v50
    v_add_f32 v214, v214, v218
    v_add_f32 v215, v215, v219
    v_lshlrev_b32 v218, 16, v51
    v_and_b32 v219, 0xffff0000, v51
    v_add_f32 v214, v214, v218
    v_add_f32 v215, v215, v219
K1_CS_32:
    ds_read_b128 v[36:39], v15 offset:0
    ds_read_b128 v[40:43], v205 offset:0
    ds_read_b64_tr_b16 v[44:45], v18 offset:34816
    ds_read_b64_tr_b16 v[46:47], v18 offset:35328
    ds_read_b64_tr_b16 v[48:49], v19 offset:34816
    ds_read_b64_tr_b16 v[50:51], v19 offset:35328
    s_waitcnt lgkmcnt(6)
    v_mfma_f32_32x32x16_bf16 v[64:79], v[20:23], v[28:31], v[64:79]
    v_mfma_f32_32x32x16_bf16 v[80:95], v[20:23], v[32:35], v[80:95]
    v_mfma_f32_32x32x16_bf16 v[96:111], v[24:27], v[28:31], v[96:111]
    v_mfma_f32_32x32x16_bf16 v[112:127], v[24:27], v[32:35], v[112:127]
    s_cmp_lg_u32 s36, 0
    s_cbranch_scc1 K1_CS_33
    v_lshlrev_b32 v218, 16, v28
    v_and_b32 v219, 0xffff0000, v28
    v_add_f32 v212, v212, v218
    v_add_f32 v213, v213, v219
    v_lshlrev_b32 v218, 16, v29
    v_and_b32 v219, 0xffff0000, v29
    v_add_f32 v212, v212, v218
    v_add_f32 v213, v213, v219
    v_lshlrev_b32 v218, 16, v30
    v_and_b32 v219, 0xffff0000, v30
    v_add_f32 v212, v212, v218
    v_add_f32 v213, v213, v219
    v_lshlrev_b32 v218, 16, v31
    v_and_b32 v219, 0xffff0000, v31
    v_add_f32 v212, v212, v218
    v_add_f32 v213, v213, v219
    v_lshlrev_b32 v218, 16, v32
    v_and_b32 v219, 0xffff0000, v32
    v_add_f32 v214, v214, v218
    v_add_f32 v215, v215, v219
    v_lshlrev_b32 v218, 16, v33
    v_and_b32 v219, 0xffff0000, v33
    v_add_f32 v214, v214, v218
    v_add_f32 v215, v215, v219
    v_lshlrev_b32 v218, 16, v34
    v_and_b32 v219, 0xffff0000, v34
    v_add_f32 v214, v214, v218
    v_add_f32 v215, v215, v219
    v_lshlrev_b32 v218, 16, v35
    v_and_b32 v219, 0xffff0000, v35
    v_add_f32 v214, v214, v218
    v_add_f32 v215, v215, v219
K1_CS_33:
    ds_read_b128 v[20:23], v16 offset:0
    ds_read_b128 v[24:27], v206 offset:0
    ds_read_b64_tr_b16 v[28:29], v18 offset:36864
    ds_read_b64_tr_b16 v[30:31], v18 offset:37376
    ds_read_b64_tr_b16 v[32:33], v19 offset:36864
    ds_read_b64_tr_b16 v[34:35], v19 offset:37376
    s_waitcnt lgkmcnt(6)
    v_mfma_f32_32x32x16_bf16 v[64:79], v[36:39], v[44:47], v[64:79]
    v_mfma_f32_32x32x16_bf16 v[80:95], v[36:39], v[48:51], v[80:95]
    v_mfma_f32_32x32x16_bf16 v[96:111], v[40:43], v[44:47], v[96:111]
    v_mfma_f32_32x32x16_bf16 v[112:127], v[40:43], v[48:51], v[112:127]
    s_cmp_lg_u32 s36, 1
    s_cbranch_scc1 K1_CS_34
    v_lshlrev_b32 v218, 16, v44
    v_and_b32 v219, 0xffff0000, v44
    v_add_f32 v212, v212, v218
    v_add_f32 v213, v213, v219
    v_lshlrev_b32 v218, 16, v45
    v_and_b32 v219, 0xffff0000, v45
    v_add_f32 v212, v212, v218
    v_add_f32 v213, v213, v219
    v_lshlrev_b32 v218, 16, v46
    v_and_b32 v219, 0xffff0000, v46
    v_add_f32 v212, v212, v218
    v_add_f32 v213, v213, v219
    v_lshlrev_b32 v218, 16, v47
    v_and_b32 v219, 0xffff0000, v47
    v_add_f32 v212, v212, v218
    v_add_f32 v213, v213, v219
    v_lshlrev_b32 v218, 16, v48
    v_and_b32 v219, 0xffff0000, v48
    v_add_f32 v214, v214, v218
    v_add_f32 v215, v215, v219
    v_lshlrev_b32 v218, 16, v49
    v_and_b32 v219, 0xffff0000, v49
    v_add_f32 v214, v214, v218
    v_add_f32 v215, v215, v219
    v_lshlrev_b32 v218, 16, v50
    v_and_b32 v219, 0xffff0000, v50
    v_add_f32 v214, v214, v218
    v_add_f32 v215, v215, v219
    v_lshlrev_b32 v218, 16, v51
    v_and_b32 v219, 0xffff0000, v51
    v_add_f32 v214, v214, v218
    v_add_f32 v215, v215, v219
K1_CS_34:
    ds_read_b128 v[36:39], v17 offset:0
    ds_read_b128 v[40:43], v207 offset:0
    ds_read_b64_tr_b16 v[44:45], v18 offset:38912
    ds_read_b64_tr_b16 v[46:47], v18 offset:39424
    ds_read_b64_tr_b16 v[48:49], v19 offset:38912
    ds_read_b64_tr_b16 v[50:51], v19 offset:39424
    s_waitcnt lgkmcnt(6)
    v_mfma_f32_32x32x16_bf16 v[64:79], v[20:23], v[28:31], v[64:79]
    v_mfma_f32_32x32x16_bf16 v[80:95], v[20:23], v[32:35], v[80:95]
    v_mfma_f32_32x32x16_bf16 v[96:111], v[24:27], v[28:31], v[96:111]
    v_mfma_f32_32x32x16_bf16 v[112:127], v[24:27], v[32:35], v[112:127]
    s_cmp_lg_u32 s36, 2
    s_cbranch_scc1 K1_CS_35
    v_lshlrev_b32 v218, 16, v28
    v_and_b32 v219, 0xffff0000, v28
    v_add_f32 v212, v212, v218
    v_add_f32 v213, v213, v219
    v_lshlrev_b32 v218, 16, v29
    v_and_b32 v219, 0xffff0000, v29
    v_add_f32 v212, v212, v218
    v_add_f32 v213, v213, v219
    v_lshlrev_b32 v218, 16, v30
    v_and_b32 v219, 0xffff0000, v30
    v_add_f32 v212, v212, v218
    v_add_f32 v213, v213, v219
    v_lshlrev_b32 v218, 16, v31
    v_and_b32 v219, 0xffff0000, v31
    v_add_f32 v212, v212, v218
    v_add_f32 v213, v213, v219
    v_lshlrev_b32 v218, 16, v32
    v_and_b32 v219, 0xffff0000, v32
    v_add_f32 v214, v214, v218
    v_add_f32 v215, v215, v219
    v_lshlrev_b32 v218, 16, v33
    v_and_b32 v219, 0xffff0000, v33
    v_add_f32 v214, v214, v218
    v_add_f32 v215, v215, v219
    v_lshlrev_b32 v218, 16, v34
    v_and_b32 v219, 0xffff0000, v34
    v_add_f32 v214, v214, v218
    v_add_f32 v215, v215, v219
    v_lshlrev_b32 v218, 16, v35
    v_and_b32 v219, 0xffff0000, v35
    v_add_f32 v214, v214, v218
    v_add_f32 v215, v215, v219
K1_CS_35:
    s_waitcnt vmcnt(0) lgkmcnt(0)
    s_barrier
    v_readfirstlane_b32 s39, v223
    s_cmp_lt_u32 s39, 40
    s_cbranch_scc1 K1_NOTREADY_V
    buffer_load_dwordx4 v[132:135], v221, s[20:23], s58 offen offset:0 sc1
    buffer_load_dwordx4 v[136:139], v221, s[20:23], s61 offen offset:0 sc1
    buffer_load_dwordx4 v[140:143], v221, s[20:23], s58 offen offset:32 sc1
    buffer_load_dwordx4 v[144:147], v221, s[20:23], s61 offen offset:32 sc1
    buffer_load_dwordx4 v[148:151], v221, s[20:23], s58 offen offset:64 sc1
    buffer_load_dwordx4 v[152:155], v221, s[20:23], s61 offen offset:64 sc1
    buffer_load_dwordx4 v[156:159], v221, s[20:23], s58 offen offset:96 sc1
    buffer_load_dwordx4 v[160:163], v221, s[20:23], s61 offen offset:96 sc1
    buffer_load_dwordx4 v[164:167], v221, s[20:23], s59 offen offset:0 sc1
    buffer_load_dwordx4 v[168:171], v221, s[20:23], s63 offen offset:0 sc1
    buffer_load_dwordx4 v[172:175], v221, s[20:23], s59 offen offset:32 sc1
    buffer_load_dwordx4 v[176:179], v221, s[20:23], s63 offen offset:32 sc1
    buffer_load_dwordx4 v[180:183], v221, s[20:23], s59 offen offset:64 sc1
    buffer_load_dwordx4 v[184:187], v221, s[20:23], s63 offen offset:64 sc1
    buffer_load_dwordx4 v[188:191], v221, s[20:23], s59 offen offset:96 sc1
    buffer_load_dwordx4 v[192:195], v221, s[20:23], s63 offen offset:96 sc1
    s_mov_b32 s62, 1
    s_branch K1_READY1_V
K1_NOTREADY_V:
    global_load_dword v223, v222, s[52:53] sc1
K1_READY1_V:
    ds_read_b128 v[20:23], v10 offset:0
    ds_read_b128 v[24:27], v200 offset:0
    ds_read_b64_tr_b16 v[28:29], v18 offset:0
    ds_read_b64_tr_b16 v[30:31], v18 offset:512
    ds_read_b64_tr_b16 v[32:33], v19 offset:0
    ds_read_b64_tr_b16 v[34:35], v19 offset:512
    v_mfma_f32_32x32x16_bf16 v[64:79], v[36:39], v[44:47], v[64:79]
    v_mfma_f32_32x32x16_bf16 v[80:95], v[36:39], v[48:51], v[80:95]
    v_mfma_f32_32x32x16_bf16 v[96:111], v[40:43], v[44:47], v[96:111]
    v_mfma_f32_32x32x16_bf16 v[112:127], v[40:43], v[48:51], v[112:127]
    s_cmp_lg_u32 s36, 3
    s_cbranch_scc1 K1_CS_36
    v_lshlrev_b32 v218, 16, v44
    v_and_b32 v219, 0xffff0000, v44
    v_add_f32 v212, v212, v218
    v_add_f32 v213, v213, v219
    v_lshlrev_b32 v218, 16, v45
    v_and_b32 v219, 0xffff0000, v45
    v_add_f32 v212, v212, v218
    v_add_f32 v213, v213, v219
    v_lshlrev_b32 v218, 16, v46
    v_and_b32 v219, 0xffff0000, v46
    v_add_f32 v212, v212, v218
    v_add_f32 v213, v213, v219
    v_lshlrev_b32 v218, 16, v47
    v_and_b32 v219, 0xffff0000, v47
    v_add_f32 v212, v212, v218
    v_add_f32 v213, v213, v219
    v_lshlrev_b32 v218, 16, v48
    v_and_b32 v219, 0xffff0000, v48
    v_add_f32 v214, v214, v218
    v_add_f32 v215, v215, v219
    v_lshlrev_b32 v218, 16, v49
    v_and_b32 v219, 0xffff0000, v49
    v_add_f32 v214, v214, v218
    v_add_f32 v215, v215, v219
    v_lshlrev_b32 v218, 16, v50
    v_and_b32 v219, 0xffff0000, v50
    v_add_f32 v214, v214, v218
    v_add_f32 v215, v215, v219
    v_lshlrev_b32 v218, 16, v51
    v_and_b32 v219, 0xffff0000, v51
    v_add_f32 v214, v214, v218
    v_add_f32 v215, v215, v219
K1_CS_36:
    ds_read_b128 v[36:39], v11 offset:0
    ds_read_b128 v[40:43], v201 offset:0
    ds_read_b64_tr_b16 v[44:45], v18 offset:2048
    ds_read_b64_tr_b16 v[46:47], v18 offset:2560
    ds_read_b64_tr_b16 v[48:49], v19 offset:2048
    ds_read_b64_tr_b16 v[50:51], v19 offset:2560
    s_waitcnt lgkmcnt(6)
    v_mfma_f32_32x32x16_bf16 v[64:79], v[20:23], v[28:31], v[64:79]
    v_mfma_f32_32x32x16_bf16 v[80:95], v[20:23], v[32:35], v[80:95]
    v_mfma_f32_32x32x16_bf16 v[96:111], v[24:27], v[28:31], v[96:111]
    v_mfma_f32_32x32x16_bf16 v[112:127], v[24:27], v[32:35], v[112:127]
    s_cmp_lg_u32 s36, 0
    s_cbranch_scc1 K1_CS_37
    v_lshlrev_b32 v218, 16, v28
    v_and_b32 v219, 0xffff0000, v28
    v_add_f32 v212, v212, v218
    v_add_f32 v213, v213, v219
    v_lshlrev_b32 v218, 16, v29
    v_and_b32 v219, 0xffff0000, v29
    v_add_f32 v212, v212, v218
    v_add_f32 v213, v213, v219
    v_lshlrev_b32 v218, 16, v30
    v_and_b32 v219, 0xffff0000, v30
    v_add_f32 v212, v212, v218
    v_add_f32 v213, v213, v219
    v_lshlrev_b32 v218, 16, v31
    v_and_b32 v219, 0xffff0000, v31
    v_add_f32 v212, v212, v218
    v_add_f32 v213, v213, v219
    v_lshlrev_b32 v218, 16, v32
    v_and_b32 v219, 0xffff0000, v32
    v_add_f32 v214, v214, v218
    v_add_f32 v215, v215, v219
    v_lshlrev_b32 v218, 16, v33
    v_and_b32 v219, 0xffff0000, v33
    v_add_f32 v214, v214, v218
    v_add_f32 v215, v215, v219
    v_lshlrev_b32 v218, 16, v34
    v_and_b32 v219, 0xffff0000, v34
    v_add_f32 v214, v214, v218
    v_add_f32 v215, v215, v219
    v_lshlrev_b32 v218, 16, v35
    v_and_b32 v219, 0xffff0000, v35
    v_add_f32 v214, v214, v218
    v_add_f32 v215, v215, v219
K1_CS_37:
    ds_read_b128 v[20:23], v12 offset:0
    ds_read_b128 v[24:27], v202 offset:0
    ds_read_b64_tr_b16 v[28:29], v18 offset:4096
    ds_read_b64_tr_b16 v[30:31], v18 offset:4608
    ds_read_b64_tr_b16 v[32:33], v19 offset:4096
    ds_read_b64_tr_b16 v[34:35], v19 offset:4608
    s_waitcnt lgkmcnt(6)
    v_mfma_f32_32x32x16_bf16 v[64:79], v[36:39], v[44:47], v[64:79]
    v_mfma_f32_32x32x16_bf16 v[80:95], v[36:39], v[48:51], v[80:95]
    v_mfma_f32_32x32x16_bf16 v[96:111], v[40:43], v[44:47], v[96:111]
    v_mfma_f32_32x32x16_bf16 v[112:127], v[40:43], v[48:51], v[112:127]
    s_cmp_lg_u32 s36, 1
    s_cbranch_scc1 K1_CS_38
    v_lshlrev_b32 v218, 16, v44
    v_and_b32 v219, 0xffff0000, v44
    v_add_f32 v212, v212, v218
    v_add_f32 v213, v213, v219
    v_lshlrev_b32 v218, 16, v45
    v_and_b32 v219, 0xffff0000, v45
    v_add_f32 v212, v212, v218
    v_add_f32 v213, v213, v219
    v_lshlrev_b32 v218, 16, v46
    v_and_b32 v219, 0xffff0000, v46
    v_add_f32 v212, v212, v218
    v_add_f32 v213, v213, v219
    v_lshlrev_b32 v218, 16, v47
    v_and_b32 v219, 0xffff0000, v47
    v_add_f32 v212, v212, v218
    v_add_f32 v213, v213, v219
    v_lshlrev_b32 v218, 16, v48
    v_and_b32 v219, 0xffff0000, v48
    v_add_f32 v214, v214, v218
    v_add_f32 v215, v215, v219
    v_lshlrev_b32 v218, 16, v49
    v_and_b32 v219, 0xffff0000, v49
    v_add_f32 v214, v214, v218
    v_add_f32 v215, v215, v219
    v_lshlrev_b32 v218, 16, v50
    v_and_b32 v219, 0xffff0000, v50
    v_add_f32 v214, v214, v218
    v_add_f32 v215, v215, v219
    v_lshlrev_b32 v218, 16, v51
    v_and_b32 v219, 0xffff0000, v51
    v_add_f32 v214, v214, v218
    v_add_f32 v215, v215, v219
K1_CS_38:
    s_cmp_lg_u32 s62, 0
    s_cbranch_scc1 K1_READY2_V
    s_waitcnt vmcnt(0)
    v_readfirstlane_b32 s39, v223
    s_cmp_lt_u32 s39, 40
    s_cbranch_scc1 K1_READY2_V

    buffer_load_dwordx4 v[132:135], v221, s[20:23], s58 offen offset:0 sc1
    buffer_load_dwordx4 v[136:139], v221, s[20:23], s61 offen offset:0 sc1
    buffer_load_dwordx4 v[140:143], v221, s[20:23], s58 offen offset:32 sc1
    buffer_load_dwordx4 v[144:147], v221, s[20:23], s61 offen offset:32 sc1
    buffer_load_dwordx4 v[148:151], v221, s[20:23], s58 offen offset:64 sc1
    buffer_load_dwordx4 v[152:155], v221, s[20:23], s61 offen offset:64 sc1
    buffer_load_dwordx4 v[156:159], v221, s[20:23], s58 offen offset:96 sc1
    buffer_load_dwordx4 v[160:163], v221, s[20:23], s61 offen offset:96 sc1
    buffer_load_dwordx4 v[164:167], v221, s[20:23], s59 offen offset:0 sc1
    buffer_load_dwordx4 v[168:171], v221, s[20:23], s63 offen offset:0 sc1
    buffer_load_dwordx4 v[172:175], v221, s[20:23], s59 offen offset:32 sc1
    buffer_load_dwordx4 v[176:179], v221, s[20:23], s63 offen offset:32 sc1
    buffer_load_dwordx4 v[180:183], v221, s[20:23], s59 offen offset:64 sc1
    buffer_load_dwordx4 v[184:187], v221, s[20:23], s63 offen offset:64 sc1
    buffer_load_dwordx4 v[188:191], v221, s[20:23], s59 offen offset:96 sc1
    buffer_load_dwordx4 v[192:195], v221, s[20:23], s63 offen offset:96 sc1
    s_mov_b32 s62, 1
K1_READY2_V:
    ds_read_b128 v[36:39], v13 offset:0
    ds_read_b128 v[40:43], v203 offset:0
    ds_read_b64_tr_b16 v[44:45], v18 offset:6144
    ds_read_b64_tr_b16 v[46:47], v18 offset:6656
    ds_read_b64_tr_b16 v[48:49], v19 offset:6144
    ds_read_b64_tr_b16 v[50:51], v19 offset:6656
    s_waitcnt lgkmcnt(6)
    v_mfma_f32_32x32x16_bf16 v[64:79], v[20:23], v[28:31], v[64:79]
    v_mfma_f32_32x32x16_bf16 v[80:95], v[20:23], v[32:35], v[80:95]
    v_mfma_f32_32x32x16_bf16 v[96:111], v[24:27], v[28:31], v[96:111]
    v_mfma_f32_32x32x16_bf16 v[112:127], v[24:27], v[32:35], v[112:127]
    s_cmp_lg_u32 s36, 2
    s_cbranch_scc1 K1_CS_39
    v_lshlrev_b32 v218, 16, v28
    v_and_b32 v219, 0xffff0000, v28
    v_add_f32 v212, v212, v218
    v_add_f32 v213, v213, v219
    v_lshlrev_b32 v218, 16, v29
    v_and_b32 v219, 0xffff0000, v29
    v_add_f32 v212, v212, v218
    v_add_f32 v213, v213, v219
    v_lshlrev_b32 v218, 16, v30
    v_and_b32 v219, 0xffff0000, v30
    v_add_f32 v212, v212, v218
    v_add_f32 v213, v213, v219
    v_lshlrev_b32 v218, 16, v31
    v_and_b32 v219, 0xffff0000, v31
    v_add_f32 v212, v212, v218
    v_add_f32 v213, v213, v219
    v_lshlrev_b32 v218, 16, v32
    v_and_b32 v219, 0xffff0000, v32
    v_add_f32 v214, v214, v218
    v_add_f32 v215, v215, v219
    v_lshlrev_b32 v218, 16, v33
    v_and_b32 v219, 0xffff0000, v33
    v_add_f32 v214, v214, v218
    v_add_f32 v215, v215, v219
    v_lshlrev_b32 v218, 16, v34
    v_and_b32 v219, 0xffff0000, v34
    v_add_f32 v214, v214, v218
    v_add_f32 v215, v215, v219
    v_lshlrev_b32 v218, 16, v35
    v_and_b32 v219, 0xffff0000, v35
    v_add_f32 v214, v214, v218
    v_add_f32 v215, v215, v219
K1_CS_39:
    s_waitcnt lgkmcnt(0)
    v_mfma_f32_32x32x16_bf16 v[64:79], v[36:39], v[44:47], v[64:79]
    v_mfma_f32_32x32x16_bf16 v[80:95], v[36:39], v[48:51], v[80:95]
    v_mfma_f32_32x32x16_bf16 v[96:111], v[40:43], v[44:47], v[96:111]
    v_mfma_f32_32x32x16_bf16 v[112:127], v[40:43], v[48:51], v[112:127]
    s_cmp_lg_u32 s36, 3
    s_cbranch_scc1 K1_CS_40
    v_lshlrev_b32 v218, 16, v44
    v_and_b32 v219, 0xffff0000, v44
    v_add_f32 v212, v212, v218
    v_add_f32 v213, v213, v219
    v_lshlrev_b32 v218, 16, v45
    v_and_b32 v219, 0xffff0000, v45
    v_add_f32 v212, v212, v218
    v_add_f32 v213, v213, v219
    v_lshlrev_b32 v218, 16, v46
    v_and_b32 v219, 0xffff0000, v46
    v_add_f32 v212, v212, v218
    v_add_f32 v213, v213, v219
    v_lshlrev_b32 v218, 16, v47
    v_and_b32 v219, 0xffff0000, v47
    v_add_f32 v212, v212, v218
    v_add_f32 v213, v213, v219
    v_lshlrev_b32 v218, 16, v48
    v_and_b32 v219, 0xffff0000, v48
    v_add_f32 v214, v214, v218
    v_add_f32 v215, v215, v219
    v_lshlrev_b32 v218, 16, v49
    v_and_b32 v219, 0xffff0000, v49
    v_add_f32 v214, v214, v218
    v_add_f32 v215, v215, v219
    v_lshlrev_b32 v218, 16, v50
    v_and_b32 v219, 0xffff0000, v50
    v_add_f32 v214, v214, v218
    v_add_f32 v215, v215, v219
    v_lshlrev_b32 v218, 16, v51
    v_and_b32 v219, 0xffff0000, v51
    v_add_f32 v214, v214, v218
    v_add_f32 v215, v215, v219
K1_CS_40:
    v_add_f32 v212, v212, v213
    v_add_f32 v214, v214, v215
    v_mov_b32 v213, v212
    v_mov_b32 v215, v214
    s_nop 1
    v_permlane32_swap_b32 v212, v213
    v_permlane32_swap_b32 v214, v215
    s_nop 1
    v_add_f32 v212, v212, v213
    v_add_f32 v214, v214, v215
    v_cndmask_b32 v212, v212, v214, s[48:49]
    s_lshl_b32 s39, s3, 8
    s_add_u32 s39, s39, 151552
    v_lshlrev_b32 v52, 2, v1
    v_add_u32 v53, s39, v52
    ds_write_b32 v53, v212
    s_lshl_b32 s39, s37, 10
    s_add_u32 s39, s39, 151552
    v_add_u32 v53, s39, v52
    s_waitcnt lgkmcnt(0)
    s_barrier
    ds_read_b32 v56, v53
    ds_read_b32 v57, v53 offset:256
    ds_read_b32 v58, v53 offset:512
    ds_read_b32 v59, v53 offset:768
    s_cmp_lg_u32 s62, 0
    s_cbranch_scc1 K1_READY_V
    s_mov_b32 s40, 0
K1_SPIN_V:
    global_load_dword v223, v222, s[52:53] sc1
    s_waitcnt vmcnt(0)
    v_readfirstlane_b32 s39, v223
    s_cmp_ge_u32 s39, 40
    s_cbranch_scc1 K1_SPINDONE_V
    s_sleep 4
    s_add_u32 s40, s40, 1
    s_cmp_lt_u32 s40, 0x40000
    s_cbranch_scc1 K1_SPIN_V
K1_SPINDONE_V:

    buffer_load_dwordx4 v[132:135], v221, s[20:23], s58 offen offset:0 sc1
    buffer_load_dwordx4 v[136:139], v221, s[20:23], s61 offen offset:0 sc1
    buffer_load_dwordx4 v[140:143], v221, s[20:23], s58 offen offset:32 sc1
    buffer_load_dwordx4 v[144:147], v221, s[20:23], s61 offen offset:32 sc1
    buffer_load_dwordx4 v[148:151], v221, s[20:23], s58 offen offset:64 sc1
    buffer_load_dwordx4 v[152:155], v221, s[20:23], s61 offen offset:64 sc1
    buffer_load_dwordx4 v[156:159], v221, s[20:23], s58 offen offset:96 sc1
    buffer_load_dwordx4 v[160:163], v221, s[20:23], s61 offen offset:96 sc1
    buffer_load_dwordx4 v[164:167], v221, s[20:23], s59 offen offset:0 sc1
    buffer_load_dwordx4 v[168:171], v221, s[20:23], s63 offen offset:0 sc1
    buffer_load_dwordx4 v[172:175], v221, s[20:23], s59 offen offset:32 sc1
    buffer_load_dwordx4 v[176:179], v221, s[20:23], s63 offen offset:32 sc1
    buffer_load_dwordx4 v[180:183], v221, s[20:23], s59 offen offset:64 sc1
    buffer_load_dwordx4 v[184:187], v221, s[20:23], s63 offen offset:64 sc1
    buffer_load_dwordx4 v[188:191], v221, s[20:23], s59 offen offset:96 sc1
    buffer_load_dwordx4 v[192:195], v221, s[20:23], s63 offen offset:96 sc1
K1_READY_V:
    s_waitcnt lgkmcnt(0)
    v_add_f32 v56, v56, v57
    v_add_f32 v58, v58, v59
    v_add_f32 v56, v56, v58

    v_mov_b32 v57, v56
    s_nop 1
    v_permlane32_swap_b32 v56, v57
    v_mov_b32 v128, v56
    v_mov_b32 v129, v57

    s_waitcnt vmcnt(0) lgkmcnt(0)
    v_and_b32 v52, 31, v1
    s_sub_u32 s39, s66, 1280
    v_add_u32 v52, s39, v52
    s_lshl_b32 s40, s34, 3
    s_lshl_b32 s41, s36, 1
    s_add_u32 s40, s40, s41
    s_add_u32 s40, s40, s37
    s_xor_b32 s41, s40, 1
    s_mul_i32 s40, s40, 2560
    s_mul_i32 s41, s41, 2560
    s_add_u32 s40, s40, 7865600
    s_add_u32 s41, s41, 7865600
    s_movk_i32 s42, 3277
    s_mov_b32 s43, 163840
    v_mul_u32_u24 v53, 20, v3

    v_add_u32 v54, 0, v52
    v_mul_u32_u24 v55, s42, v54
    v_lshrrev_b32 v55, 16, v55
    v_mul_u32_u24 v56, 20, v55
    v_sub_u32 v56, v54, v56
    v_add_u32 v56, v56, v53
    v_mul_lo_u32 v55, v55, s43
    v_lshl_add_u32 v58, v56, 4, v55

    v_add_u32 v54, 32, v52
    v_mul_u32_u24 v55, s42, v54
    v_lshrrev_b32 v55, 16, v55
    v_mul_u32_u24 v56, 20, v55
    v_sub_u32 v56, v54, v56
    v_add_u32 v56, v56, v53
    v_mul_lo_u32 v55, v55, s43
    v_lshl_add_u32 v59, v56, 4, v55

    v_mul_f32 v52, v136, v128
    v_mul_f32 v53, v137, v128
    v_mul_f32 v54, v138, v128
    v_mul_f32 v55, v139, v128
    v_fma_f32 v64, v64, v132, v52
    v_fma_f32 v65, v65, v133, v53
    v_fma_f32 v66, v66, v134, v54
    v_fma_f32 v67, v67, v135, v55
    v_mul_f32 v52, v144, v128
    v_mul_f32 v53, v145, v128
    v_mul_f32 v54, v146, v128
    v_mul_f32 v55, v147, v128
    v_fma_f32 v68, v68, v140, v52
    v_fma_f32 v69, v69, v141, v53
    v_fma_f32 v70, v70, v142, v54
    v_fma_f32 v71, v71, v143, v55
    v_mul_f32 v52, v152, v128
    v_mul_f32 v53, v153, v128
    v_mul_f32 v54, v154, v128
    v_mul_f32 v55, v155, v128
    v_fma_f32 v72, v72, v148, v52
    v_fma_f32 v73, v73, v149, v53
    v_fma_f32 v74, v74, v150, v54
    v_fma_f32 v75, v75, v151, v55
    v_mul_f32 v52, v160, v128
    v_mul_f32 v53, v161, v128
    v_mul_f32 v54, v162, v128
    v_mul_f32 v55, v163, v128
    v_fma_f32 v76, v76, v156, v52
    v_fma_f32 v77, v77, v157, v53
    v_fma_f32 v78, v78, v158, v54
    v_fma_f32 v79, v79, v159, v55
    v_cvt_pk_bf16_f32 v20, v64, v65
    v_cvt_pk_bf16_f32 v21, v66, v67
    v_cvt_pk_bf16_f32 v22, v68, v69
    v_cvt_pk_bf16_f32 v23, v70, v71
    buffer_store_dwordx4 v[20:23], v58, s[20:23], s40 offen offset:0
    v_cvt_pk_bf16_f32 v24, v72, v73
    v_cvt_pk_bf16_f32 v25, v74, v75
    v_cvt_pk_bf16_f32 v26, v76, v77
    v_cvt_pk_bf16_f32 v27, v78, v79
    buffer_store_dwordx4 v[24:27], v58, s[20:23], s40 offen offset:640
    v_mul_f32 v52, v136, v129
    v_mul_f32 v53, v137, v129
    v_mul_f32 v54, v138, v129
    v_mul_f32 v55, v139, v129
    v_fma_f32 v80, v80, v132, v52
    v_fma_f32 v81, v81, v133, v53
    v_fma_f32 v82, v82, v134, v54
    v_fma_f32 v83, v83, v135, v55
    v_mul_f32 v52, v144, v129
    v_mul_f32 v53, v145, v129
    v_mul_f32 v54, v146, v129
    v_mul_f32 v55, v147, v129
    v_fma_f32 v84, v84, v140, v52
    v_fma_f32 v85, v85, v141, v53
    v_fma_f32 v86, v86, v142, v54
    v_fma_f32 v87, v87, v143, v55
    v_mul_f32 v52, v152, v129
    v_mul_f32 v53, v153, v129
    v_mul_f32 v54, v154, v129
    v_mul_f32 v55, v155, v129
    v_fma_f32 v88, v88, v148, v52
    v_fma_f32 v89, v89, v149, v53
    v_fma_f32 v90, v90, v150, v54
    v_fma_f32 v91, v91, v151, v55
    v_mul_f32 v52, v160, v129
    v_mul_f32 v53, v161, v129
    v_mul_f32 v54, v162, v129
    v_mul_f32 v55, v163, v129
    v_fma_f32 v92, v92, v156, v52
    v_fma_f32 v93, v93, v157, v53
    v_fma_f32 v94, v94, v158, v54
    v_fma_f32 v95, v95, v159, v55
    v_cvt_pk_bf16_f32 v28, v80, v81
    v_cvt_pk_bf16_f32 v29, v82, v83
    v_cvt_pk_bf16_f32 v30, v84, v85
    v_cvt_pk_bf16_f32 v31, v86, v87
    buffer_store_dwordx4 v[28:31], v59, s[20:23], s40 offen offset:0
    v_cvt_pk_bf16_f32 v32, v88, v89
    v_cvt_pk_bf16_f32 v33, v90, v91
    v_cvt_pk_bf16_f32 v34, v92, v93
    v_cvt_pk_bf16_f32 v35, v94, v95
    buffer_store_dwordx4 v[32:35], v59, s[20:23], s40 offen offset:640
    v_mul_f32 v52, v168, v128
    v_mul_f32 v53, v169, v128
    v_mul_f32 v54, v170, v128
    v_mul_f32 v55, v171, v128
    v_fma_f32 v96, v96, v164, v52
    v_fma_f32 v97, v97, v165, v53
    v_fma_f32 v98, v98, v166, v54
    v_fma_f32 v99, v99, v167, v55
    v_mul_f32 v52, v176, v128
    v_mul_f32 v53, v177, v128
    v_mul_f32 v54, v178, v128
    v_mul_f32 v55, v179, v128
    v_fma_f32 v100, v100, v172, v52
    v_fma_f32 v101, v101, v173, v53
    v_fma_f32 v102, v102, v174, v54
    v_fma_f32 v103, v103, v175, v55
    v_mul_f32 v52, v184, v128
    v_mul_f32 v53, v185, v128
    v_mul_f32 v54, v186, v128
    v_mul_f32 v55, v187, v128
    v_fma_f32 v104, v104, v180, v52
    v_fma_f32 v105, v105, v181, v53
    v_fma_f32 v106, v106, v182, v54
    v_fma_f32 v107, v107, v183, v55
    v_mul_f32 v52, v192, v128
    v_mul_f32 v53, v193, v128
    v_mul_f32 v54, v194, v128
    v_mul_f32 v55, v195, v128
    v_fma_f32 v108, v108, v188, v52
    v_fma_f32 v109, v109, v189, v53
    v_fma_f32 v110, v110, v190, v54
    v_fma_f32 v111, v111, v191, v55
    v_cvt_pk_bf16_f32 v36, v96, v97
    v_cvt_pk_bf16_f32 v37, v98, v99
    v_cvt_pk_bf16_f32 v38, v100, v101
    v_cvt_pk_bf16_f32 v39, v102, v103
    buffer_store_dwordx4 v[36:39], v58, s[20:23], s41 offen offset:0
    v_cvt_pk_bf16_f32 v40, v104, v105
    v_cvt_pk_bf16_f32 v41, v106, v107
    v_cvt_pk_bf16_f32 v42, v108, v109
    v_cvt_pk_bf16_f32 v43, v110, v111
    buffer_store_dwordx4 v[40:43], v58, s[20:23], s41 offen offset:640
    v_mul_f32 v52, v168, v129
    v_mul_f32 v53, v169, v129
    v_mul_f32 v54, v170, v129
    v_mul_f32 v55, v171, v129
    v_fma_f32 v112, v112, v164, v52
    v_fma_f32 v113, v113, v165, v53
    v_fma_f32 v114, v114, v166, v54
    v_fma_f32 v115, v115, v167, v55
    v_mul_f32 v52, v176, v129
    v_mul_f32 v53, v177, v129
    v_mul_f32 v54, v178, v129
    v_mul_f32 v55, v179, v129
    v_fma_f32 v116, v116, v172, v52
    v_fma_f32 v117, v117, v173, v53
    v_fma_f32 v118, v118, v174, v54
    v_fma_f32 v119, v119, v175, v55
    v_mul_f32 v52, v184, v129
    v_mul_f32 v53, v185, v129
    v_mul_f32 v54, v186, v129
    v_mul_f32 v55, v187, v129
    v_fma_f32 v120, v120, v180, v52
    v_fma_f32 v121, v121, v181, v53
    v_fma_f32 v122, v122, v182, v54
    v_fma_f32 v123, v123, v183, v55
    v_mul_f32 v52, v192, v129
    v_mul_f32 v53, v193, v129
    v_mul_f32 v54, v194, v129
    v_mul_f32 v55, v195, v129
    v_fma_f32 v124, v124, v188, v52
    v_fma_f32 v125, v125, v189, v53
    v_fma_f32 v126, v126, v190, v54
    v_fma_f32 v127, v127, v191, v55
    v_cvt_pk_bf16_f32 v44, v112, v113
    v_cvt_pk_bf16_f32 v45, v114, v115
    v_cvt_pk_bf16_f32 v46, v116, v117
    v_cvt_pk_bf16_f32 v47, v118, v119
    buffer_store_dwordx4 v[44:47], v59, s[20:23], s41 offen offset:0
    v_cvt_pk_bf16_f32 v48, v120, v121
    v_cvt_pk_bf16_f32 v49, v122, v123
    v_cvt_pk_bf16_f32 v50, v124, v125
    v_cvt_pk_bf16_f32 v51, v126, v127
    buffer_store_dwordx4 v[48:51], v59, s[20:23], s41 offen offset:640
    s_endpgm
K1_MAIN_N:
    s_mov_b32 s48, 0
    s_mov_b32 s49, -1
    s_waitcnt vmcnt(6)
    s_barrier
    ds_read_b128 v[20:23], v10 offset:0
    ds_read_b128 v[24:27], v200 offset:0
    ds_read_b64_tr_b16 v[28:29], v18 offset:0
    ds_read_b64_tr_b16 v[30:31], v18 offset:512
    ds_read_b64_tr_b16 v[32:33], v19 offset:0
    ds_read_b64_tr_b16 v[34:35], v19 offset:512
    ds_read_b128 v[36:39], v11 offset:0
    ds_read_b128 v[40:43], v201 offset:0
    ds_read_b64_tr_b16 v[44:45], v18 offset:2048
    ds_read_b64_tr_b16 v[46:47], v18 offset:2560
    ds_read_b64_tr_b16 v[48:49], v19 offset:2048
    ds_read_b64_tr_b16 v[50:51], v19 offset:2560
    s_waitcnt lgkmcnt(6)
    v_mfma_f32_32x32x16_bf16 v[64:79], v[28:31], v[20:23], v[64:79]
    v_mfma_f32_32x32x16_bf16 v[80:95], v[32:35], v[20:23], v[80:95]
    v_mfma_f32_32x32x16_bf16 v[96:111], v[28:31], v[24:27], v[96:111]
    v_mfma_f32_32x32x16_bf16 v[112:127], v[32:35], v[24:27], v[112:127]
    s_cmp_lg_u32 s36, 0
    s_cbranch_scc1 K1_CS_41
    v_lshlrev_b32 v218, 16, v28
    v_and_b32 v219, 0xffff0000, v28
    v_add_f32 v212, v212, v218
    v_add_f32 v213, v213, v219
    v_lshlrev_b32 v218, 16, v29
    v_and_b32 v219, 0xffff0000, v29
    v_add_f32 v212, v212, v218
    v_add_f32 v213, v213, v219
    v_lshlrev_b32 v218, 16, v30
    v_and_b32 v219, 0xffff0000, v30
    v_add_f32 v212, v212, v218
    v_add_f32 v213, v213, v219
    v_lshlrev_b32 v218, 16, v31
    v_and_b32 v219, 0xffff0000, v31
    v_add_f32 v212, v212, v218
    v_add_f32 v213, v213, v219
    v_lshlrev_b32 v218, 16, v32
    v_and_b32 v219, 0xffff0000, v32
    v_add_f32 v214, v214, v218
    v_add_f32 v215, v215, v219
    v_lshlrev_b32 v218, 16, v33
    v_and_b32 v219, 0xffff0000, v33
    v_add_f32 v214, v214, v218
    v_add_f32 v215, v215, v219
    v_lshlrev_b32 v218, 16, v34
    v_and_b32 v219, 0xffff0000, v34
    v_add_f32 v214, v214, v218
    v_add_f32 v215, v215, v219
    v_lshlrev_b32 v218, 16, v35
    v_and_b32 v219, 0xffff0000, v35
    v_add_f32 v214, v214, v218
    v_add_f32 v215, v215, v219
K1_CS_41:
    s_add_u32 m0, s32, 65536
    s_nop 0
    buffer_load_dwordx4 v4, s[12:15], s29 offen offset:0 lds
    buffer_load_dwordx4 v5, s[12:15], s29 offen offset:1024 lds
    ds_read_b128 v[20:23], v12 offset:0
    ds_read_b128 v[24:27], v202 offset:0
    ds_read_b64_tr_b16 v[28:29], v18 offset:4096
    ds_read_b64_tr_b16 v[30:31], v18 offset:4608
    ds_read_b64_tr_b16 v[32:33], v19 offset:4096
    ds_read_b64_tr_b16 v[34:35], v19 offset:4608
    s_waitcnt lgkmcnt(6)
    v_mfma_f32_32x32x16_bf16 v[64:79], v[44:47], v[36:39], v[64:79]
    v_mfma_f32_32x32x16_bf16 v[80:95], v[48:51], v[36:39], v[80:95]
    v_mfma_f32_32x32x16_bf16 v[96:111], v[44:47], v[40:43], v[96:111]
    v_mfma_f32_32x32x16_bf16 v[112:127], v[48:51], v[40:43], v[112:127]
    s_cmp_lg_u32 s36, 1
    s_cbranch_scc1 K1_CS_42
    v_lshlrev_b32 v218, 16, v44
    v_and_b32 v219, 0xffff0000, v44
    v_add_f32 v212, v212, v218
    v_add_f32 v213, v213, v219
    v_lshlrev_b32 v218, 16, v45
    v_and_b32 v219, 0xffff0000, v45
    v_add_f32 v212, v212, v218
    v_add_f32 v213, v213, v219
    v_lshlrev_b32 v218, 16, v46
    v_and_b32 v219, 0xffff0000, v46
    v_add_f32 v212, v212, v218
    v_add_f32 v213, v213, v219
    v_lshlrev_b32 v218, 16, v47
    v_and_b32 v219, 0xffff0000, v47
    v_add_f32 v212, v212, v218
    v_add_f32 v213, v213, v219
    v_lshlrev_b32 v218, 16, v48
    v_and_b32 v219, 0xffff0000, v48
    v_add_f32 v214, v214, v218
    v_add_f32 v215, v215, v219
    v_lshlrev_b32 v218, 16, v49
    v_and_b32 v219, 0xffff0000, v49
    v_add_f32 v214, v214, v218
    v_add_f32 v215, v215, v219
    v_lshlrev_b32 v218, 16, v50
    v_and_b32 v219, 0xffff0000, v50
    v_add_f32 v214, v214, v218
    v_add_f32 v215, v215, v219
    v_lshlrev_b32 v218, 16, v51
    v_and_b32 v219, 0xffff0000, v51
    v_add_f32 v214, v214, v218
    v_add_f32 v215, v215, v219
K1_CS_42:
    s_add_u32 m0, s32, 65536
    s_nop 0
    buffer_load_dwordx4 v6, s[12:15], s29 offen offset:2048 lds
    buffer_load_dwordx4 v7, s[12:15], s29 offen offset:3072 lds
    s_add_u32 s29, s29, 128
    ds_read_b128 v[36:39], v13 offset:0
    ds_read_b128 v[40:43], v203 offset:0
    ds_read_b64_tr_b16 v[44:45], v18 offset:6144
    ds_read_b64_tr_b16 v[46:47], v18 offset:6656
    ds_read_b64_tr_b16 v[48:49], v19 offset:6144
    ds_read_b64_tr_b16 v[50:51], v19 offset:6656
    s_waitcnt lgkmcnt(6)
    v_mfma_f32_32x32x16_bf16 v[64:79], v[28:31], v[20:23], v[64:79]
    v_mfma_f32_32x32x16_bf16 v[80:95], v[32:35], v[20:23], v[80:95]
    v_mfma_f32_32x32x16_bf16 v[96:111], v[28:31], v[24:27], v[96:111]
    v_mfma_f32_32x32x16_bf16 v[112:127], v[32:35], v[24:27], v[112:127]
    s_cmp_lg_u32 s36, 2
    s_cbranch_scc1 K1_CS_43
    v_lshlrev_b32 v218, 16, v28
    v_and_b32 v219, 0xffff0000, v28
    v_add_f32 v212, v212, v218
    v_add_f32 v213, v213, v219
    v_lshlrev_b32 v218, 16, v29
    v_and_b32 v219, 0xffff0000, v29
    v_add_f32 v212, v212, v218
    v_add_f32 v213, v213, v219
    v_lshlrev_b32 v218, 16, v30
    v_and_b32 v219, 0xffff0000, v30
    v_add_f32 v212, v212, v218
    v_add_f32 v213, v213, v219
    v_lshlrev_b32 v218, 16, v31
    v_and_b32 v219, 0xffff0000, v31
    v_add_f32 v212, v212, v218
    v_add_f32 v213, v213, v219
    v_lshlrev_b32 v218, 16, v32
    v_and_b32 v219, 0xffff0000, v32
    v_add_f32 v214, v214, v218
    v_add_f32 v215, v215, v219
    v_lshlrev_b32 v218, 16, v33
    v_and_b32 v219, 0xffff0000, v33
    v_add_f32 v214, v214, v218
    v_add_f32 v215, v215, v219
    v_lshlrev_b32 v218, 16, v34
    v_and_b32 v219, 0xffff0000, v34
    v_add_f32 v214, v214, v218
    v_add_f32 v215, v215, v219
    v_lshlrev_b32 v218, 16, v35
    v_and_b32 v219, 0xffff0000, v35
    v_add_f32 v214, v214, v218
    v_add_f32 v215, v215, v219
K1_CS_43:
    s_add_u32 m0, s33, 32768
    s_nop 0
    buffer_load_dwordx4 v8, s[16:19], s30 offen offset:0 lds
    buffer_load_dwordx4 v9, s[16:19], s30 offen offset:1024 lds
    s_add_u32 s30, s30, s31
    s_waitcnt vmcnt(6) lgkmcnt(0)
    s_barrier
    ds_read_b128 v[20:23], v10 offset:32768
    ds_read_b128 v[24:27], v200 offset:32768
    ds_read_b64_tr_b16 v[28:29], v18 offset:16384
    ds_read_b64_tr_b16 v[30:31], v18 offset:16896
    ds_read_b64_tr_b16 v[32:33], v19 offset:16384
    ds_read_b64_tr_b16 v[34:35], v19 offset:16896
    v_mfma_f32_32x32x16_bf16 v[64:79], v[44:47], v[36:39], v[64:79]
    v_mfma_f32_32x32x16_bf16 v[80:95], v[48:51], v[36:39], v[80:95]
    v_mfma_f32_32x32x16_bf16 v[96:111], v[44:47], v[40:43], v[96:111]
    v_mfma_f32_32x32x16_bf16 v[112:127], v[48:51], v[40:43], v[112:127]
    s_cmp_lg_u32 s36, 3
    s_cbranch_scc1 K1_CS_44
    v_lshlrev_b32 v218, 16, v44
    v_and_b32 v219, 0xffff0000, v44
    v_add_f32 v212, v212, v218
    v_add_f32 v213, v213, v219
    v_lshlrev_b32 v218, 16, v45
    v_and_b32 v219, 0xffff0000, v45
    v_add_f32 v212, v212, v218
    v_add_f32 v213, v213, v219
    v_lshlrev_b32 v218, 16, v46
    v_and_b32 v219, 0xffff0000, v46
    v_add_f32 v212, v212, v218
    v_add_f32 v213, v213, v219
    v_lshlrev_b32 v218, 16, v47
    v_and_b32 v219, 0xffff0000, v47
    v_add_f32 v212, v212, v218
    v_add_f32 v213, v213, v219
    v_lshlrev_b32 v218, 16, v48
    v_and_b32 v219, 0xffff0000, v48
    v_add_f32 v214, v214, v218
    v_add_f32 v215, v215, v219
    v_lshlrev_b32 v218, 16, v49
    v_and_b32 v219, 0xffff0000, v49
    v_add_f32 v214, v214, v218
    v_add_f32 v215, v215, v219
    v_lshlrev_b32 v218, 16, v50
    v_and_b32 v219, 0xffff0000, v50
    v_add_f32 v214, v214, v218
    v_add_f32 v215, v215, v219
    v_lshlrev_b32 v218, 16, v51
    v_and_b32 v219, 0xffff0000, v51
    v_add_f32 v214, v214, v218
    v_add_f32 v215, v215, v219
K1_CS_44:
    ds_read_b128 v[36:39], v11 offset:32768
    ds_read_b128 v[40:43], v201 offset:32768
    ds_read_b64_tr_b16 v[44:45], v18 offset:18432
    ds_read_b64_tr_b16 v[46:47], v18 offset:18944
    ds_read_b64_tr_b16 v[48:49], v19 offset:18432
    ds_read_b64_tr_b16 v[50:51], v19 offset:18944
    s_waitcnt lgkmcnt(6)
    v_mfma_f32_32x32x16_bf16 v[64:79], v[28:31], v[20:23], v[64:79]
    v_mfma_f32_32x32x16_bf16 v[80:95], v[32:35], v[20:23], v[80:95]
    v_mfma_f32_32x32x16_bf16 v[96:111], v[28:31], v[24:27], v[96:111]
    v_mfma_f32_32x32x16_bf16 v[112:127], v[32:35], v[24:27], v[112:127]
    s_cmp_lg_u32 s36, 0
    s_cbranch_scc1 K1_CS_45
    v_lshlrev_b32 v218, 16, v28
    v_and_b32 v219, 0xffff0000, v28
    v_add_f32 v212, v212, v218
    v_add_f32 v213, v213, v219
    v_lshlrev_b32 v218, 16, v29
    v_and_b32 v219, 0xffff0000, v29
    v_add_f32 v212, v212, v218
    v_add_f32 v213, v213, v219
    v_lshlrev_b32 v218, 16, v30
    v_and_b32 v219, 0xffff0000, v30
    v_add_f32 v212, v212, v218
    v_add_f32 v213, v213, v219
    v_lshlrev_b32 v218, 16, v31
    v_and_b32 v219, 0xffff0000, v31
    v_add_f32 v212, v212, v218
    v_add_f32 v213, v213, v219
    v_lshlrev_b32 v218, 16, v32
    v_and_b32 v219, 0xffff0000, v32
    v_add_f32 v214, v214, v218
    v_add_f32 v215, v215, v219
    v_lshlrev_b32 v218, 16, v33
    v_and_b32 v219, 0xffff0000, v33
    v_add_f32 v214, v214, v218
    v_add_f32 v215, v215, v219
    v_lshlrev_b32 v218, 16, v34
    v_and_b32 v219, 0xffff0000, v34
    v_add_f32 v214, v214, v218
    v_add_f32 v215, v215, v219
    v_lshlrev_b32 v218, 16, v35
    v_and_b32 v219, 0xffff0000, v35
    v_add_f32 v214, v214, v218
    v_add_f32 v215, v215, v219
K1_CS_45:
    s_add_u32 m0, s32, 0
    s_nop 0
    buffer_load_dwordx4 v4, s[12:15], s29 offen offset:0 lds
    buffer_load_dwordx4 v5, s[12:15], s29 offen offset:1024 lds
    ds_read_b128 v[20:23], v12 offset:32768
    ds_read_b128 v[24:27], v202 offset:32768
    ds_read_b64_tr_b16 v[28:29], v18 offset:20480
    ds_read_b64_tr_b16 v[30:31], v18 offset:20992
    ds_read_b64_tr_b16 v[32:33], v19 offset:20480
    ds_read_b64_tr_b16 v[34:35], v19 offset:20992
    s_waitcnt lgkmcnt(6)
    v_mfma_f32_32x32x16_bf16 v[64:79], v[44:47], v[36:39], v[64:79]
    v_mfma_f32_32x32x16_bf16 v[80:95], v[48:51], v[36:39], v[80:95]
    v_mfma_f32_32x32x16_bf16 v[96:111], v[44:47], v[40:43], v[96:111]
    v_mfma_f32_32x32x16_bf16 v[112:127], v[48:51], v[40:43], v[112:127]
    s_cmp_lg_u32 s36, 1
    s_cbranch_scc1 K1_CS_46
    v_lshlrev_b32 v218, 16, v44
    v_and_b32 v219, 0xffff0000, v44
    v_add_f32 v212, v212, v218
    v_add_f32 v213, v213, v219
    v_lshlrev_b32 v218, 16, v45
    v_and_b32 v219, 0xffff0000, v45
    v_add_f32 v212, v212, v218
    v_add_f32 v213, v213, v219
    v_lshlrev_b32 v218, 16, v46
    v_and_b32 v219, 0xffff0000, v46
    v_add_f32 v212, v212, v218
    v_add_f32 v213, v213, v219
    v_lshlrev_b32 v218, 16, v47
    v_and_b32 v219, 0xffff0000, v47
    v_add_f32 v212, v212, v218
    v_add_f32 v213, v213, v219
    v_lshlrev_b32 v218, 16, v48
    v_and_b32 v219, 0xffff0000, v48
    v_add_f32 v214, v214, v218
    v_add_f32 v215, v215, v219
    v_lshlrev_b32 v218, 16, v49
    v_and_b32 v219, 0xffff0000, v49
    v_add_f32 v214, v214, v218
    v_add_f32 v215, v215, v219
    v_lshlrev_b32 v218, 16, v50
    v_and_b32 v219, 0xffff0000, v50
    v_add_f32 v214, v214, v218
    v_add_f32 v215, v215, v219
    v_lshlrev_b32 v218, 16, v51
    v_and_b32 v219, 0xffff0000, v51
    v_add_f32 v214, v214, v218
    v_add_f32 v215, v215, v219
K1_CS_46:
    s_add_u32 m0, s32, 0
    s_nop 0
    buffer_load_dwordx4 v6, s[12:15], s29 offen offset:2048 lds
    buffer_load_dwordx4 v7, s[12:15], s29 offen offset:3072 lds
    s_add_u32 s29, s29, 128
    ds_read_b128 v[36:39], v13 offset:32768
    ds_read_b128 v[40:43], v203 offset:32768
    ds_read_b64_tr_b16 v[44:45], v18 offset:22528
    ds_read_b64_tr_b16 v[46:47], v18 offset:23040
    ds_read_b64_tr_b16 v[48:49], v19 offset:22528
    ds_read_b64_tr_b16 v[50:51], v19 offset:23040
    s_waitcnt lgkmcnt(6)
    v_mfma_f32_32x32x16_bf16 v[64:79], v[28:31], v[20:23], v[64:79]
    v_mfma_f32_32x32x16_bf16 v[80:95], v[32:35], v[20:23], v[80:95]
    v_mfma_f32_32x32x16_bf16 v[96:111], v[28:31], v[24:27], v[96:111]
    v_mfma_f32_32x32x16_bf16 v[112:127], v[32:35], v[24:27], v[112:127]
    s_cmp_lg_u32 s36, 2
    s_cbranch_scc1 K1_CS_47
    v_lshlrev_b32 v218, 16, v28
    v_and_b32 v219, 0xffff0000, v28
    v_add_f32 v212, v212, v218
    v_add_f32 v213, v213, v219
    v_lshlrev_b32 v218, 16, v29
    v_and_b32 v219, 0xffff0000, v29
    v_add_f32 v212, v212, v218
    v_add_f32 v213, v213, v219
    v_lshlrev_b32 v218, 16, v30
    v_and_b32 v219, 0xffff0000, v30
    v_add_f32 v212, v212, v218
    v_add_f32 v213, v213, v219
    v_lshlrev_b32 v218, 16, v31
    v_and_b32 v219, 0xffff0000, v31
    v_add_f32 v212, v212, v218
    v_add_f32 v213, v213, v219
    v_lshlrev_b32 v218, 16, v32
    v_and_b32 v219, 0xffff0000, v32
    v_add_f32 v214, v214, v218
    v_add_f32 v215, v215, v219
    v_lshlrev_b32 v218, 16, v33
    v_and_b32 v219, 0xffff0000, v33
    v_add_f32 v214, v214, v218
    v_add_f32 v215, v215, v219
    v_lshlrev_b32 v218, 16, v34
    v_and_b32 v219, 0xffff0000, v34
    v_add_f32 v214, v214, v218
    v_add_f32 v215, v215, v219
    v_lshlrev_b32 v218, 16, v35
    v_and_b32 v219, 0xffff0000, v35
    v_add_f32 v214, v214, v218
    v_add_f32 v215, v215, v219
K1_CS_47:
    s_add_u32 m0, s33, 0
    s_nop 0
    buffer_load_dwordx4 v8, s[16:19], s30 offen offset:0 lds
    buffer_load_dwordx4 v9, s[16:19], s30 offen offset:1024 lds
    s_add_u32 s30, s30, s31
    s_waitcnt vmcnt(6) lgkmcnt(0)
    s_barrier
    ds_read_b128 v[20:23], v14 offset:0
    ds_read_b128 v[24:27], v204 offset:0
    ds_read_b64_tr_b16 v[28:29], v18 offset:32768
    ds_read_b64_tr_b16 v[30:31], v18 offset:33280
    ds_read_b64_tr_b16 v[32:33], v19 offset:32768
    ds_read_b64_tr_b16 v[34:35], v19 offset:33280
    v_mfma_f32_32x32x16_bf16 v[64:79], v[44:47], v[36:39], v[64:79]
    v_mfma_f32_32x32x16_bf16 v[80:95], v[48:51], v[36:39], v[80:95]
    v_mfma_f32_32x32x16_bf16 v[96:111], v[44:47], v[40:43], v[96:111]
    v_mfma_f32_32x32x16_bf16 v[112:127], v[48:51], v[40:43], v[112:127]
    s_cmp_lg_u32 s36, 3
    s_cbranch_scc1 K1_CS_48
    v_lshlrev_b32 v218, 16, v44
    v_and_b32 v219, 0xffff0000, v44
    v_add_f32 v212, v212, v218
    v_add_f32 v213, v213, v219
    v_lshlrev_b32 v218, 16, v45
    v_and_b32 v219, 0xffff0000, v45
    v_add_f32 v212, v212, v218
    v_add_f32 v213, v213, v219
    v_lshlrev_b32 v218, 16, v46
    v_and_b32 v219, 0xffff0000, v46
    v_add_f32 v212, v212, v218
    v_add_f32 v213, v213, v219
    v_lshlrev_b32 v218, 16, v47
    v_and_b32 v219, 0xffff0000, v47
    v_add_f32 v212, v212, v218
    v_add_f32 v213, v213, v219
    v_lshlrev_b32 v218, 16, v48
    v_and_b32 v219, 0xffff0000, v48
    v_add_f32 v214, v214, v218
    v_add_f32 v215, v215, v219
    v_lshlrev_b32 v218, 16, v49
    v_and_b32 v219, 0xffff0000, v49
    v_add_f32 v214, v214, v218
    v_add_f32 v215, v215, v219
    v_lshlrev_b32 v218, 16, v50
    v_and_b32 v219, 0xffff0000, v50
    v_add_f32 v214, v214, v218
    v_add_f32 v215, v215, v219
    v_lshlrev_b32 v218, 16, v51
    v_and_b32 v219, 0xffff0000, v51
    v_add_f32 v214, v214, v218
    v_add_f32 v215, v215, v219
K1_CS_48:
    ds_read_b128 v[36:39], v15 offset:0
    ds_read_b128 v[40:43], v205 offset:0
    ds_read_b64_tr_b16 v[44:45], v18 offset:34816
    ds_read_b64_tr_b16 v[46:47], v18 offset:35328
    ds_read_b64_tr_b16 v[48:49], v19 offset:34816
    ds_read_b64_tr_b16 v[50:51], v19 offset:35328
    s_waitcnt lgkmcnt(6)
    v_mfma_f32_32x32x16_bf16 v[64:79], v[28:31], v[20:23], v[64:79]
    v_mfma_f32_32x32x16_bf16 v[80:95], v[32:35], v[20:23], v[80:95]
    v_mfma_f32_32x32x16_bf16 v[96:111], v[28:31], v[24:27], v[96:111]
    v_mfma_f32_32x32x16_bf16 v[112:127], v[32:35], v[24:27], v[112:127]
    s_cmp_lg_u32 s36, 0
    s_cbranch_scc1 K1_CS_49
    v_lshlrev_b32 v218, 16, v28
    v_and_b32 v219, 0xffff0000, v28
    v_add_f32 v212, v212, v218
    v_add_f32 v213, v213, v219
    v_lshlrev_b32 v218, 16, v29
    v_and_b32 v219, 0xffff0000, v29
    v_add_f32 v212, v212, v218
    v_add_f32 v213, v213, v219
    v_lshlrev_b32 v218, 16, v30
    v_and_b32 v219, 0xffff0000, v30
    v_add_f32 v212, v212, v218
    v_add_f32 v213, v213, v219
    v_lshlrev_b32 v218, 16, v31
    v_and_b32 v219, 0xffff0000, v31
    v_add_f32 v212, v212, v218
    v_add_f32 v213, v213, v219
    v_lshlrev_b32 v218, 16, v32
    v_and_b32 v219, 0xffff0000, v32
    v_add_f32 v214, v214, v218
    v_add_f32 v215, v215, v219
    v_lshlrev_b32 v218, 16, v33
    v_and_b32 v219, 0xffff0000, v33
    v_add_f32 v214, v214, v218
    v_add_f32 v215, v215, v219
    v_lshlrev_b32 v218, 16, v34
    v_and_b32 v219, 0xffff0000, v34
    v_add_f32 v214, v214, v218
    v_add_f32 v215, v215, v219
    v_lshlrev_b32 v218, 16, v35
    v_and_b32 v219, 0xffff0000, v35
    v_add_f32 v214, v214, v218
    v_add_f32 v215, v215, v219
K1_CS_49:
    s_add_u32 m0, s32, 32768
    s_nop 0
    buffer_load_dwordx4 v4, s[12:15], s29 offen offset:0 lds
    buffer_load_dwordx4 v5, s[12:15], s29 offen offset:1024 lds
    ds_read_b128 v[20:23], v16 offset:0
    ds_read_b128 v[24:27], v206 offset:0
    ds_read_b64_tr_b16 v[28:29], v18 offset:36864
    ds_read_b64_tr_b16 v[30:31], v18 offset:37376
    ds_read_b64_tr_b16 v[32:33], v19 offset:36864
    ds_read_b64_tr_b16 v[34:35], v19 offset:37376
    s_waitcnt lgkmcnt(6)
    v_mfma_f32_32x32x16_bf16 v[64:79], v[44:47], v[36:39], v[64:79]
    v_mfma_f32_32x32x16_bf16 v[80:95], v[48:51], v[36:39], v[80:95]
    v_mfma_f32_32x32x16_bf16 v[96:111], v[44:47], v[40:43], v[96:111]
    v_mfma_f32_32x32x16_bf16 v[112:127], v[48:51], v[40:43], v[112:127]
    s_cmp_lg_u32 s36, 1
    s_cbranch_scc1 K1_CS_50
    v_lshlrev_b32 v218, 16, v44
    v_and_b32 v219, 0xffff0000, v44
    v_add_f32 v212, v212, v218
    v_add_f32 v213, v213, v219
    v_lshlrev_b32 v218, 16, v45
    v_and_b32 v219, 0xffff0000, v45
    v_add_f32 v212, v212, v218
    v_add_f32 v213, v213, v219
    v_lshlrev_b32 v218, 16, v46
    v_and_b32 v219, 0xffff0000, v46
    v_add_f32 v212, v212, v218
    v_add_f32 v213, v213, v219
    v_lshlrev_b32 v218, 16, v47
    v_and_b32 v219, 0xffff0000, v47
    v_add_f32 v212, v212, v218
    v_add_f32 v213, v213, v219
    v_lshlrev_b32 v218, 16, v48
    v_and_b32 v219, 0xffff0000, v48
    v_add_f32 v214, v214, v218
    v_add_f32 v215, v215, v219
    v_lshlrev_b32 v218, 16, v49
    v_and_b32 v219, 0xffff0000, v49
    v_add_f32 v214, v214, v218
    v_add_f32 v215, v215, v219
    v_lshlrev_b32 v218, 16, v50
    v_and_b32 v219, 0xffff0000, v50
    v_add_f32 v214, v214, v218
    v_add_f32 v215, v215, v219
    v_lshlrev_b32 v218, 16, v51
    v_and_b32 v219, 0xffff0000, v51
    v_add_f32 v214, v214, v218
    v_add_f32 v215, v215, v219
K1_CS_50:
    s_add_u32 m0, s32, 32768
    s_nop 0
    buffer_load_dwordx4 v6, s[12:15], s29 offen offset:2048 lds
    buffer_load_dwordx4 v7, s[12:15], s29 offen offset:3072 lds
    s_add_u32 s29, s29, 128
    ds_read_b128 v[36:39], v17 offset:0
    ds_read_b128 v[40:43], v207 offset:0
    ds_read_b64_tr_b16 v[44:45], v18 offset:38912
    ds_read_b64_tr_b16 v[46:47], v18 offset:39424
    ds_read_b64_tr_b16 v[48:49], v19 offset:38912
    ds_read_b64_tr_b16 v[50:51], v19 offset:39424
    s_waitcnt lgkmcnt(6)
    v_mfma_f32_32x32x16_bf16 v[64:79], v[28:31], v[20:23], v[64:79]
    v_mfma_f32_32x32x16_bf16 v[80:95], v[32:35], v[20:23], v[80:95]
    v_mfma_f32_32x32x16_bf16 v[96:111], v[28:31], v[24:27], v[96:111]
    v_mfma_f32_32x32x16_bf16 v[112:127], v[32:35], v[24:27], v[112:127]
    s_cmp_lg_u32 s36, 2
    s_cbranch_scc1 K1_CS_51
    v_lshlrev_b32 v218, 16, v28
    v_and_b32 v219, 0xffff0000, v28
    v_add_f32 v212, v212, v218
    v_add_f32 v213, v213, v219
    v_lshlrev_b32 v218, 16, v29
    v_and_b32 v219, 0xffff0000, v29
    v_add_f32 v212, v212, v218
    v_add_f32 v213, v213, v219
    v_lshlrev_b32 v218, 16, v30
    v_and_b32 v219, 0xffff0000, v30
    v_add_f32 v212, v212, v218
    v_add_f32 v213, v213, v219
    v_lshlrev_b32 v218, 16, v31
    v_and_b32 v219, 0xffff0000, v31
    v_add_f32 v212, v212, v218
    v_add_f32 v213, v213, v219
    v_lshlrev_b32 v218, 16, v32
    v_and_b32 v219, 0xffff0000, v32
    v_add_f32 v214, v214, v218
    v_add_f32 v215, v215, v219
    v_lshlrev_b32 v218, 16, v33
    v_and_b32 v219, 0xffff0000, v33
    v_add_f32 v214, v214, v218
    v_add_f32 v215, v215, v219
    v_lshlrev_b32 v218, 16, v34
    v_and_b32 v219, 0xffff0000, v34
    v_add_f32 v214, v214, v218
    v_add_f32 v215, v215, v219
    v_lshlrev_b32 v218, 16, v35
    v_and_b32 v219, 0xffff0000, v35
    v_add_f32 v214, v214, v218
    v_add_f32 v215, v215, v219
K1_CS_51:
    s_add_u32 m0, s33, 16384
    s_nop 0
    buffer_load_dwordx4 v8, s[16:19], s30 offen offset:0 lds
    buffer_load_dwordx4 v9, s[16:19], s30 offen offset:1024 lds
    s_add_u32 s30, s30, s31
    s_waitcnt vmcnt(6) lgkmcnt(0)
    s_barrier
    ds_read_b128 v[20:23], v10 offset:0
    ds_read_b128 v[24:27], v200 offset:0
    ds_read_b64_tr_b16 v[28:29], v18 offset:0
    ds_read_b64_tr_b16 v[30:31], v18 offset:512
    ds_read_b64_tr_b16 v[32:33], v19 offset:0
    ds_read_b64_tr_b16 v[34:35], v19 offset:512
    v_mfma_f32_32x32x16_bf16 v[64:79], v[44:47], v[36:39], v[64:79]
    v_mfma_f32_32x32x16_bf16 v[80:95], v[48:51], v[36:39], v[80:95]
    v_mfma_f32_32x32x16_bf16 v[96:111], v[44:47], v[40:43], v[96:111]
    v_mfma_f32_32x32x16_bf16 v[112:127], v[48:51], v[40:43], v[112:127]
    s_cmp_lg_u32 s36, 3
    s_cbranch_scc1 K1_CS_52
    v_lshlrev_b32 v218, 16, v44
    v_and_b32 v219, 0xffff0000, v44
    v_add_f32 v212, v212, v218
    v_add_f32 v213, v213, v219
    v_lshlrev_b32 v218, 16, v45
    v_and_b32 v219, 0xffff0000, v45
    v_add_f32 v212, v212, v218
    v_add_f32 v213, v213, v219
    v_lshlrev_b32 v218, 16, v46
    v_and_b32 v219, 0xffff0000, v46
    v_add_f32 v212, v212, v218
    v_add_f32 v213, v213, v219
    v_lshlrev_b32 v218, 16, v47
    v_and_b32 v219, 0xffff0000, v47
    v_add_f32 v212, v212, v218
    v_add_f32 v213, v213, v219
    v_lshlrev_b32 v218, 16, v48
    v_and_b32 v219, 0xffff0000, v48
    v_add_f32 v214, v214, v218
    v_add_f32 v215, v215, v219
    v_lshlrev_b32 v218, 16, v49
    v_and_b32 v219, 0xffff0000, v49
    v_add_f32 v214, v214, v218
    v_add_f32 v215, v215, v219
    v_lshlrev_b32 v218, 16, v50
    v_and_b32 v219, 0xffff0000, v50
    v_add_f32 v214, v214, v218
    v_add_f32 v215, v215, v219
    v_lshlrev_b32 v218, 16, v51
    v_and_b32 v219, 0xffff0000, v51
    v_add_f32 v214, v214, v218
    v_add_f32 v215, v215, v219
K1_CS_52:
    ds_read_b128 v[36:39], v11 offset:0
    ds_read_b128 v[40:43], v201 offset:0
    ds_read_b64_tr_b16 v[44:45], v18 offset:2048
    ds_read_b64_tr_b16 v[46:47], v18 offset:2560
    ds_read_b64_tr_b16 v[48:49], v19 offset:2048
    ds_read_b64_tr_b16 v[50:51], v19 offset:2560
    s_waitcnt lgkmcnt(6)
    v_mfma_f32_32x32x16_bf16 v[64:79], v[28:31], v[20:23], v[64:79]
    v_mfma_f32_32x32x16_bf16 v[80:95], v[32:35], v[20:23], v[80:95]
    v_mfma_f32_32x32x16_bf16 v[96:111], v[28:31], v[24:27], v[96:111]
    v_mfma_f32_32x32x16_bf16 v[112:127], v[32:35], v[24:27], v[112:127]
    s_cmp_lg_u32 s36, 0
    s_cbranch_scc1 K1_CS_53
    v_lshlrev_b32 v218, 16, v28
    v_and_b32 v219, 0xffff0000, v28
    v_add_f32 v212, v212, v218
    v_add_f32 v213, v213, v219
    v_lshlrev_b32 v218, 16, v29
    v_and_b32 v219, 0xffff0000, v29
    v_add_f32 v212, v212, v218
    v_add_f32 v213, v213, v219
    v_lshlrev_b32 v218, 16, v30
    v_and_b32 v219, 0xffff0000, v30
    v_add_f32 v212, v212, v218
    v_add_f32 v213, v213, v219
    v_lshlrev_b32 v218, 16, v31
    v_and_b32 v219, 0xffff0000, v31
    v_add_f32 v212, v212, v218
    v_add_f32 v213, v213, v219
    v_lshlrev_b32 v218, 16, v32
    v_and_b32 v219, 0xffff0000, v32
    v_add_f32 v214, v214, v218
    v_add_f32 v215, v215, v219
    v_lshlrev_b32 v218, 16, v33
    v_and_b32 v219, 0xffff0000, v33
    v_add_f32 v214, v214, v218
    v_add_f32 v215, v215, v219
    v_lshlrev_b32 v218, 16, v34
    v_and_b32 v219, 0xffff0000, v34
    v_add_f32 v214, v214, v218
    v_add_f32 v215, v215, v219
    v_lshlrev_b32 v218, 16, v35
    v_and_b32 v219, 0xffff0000, v35
    v_add_f32 v214, v214, v218
    v_add_f32 v215, v215, v219
K1_CS_53:
    s_add_u32 m0, s32, 65536
    s_nop 0
    buffer_load_dwordx4 v4, s[12:15], s29 offen offset:0 lds
    buffer_load_dwordx4 v5, s[12:15], s29 offen offset:1024 lds
    ds_read_b128 v[20:23], v12 offset:0
    ds_read_b128 v[24:27], v202 offset:0
    ds_read_b64_tr_b16 v[28:29], v18 offset:4096
    ds_read_b64_tr_b16 v[30:31], v18 offset:4608
    ds_read_b64_tr_b16 v[32:33], v19 offset:4096
    ds_read_b64_tr_b16 v[34:35], v19 offset:4608
    s_waitcnt lgkmcnt(6)
    v_mfma_f32_32x32x16_bf16 v[64:79], v[44:47], v[36:39], v[64:79]
    v_mfma_f32_32x32x16_bf16 v[80:95], v[48:51], v[36:39], v[80:95]
    v_mfma_f32_32x32x16_bf16 v[96:111], v[44:47], v[40:43], v[96:111]
    v_mfma_f32_32x32x16_bf16 v[112:127], v[48:51], v[40:43], v[112:127]
    s_cmp_lg_u32 s36, 1
    s_cbranch_scc1 K1_CS_54
    v_lshlrev_b32 v218, 16, v44
    v_and_b32 v219, 0xffff0000, v44
    v_add_f32 v212, v212, v218
    v_add_f32 v213, v213, v219
    v_lshlrev_b32 v218, 16, v45
    v_and_b32 v219, 0xffff0000, v45
    v_add_f32 v212, v212, v218
    v_add_f32 v213, v213, v219
    v_lshlrev_b32 v218, 16, v46
    v_and_b32 v219, 0xffff0000, v46
    v_add_f32 v212, v212, v218
    v_add_f32 v213, v213, v219
    v_lshlrev_b32 v218, 16, v47
    v_and_b32 v219, 0xffff0000, v47
    v_add_f32 v212, v212, v218
    v_add_f32 v213, v213, v219
    v_lshlrev_b32 v218, 16, v48
    v_and_b32 v219, 0xffff0000, v48
    v_add_f32 v214, v214, v218
    v_add_f32 v215, v215, v219
    v_lshlrev_b32 v218, 16, v49
    v_and_b32 v219, 0xffff0000, v49
    v_add_f32 v214, v214, v218
    v_add_f32 v215, v215, v219
    v_lshlrev_b32 v218, 16, v50
    v_and_b32 v219, 0xffff0000, v50
    v_add_f32 v214, v214, v218
    v_add_f32 v215, v215, v219
    v_lshlrev_b32 v218, 16, v51
    v_and_b32 v219, 0xffff0000, v51
    v_add_f32 v214, v214, v218
    v_add_f32 v215, v215, v219
K1_CS_54:
    s_add_u32 m0, s32, 65536
    s_nop 0
    buffer_load_dwordx4 v6, s[12:15], s29 offen offset:2048 lds
    buffer_load_dwordx4 v7, s[12:15], s29 offen offset:3072 lds
    s_add_u32 s29, s29, 128
    ds_read_b128 v[36:39], v13 offset:0
    ds_read_b128 v[40:43], v203 offset:0
    ds_read_b64_tr_b16 v[44:45], v18 offset:6144
    ds_read_b64_tr_b16 v[46:47], v18 offset:6656
    ds_read_b64_tr_b16 v[48:49], v19 offset:6144
    ds_read_b64_tr_b16 v[50:51], v19 offset:6656
    s_waitcnt lgkmcnt(6)
    v_mfma_f32_32x32x16_bf16 v[64:79], v[28:31], v[20:23], v[64:79]
    v_mfma_f32_32x32x16_bf16 v[80:95], v[32:35], v[20:23], v[80:95]
    v_mfma_f32_32x32x16_bf16 v[96:111], v[28:31], v[24:27], v[96:111]
    v_mfma_f32_32x32x16_bf16 v[112:127], v[32:35], v[24:27], v[112:127]
    s_cmp_lg_u32 s36, 2
    s_cbranch_scc1 K1_CS_55
    v_lshlrev_b32 v218, 16, v28
    v_and_b32 v219, 0xffff0000, v28
    v_add_f32 v212, v212, v218
    v_add_f32 v213, v213, v219
    v_lshlrev_b32 v218, 16, v29
    v_and_b32 v219, 0xffff0000, v29
    v_add_f32 v212, v212, v218
    v_add_f32 v213, v213, v219
    v_lshlrev_b32 v218, 16, v30
    v_and_b32 v219, 0xffff0000, v30
    v_add_f32 v212, v212, v218
    v_add_f32 v213, v213, v219
    v_lshlrev_b32 v218, 16, v31
    v_and_b32 v219, 0xffff0000, v31
    v_add_f32 v212, v212, v218
    v_add_f32 v213, v213, v219
    v_lshlrev_b32 v218, 16, v32
    v_and_b32 v219, 0xffff0000, v32
    v_add_f32 v214, v214, v218
    v_add_f32 v215, v215, v219
    v_lshlrev_b32 v218, 16, v33
    v_and_b32 v219, 0xffff0000, v33
    v_add_f32 v214, v214, v218
    v_add_f32 v215, v215, v219
    v_lshlrev_b32 v218, 16, v34
    v_and_b32 v219, 0xffff0000, v34
    v_add_f32 v214, v214, v218
    v_add_f32 v215, v215, v219
    v_lshlrev_b32 v218, 16, v35
    v_and_b32 v219, 0xffff0000, v35
    v_add_f32 v214, v214, v218
    v_add_f32 v215, v215, v219
K1_CS_55:
    s_add_u32 m0, s33, 32768
    s_nop 0
    buffer_load_dwordx4 v8, s[16:19], s30 offen offset:0 lds
    buffer_load_dwordx4 v9, s[16:19], s30 offen offset:1024 lds
    s_add_u32 s30, s30, s31
    s_waitcnt vmcnt(6) lgkmcnt(0)
    s_barrier
    ds_read_b128 v[20:23], v10 offset:32768
    ds_read_b128 v[24:27], v200 offset:32768
    ds_read_b64_tr_b16 v[28:29], v18 offset:16384
    ds_read_b64_tr_b16 v[30:31], v18 offset:16896
    ds_read_b64_tr_b16 v[32:33], v19 offset:16384
    ds_read_b64_tr_b16 v[34:35], v19 offset:16896
    v_mfma_f32_32x32x16_bf16 v[64:79], v[44:47], v[36:39], v[64:79]
    v_mfma_f32_32x32x16_bf16 v[80:95], v[48:51], v[36:39], v[80:95]
    v_mfma_f32_32x32x16_bf16 v[96:111], v[44:47], v[40:43], v[96:111]
    v_mfma_f32_32x32x16_bf16 v[112:127], v[48:51], v[40:43], v[112:127]
    s_cmp_lg_u32 s36, 3
    s_cbranch_scc1 K1_CS_56
    v_lshlrev_b32 v218, 16, v44
    v_and_b32 v219, 0xffff0000, v44
    v_add_f32 v212, v212, v218
    v_add_f32 v213, v213, v219
    v_lshlrev_b32 v218, 16, v45
    v_and_b32 v219, 0xffff0000, v45
    v_add_f32 v212, v212, v218
    v_add_f32 v213, v213, v219
    v_lshlrev_b32 v218, 16, v46
    v_and_b32 v219, 0xffff0000, v46
    v_add_f32 v212, v212, v218
    v_add_f32 v213, v213, v219
    v_lshlrev_b32 v218, 16, v47
    v_and_b32 v219, 0xffff0000, v47
    v_add_f32 v212, v212, v218
    v_add_f32 v213, v213, v219
    v_lshlrev_b32 v218, 16, v48
    v_and_b32 v219, 0xffff0000, v48
    v_add_f32 v214, v214, v218
    v_add_f32 v215, v215, v219
    v_lshlrev_b32 v218, 16, v49
    v_and_b32 v219, 0xffff0000, v49
    v_add_f32 v214, v214, v218
    v_add_f32 v215, v215, v219
    v_lshlrev_b32 v218, 16, v50
    v_and_b32 v219, 0xffff0000, v50
    v_add_f32 v214, v214, v218
    v_add_f32 v215, v215, v219
    v_lshlrev_b32 v218, 16, v51
    v_and_b32 v219, 0xffff0000, v51
    v_add_f32 v214, v214, v218
    v_add_f32 v215, v215, v219
K1_CS_56:
    ds_read_b128 v[36:39], v11 offset:32768
    ds_read_b128 v[40:43], v201 offset:32768
    ds_read_b64_tr_b16 v[44:45], v18 offset:18432
    ds_read_b64_tr_b16 v[46:47], v18 offset:18944
    ds_read_b64_tr_b16 v[48:49], v19 offset:18432
    ds_read_b64_tr_b16 v[50:51], v19 offset:18944
    s_waitcnt lgkmcnt(6)
    v_mfma_f32_32x32x16_bf16 v[64:79], v[28:31], v[20:23], v[64:79]
    v_mfma_f32_32x32x16_bf16 v[80:95], v[32:35], v[20:23], v[80:95]
    v_mfma_f32_32x32x16_bf16 v[96:111], v[28:31], v[24:27], v[96:111]
    v_mfma_f32_32x32x16_bf16 v[112:127], v[32:35], v[24:27], v[112:127]
    s_cmp_lg_u32 s36, 0
    s_cbranch_scc1 K1_CS_57
    v_lshlrev_b32 v218, 16, v28
    v_and_b32 v219, 0xffff0000, v28
    v_add_f32 v212, v212, v218
    v_add_f32 v213, v213, v219
    v_lshlrev_b32 v218, 16, v29
    v_and_b32 v219, 0xffff0000, v29
    v_add_f32 v212, v212, v218
    v_add_f32 v213, v213, v219
    v_lshlrev_b32 v218, 16, v30
    v_and_b32 v219, 0xffff0000, v30
    v_add_f32 v212, v212, v218
    v_add_f32 v213, v213, v219
    v_lshlrev_b32 v218, 16, v31
    v_and_b32 v219, 0xffff0000, v31
    v_add_f32 v212, v212, v218
    v_add_f32 v213, v213, v219
    v_lshlrev_b32 v218, 16, v32
    v_and_b32 v219, 0xffff0000, v32
    v_add_f32 v214, v214, v218
    v_add_f32 v215, v215, v219
    v_lshlrev_b32 v218, 16, v33
    v_and_b32 v219, 0xffff0000, v33
    v_add_f32 v214, v214, v218
    v_add_f32 v215, v215, v219
    v_lshlrev_b32 v218, 16, v34
    v_and_b32 v219, 0xffff0000, v34
    v_add_f32 v214, v214, v218
    v_add_f32 v215, v215, v219
    v_lshlrev_b32 v218, 16, v35
    v_and_b32 v219, 0xffff0000, v35
    v_add_f32 v214, v214, v218
    v_add_f32 v215, v215, v219
K1_CS_57:
    s_add_u32 m0, s32, 0
    s_nop 0
    buffer_load_dwordx4 v4, s[12:15], s29 offen offset:0 lds
    buffer_load_dwordx4 v5, s[12:15], s29 offen offset:1024 lds
    ds_read_b128 v[20:23], v12 offset:32768
    ds_read_b128 v[24:27], v202 offset:32768
    ds_read_b64_tr_b16 v[28:29], v18 offset:20480
    ds_read_b64_tr_b16 v[30:31], v18 offset:20992
    ds_read_b64_tr_b16 v[32:33], v19 offset:20480
    ds_read_b64_tr_b16 v[34:35], v19 offset:20992
    s_waitcnt lgkmcnt(6)
    v_mfma_f32_32x32x16_bf16 v[64:79], v[44:47], v[36:39], v[64:79]
    v_mfma_f32_32x32x16_bf16 v[80:95], v[48:51], v[36:39], v[80:95]
    v_mfma_f32_32x32x16_bf16 v[96:111], v[44:47], v[40:43], v[96:111]
    v_mfma_f32_32x32x16_bf16 v[112:127], v[48:51], v[40:43], v[112:127]
    s_cmp_lg_u32 s36, 1
    s_cbranch_scc1 K1_CS_58
    v_lshlrev_b32 v218, 16, v44
    v_and_b32 v219, 0xffff0000, v44
    v_add_f32 v212, v212, v218
    v_add_f32 v213, v213, v219
    v_lshlrev_b32 v218, 16, v45
    v_and_b32 v219, 0xffff0000, v45
    v_add_f32 v212, v212, v218
    v_add_f32 v213, v213, v219
    v_lshlrev_b32 v218, 16, v46
    v_and_b32 v219, 0xffff0000, v46
    v_add_f32 v212, v212, v218
    v_add_f32 v213, v213, v219
    v_lshlrev_b32 v218, 16, v47
    v_and_b32 v219, 0xffff0000, v47
    v_add_f32 v212, v212, v218
    v_add_f32 v213, v213, v219
    v_lshlrev_b32 v218, 16, v48
    v_and_b32 v219, 0xffff0000, v48
    v_add_f32 v214, v214, v218
    v_add_f32 v215, v215, v219
    v_lshlrev_b32 v218, 16, v49
    v_and_b32 v219, 0xffff0000, v49
    v_add_f32 v214, v214, v218
    v_add_f32 v215, v215, v219
    v_lshlrev_b32 v218, 16, v50
    v_and_b32 v219, 0xffff0000, v50
    v_add_f32 v214, v214, v218
    v_add_f32 v215, v215, v219
    v_lshlrev_b32 v218, 16, v51
    v_and_b32 v219, 0xffff0000, v51
    v_add_f32 v214, v214, v218
    v_add_f32 v215, v215, v219
K1_CS_58:
    s_add_u32 m0, s32, 0
    s_nop 0
    buffer_load_dwordx4 v6, s[12:15], s29 offen offset:2048 lds
    buffer_load_dwordx4 v7, s[12:15], s29 offen offset:3072 lds
    s_add_u32 s29, s29, 128
    ds_read_b128 v[36:39], v13 offset:32768
    ds_read_b128 v[40:43], v203 offset:32768
    ds_read_b64_tr_b16 v[44:45], v18 offset:22528
    ds_read_b64_tr_b16 v[46:47], v18 offset:23040
    ds_read_b64_tr_b16 v[48:49], v19 offset:22528
    ds_read_b64_tr_b16 v[50:51], v19 offset:23040
    s_waitcnt lgkmcnt(6)
    v_mfma_f32_32x32x16_bf16 v[64:79], v[28:31], v[20:23], v[64:79]
    v_mfma_f32_32x32x16_bf16 v[80:95], v[32:35], v[20:23], v[80:95]
    v_mfma_f32_32x32x16_bf16 v[96:111], v[28:31], v[24:27], v[96:111]
    v_mfma_f32_32x32x16_bf16 v[112:127], v[32:35], v[24:27], v[112:127]
    s_cmp_lg_u32 s36, 2
    s_cbranch_scc1 K1_CS_59
    v_lshlrev_b32 v218, 16, v28
    v_and_b32 v219, 0xffff0000, v28
    v_add_f32 v212, v212, v218
    v_add_f32 v213, v213, v219
    v_lshlrev_b32 v218, 16, v29
    v_and_b32 v219, 0xffff0000, v29
    v_add_f32 v212, v212, v218
    v_add_f32 v213, v213, v219
    v_lshlrev_b32 v218, 16, v30
    v_and_b32 v219, 0xffff0000, v30
    v_add_f32 v212, v212, v218
    v_add_f32 v213, v213, v219
    v_lshlrev_b32 v218, 16, v31
    v_and_b32 v219, 0xffff0000, v31
    v_add_f32 v212, v212, v218
    v_add_f32 v213, v213, v219
    v_lshlrev_b32 v218, 16, v32
    v_and_b32 v219, 0xffff0000, v32
    v_add_f32 v214, v214, v218
    v_add_f32 v215, v215, v219
    v_lshlrev_b32 v218, 16, v33
    v_and_b32 v219, 0xffff0000, v33
    v_add_f32 v214, v214, v218
    v_add_f32 v215, v215, v219
    v_lshlrev_b32 v218, 16, v34
    v_and_b32 v219, 0xffff0000, v34
    v_add_f32 v214, v214, v218
    v_add_f32 v215, v215, v219
    v_lshlrev_b32 v218, 16, v35
    v_and_b32 v219, 0xffff0000, v35
    v_add_f32 v214, v214, v218
    v_add_f32 v215, v215, v219
K1_CS_59:
    s_add_u32 m0, s33, 0
    s_nop 0
    buffer_load_dwordx4 v8, s[16:19], s30 offen offset:0 lds
    buffer_load_dwordx4 v9, s[16:19], s30 offen offset:1024 lds
    s_add_u32 s30, s30, s31
    s_waitcnt vmcnt(6) lgkmcnt(0)
    s_barrier
    ds_read_b128 v[20:23], v14 offset:0
    ds_read_b128 v[24:27], v204 offset:0
    ds_read_b64_tr_b16 v[28:29], v18 offset:32768
    ds_read_b64_tr_b16 v[30:31], v18 offset:33280
    ds_read_b64_tr_b16 v[32:33], v19 offset:32768
    ds_read_b64_tr_b16 v[34:35], v19 offset:33280
    v_mfma_f32_32x32x16_bf16 v[64:79], v[44:47], v[36:39], v[64:79]
    v_mfma_f32_32x32x16_bf16 v[80:95], v[48:51], v[36:39], v[80:95]
    v_mfma_f32_32x32x16_bf16 v[96:111], v[44:47], v[40:43], v[96:111]
    v_mfma_f32_32x32x16_bf16 v[112:127], v[48:51], v[40:43], v[112:127]
    s_cmp_lg_u32 s36, 3
    s_cbranch_scc1 K1_CS_60
    v_lshlrev_b32 v218, 16, v44
    v_and_b32 v219, 0xffff0000, v44
    v_add_f32 v212, v212, v218
    v_add_f32 v213, v213, v219
    v_lshlrev_b32 v218, 16, v45
    v_and_b32 v219, 0xffff0000, v45
    v_add_f32 v212, v212, v218
    v_add_f32 v213, v213, v219
    v_lshlrev_b32 v218, 16, v46
    v_and_b32 v219, 0xffff0000, v46
    v_add_f32 v212, v212, v218
    v_add_f32 v213, v213, v219
    v_lshlrev_b32 v218, 16, v47
    v_and_b32 v219, 0xffff0000, v47
    v_add_f32 v212, v212, v218
    v_add_f32 v213, v213, v219
    v_lshlrev_b32 v218, 16, v48
    v_and_b32 v219, 0xffff0000, v48
    v_add_f32 v214, v214, v218
    v_add_f32 v215, v215, v219
    v_lshlrev_b32 v218, 16, v49
    v_and_b32 v219, 0xffff0000, v49
    v_add_f32 v214, v214, v218
    v_add_f32 v215, v215, v219
    v_lshlrev_b32 v218, 16, v50
    v_and_b32 v219, 0xffff0000, v50
    v_add_f32 v214, v214, v218
    v_add_f32 v215, v215, v219
    v_lshlrev_b32 v218, 16, v51
    v_and_b32 v219, 0xffff0000, v51
    v_add_f32 v214, v214, v218
    v_add_f32 v215, v215, v219
K1_CS_60:
    ds_read_b128 v[36:39], v15 offset:0
    ds_read_b128 v[40:43], v205 offset:0
    ds_read_b64_tr_b16 v[44:45], v18 offset:34816
    ds_read_b64_tr_b16 v[46:47], v18 offset:35328
    ds_read_b64_tr_b16 v[48:49], v19 offset:34816
    ds_read_b64_tr_b16 v[50:51], v19 offset:35328
    s_waitcnt lgkmcnt(6)
    v_mfma_f32_32x32x16_bf16 v[64:79], v[28:31], v[20:23], v[64:79]
    v_mfma_f32_32x32x16_bf16 v[80:95], v[32:35], v[20:23], v[80:95]
    v_mfma_f32_32x32x16_bf16 v[96:111], v[28:31], v[24:27], v[96:111]
    v_mfma_f32_32x32x16_bf16 v[112:127], v[32:35], v[24:27], v[112:127]
    s_cmp_lg_u32 s36, 0
    s_cbranch_scc1 K1_CS_61
    v_lshlrev_b32 v218, 16, v28
    v_and_b32 v219, 0xffff0000, v28
    v_add_f32 v212, v212, v218
    v_add_f32 v213, v213, v219
    v_lshlrev_b32 v218, 16, v29
    v_and_b32 v219, 0xffff0000, v29
    v_add_f32 v212, v212, v218
    v_add_f32 v213, v213, v219
    v_lshlrev_b32 v218, 16, v30
    v_and_b32 v219, 0xffff0000, v30
    v_add_f32 v212, v212, v218
    v_add_f32 v213, v213, v219
    v_lshlrev_b32 v218, 16, v31
    v_and_b32 v219, 0xffff0000, v31
    v_add_f32 v212, v212, v218
    v_add_f32 v213, v213, v219
    v_lshlrev_b32 v218, 16, v32
    v_and_b32 v219, 0xffff0000, v32
    v_add_f32 v214, v214, v218
    v_add_f32 v215, v215, v219
    v_lshlrev_b32 v218, 16, v33
    v_and_b32 v219, 0xffff0000, v33
    v_add_f32 v214, v214, v218
    v_add_f32 v215, v215, v219
    v_lshlrev_b32 v218, 16, v34
    v_and_b32 v219, 0xffff0000, v34
    v_add_f32 v214, v214, v218
    v_add_f32 v215, v215, v219
    v_lshlrev_b32 v218, 16, v35
    v_and_b32 v219, 0xffff0000, v35
    v_add_f32 v214, v214, v218
    v_add_f32 v215, v215, v219
K1_CS_61:
    s_add_u32 m0, s32, 32768
    s_nop 0
    buffer_load_dwordx4 v4, s[12:15], s29 offen offset:0 lds
    buffer_load_dwordx4 v5, s[12:15], s29 offen offset:1024 lds
    ds_read_b128 v[20:23], v16 offset:0
    ds_read_b128 v[24:27], v206 offset:0
    ds_read_b64_tr_b16 v[28:29], v18 offset:36864
    ds_read_b64_tr_b16 v[30:31], v18 offset:37376
    ds_read_b64_tr_b16 v[32:33], v19 offset:36864
    ds_read_b64_tr_b16 v[34:35], v19 offset:37376
    s_waitcnt lgkmcnt(6)
    v_mfma_f32_32x32x16_bf16 v[64:79], v[44:47], v[36:39], v[64:79]
    v_mfma_f32_32x32x16_bf16 v[80:95], v[48:51], v[36:39], v[80:95]
    v_mfma_f32_32x32x16_bf16 v[96:111], v[44:47], v[40:43], v[96:111]
    v_mfma_f32_32x32x16_bf16 v[112:127], v[48:51], v[40:43], v[112:127]
    s_cmp_lg_u32 s36, 1
    s_cbranch_scc1 K1_CS_62
    v_lshlrev_b32 v218, 16, v44
    v_and_b32 v219, 0xffff0000, v44
    v_add_f32 v212, v212, v218
    v_add_f32 v213, v213, v219
    v_lshlrev_b32 v218, 16, v45
    v_and_b32 v219, 0xffff0000, v45
    v_add_f32 v212, v212, v218
    v_add_f32 v213, v213, v219
    v_lshlrev_b32 v218, 16, v46
    v_and_b32 v219, 0xffff0000, v46
    v_add_f32 v212, v212, v218
    v_add_f32 v213, v213, v219
    v_lshlrev_b32 v218, 16, v47
    v_and_b32 v219, 0xffff0000, v47
    v_add_f32 v212, v212, v218
    v_add_f32 v213, v213, v219
    v_lshlrev_b32 v218, 16, v48
    v_and_b32 v219, 0xffff0000, v48
    v_add_f32 v214, v214, v218
    v_add_f32 v215, v215, v219
    v_lshlrev_b32 v218, 16, v49
    v_and_b32 v219, 0xffff0000, v49
    v_add_f32 v214, v214, v218
    v_add_f32 v215, v215, v219
    v_lshlrev_b32 v218, 16, v50
    v_and_b32 v219, 0xffff0000, v50
    v_add_f32 v214, v214, v218
    v_add_f32 v215, v215, v219
    v_lshlrev_b32 v218, 16, v51
    v_and_b32 v219, 0xffff0000, v51
    v_add_f32 v214, v214, v218
    v_add_f32 v215, v215, v219
K1_CS_62:
    s_add_u32 m0, s32, 32768
    s_nop 0
    buffer_load_dwordx4 v6, s[12:15], s29 offen offset:2048 lds
    buffer_load_dwordx4 v7, s[12:15], s29 offen offset:3072 lds
    s_add_u32 s29, s29, 128
    ds_read_b128 v[36:39], v17 offset:0
    ds_read_b128 v[40:43], v207 offset:0
    ds_read_b64_tr_b16 v[44:45], v18 offset:38912
    ds_read_b64_tr_b16 v[46:47], v18 offset:39424
    ds_read_b64_tr_b16 v[48:49], v19 offset:38912
    ds_read_b64_tr_b16 v[50:51], v19 offset:39424
    s_waitcnt lgkmcnt(6)
    v_mfma_f32_32x32x16_bf16 v[64:79], v[28:31], v[20:23], v[64:79]
    v_mfma_f32_32x32x16_bf16 v[80:95], v[32:35], v[20:23], v[80:95]
    v_mfma_f32_32x32x16_bf16 v[96:111], v[28:31], v[24:27], v[96:111]
    v_mfma_f32_32x32x16_bf16 v[112:127], v[32:35], v[24:27], v[112:127]
    s_cmp_lg_u32 s36, 2
    s_cbranch_scc1 K1_CS_63
    v_lshlrev_b32 v218, 16, v28
    v_and_b32 v219, 0xffff0000, v28
    v_add_f32 v212, v212, v218
    v_add_f32 v213, v213, v219
    v_lshlrev_b32 v218, 16, v29
    v_and_b32 v219, 0xffff0000, v29
    v_add_f32 v212, v212, v218
    v_add_f32 v213, v213, v219
    v_lshlrev_b32 v218, 16, v30
    v_and_b32 v219, 0xffff0000, v30
    v_add_f32 v212, v212, v218
    v_add_f32 v213, v213, v219
    v_lshlrev_b32 v218, 16, v31
    v_and_b32 v219, 0xffff0000, v31
    v_add_f32 v212, v212, v218
    v_add_f32 v213, v213, v219
    v_lshlrev_b32 v218, 16, v32
    v_and_b32 v219, 0xffff0000, v32
    v_add_f32 v214, v214, v218
    v_add_f32 v215, v215, v219
    v_lshlrev_b32 v218, 16, v33
    v_and_b32 v219, 0xffff0000, v33
    v_add_f32 v214, v214, v218
    v_add_f32 v215, v215, v219
    v_lshlrev_b32 v218, 16, v34
    v_and_b32 v219, 0xffff0000, v34
    v_add_f32 v214, v214, v218
    v_add_f32 v215, v215, v219
    v_lshlrev_b32 v218, 16, v35
    v_and_b32 v219, 0xffff0000, v35
    v_add_f32 v214, v214, v218
    v_add_f32 v215, v215, v219
K1_CS_63:
    s_add_u32 m0, s33, 16384
    s_nop 0
    buffer_load_dwordx4 v8, s[16:19], s30 offen offset:0 lds
    buffer_load_dwordx4 v9, s[16:19], s30 offen offset:1024 lds
    s_add_u32 s30, s30, s31
    s_waitcnt vmcnt(6) lgkmcnt(0)
    s_barrier
    ds_read_b128 v[20:23], v10 offset:0
    ds_read_b128 v[24:27], v200 offset:0
    ds_read_b64_tr_b16 v[28:29], v18 offset:0
    ds_read_b64_tr_b16 v[30:31], v18 offset:512
    ds_read_b64_tr_b16 v[32:33], v19 offset:0
    ds_read_b64_tr_b16 v[34:35], v19 offset:512
    v_mfma_f32_32x32x16_bf16 v[64:79], v[44:47], v[36:39], v[64:79]
    v_mfma_f32_32x32x16_bf16 v[80:95], v[48:51], v[36:39], v[80:95]
    v_mfma_f32_32x32x16_bf16 v[96:111], v[44:47], v[40:43], v[96:111]
    v_mfma_f32_32x32x16_bf16 v[112:127], v[48:51], v[40:43], v[112:127]
    s_cmp_lg_u32 s36, 3
    s_cbranch_scc1 K1_CS_64
    v_lshlrev_b32 v218, 16, v44
    v_and_b32 v219, 0xffff0000, v44
    v_add_f32 v212, v212, v218
    v_add_f32 v213, v213, v219
    v_lshlrev_b32 v218, 16, v45
    v_and_b32 v219, 0xffff0000, v45
    v_add_f32 v212, v212, v218
    v_add_f32 v213, v213, v219
    v_lshlrev_b32 v218, 16, v46
    v_and_b32 v219, 0xffff0000, v46
    v_add_f32 v212, v212, v218
    v_add_f32 v213, v213, v219
    v_lshlrev_b32 v218, 16, v47
    v_and_b32 v219, 0xffff0000, v47
    v_add_f32 v212, v212, v218
    v_add_f32 v213, v213, v219
    v_lshlrev_b32 v218, 16, v48
    v_and_b32 v219, 0xffff0000, v48
    v_add_f32 v214, v214, v218
    v_add_f32 v215, v215, v219
    v_lshlrev_b32 v218, 16, v49
    v_and_b32 v219, 0xffff0000, v49
    v_add_f32 v214, v214, v218
    v_add_f32 v215, v215, v219
    v_lshlrev_b32 v218, 16, v50
    v_and_b32 v219, 0xffff0000, v50
    v_add_f32 v214, v214, v218
    v_add_f32 v215, v215, v219
    v_lshlrev_b32 v218, 16, v51
    v_and_b32 v219, 0xffff0000, v51
    v_add_f32 v214, v214, v218
    v_add_f32 v215, v215, v219
K1_CS_64:
    ds_read_b128 v[36:39], v11 offset:0
    ds_read_b128 v[40:43], v201 offset:0
    ds_read_b64_tr_b16 v[44:45], v18 offset:2048
    ds_read_b64_tr_b16 v[46:47], v18 offset:2560
    ds_read_b64_tr_b16 v[48:49], v19 offset:2048
    ds_read_b64_tr_b16 v[50:51], v19 offset:2560
    s_waitcnt lgkmcnt(6)
    v_mfma_f32_32x32x16_bf16 v[64:79], v[28:31], v[20:23], v[64:79]
    v_mfma_f32_32x32x16_bf16 v[80:95], v[32:35], v[20:23], v[80:95]
    v_mfma_f32_32x32x16_bf16 v[96:111], v[28:31], v[24:27], v[96:111]
    v_mfma_f32_32x32x16_bf16 v[112:127], v[32:35], v[24:27], v[112:127]
    s_cmp_lg_u32 s36, 0
    s_cbranch_scc1 K1_CS_65
    v_lshlrev_b32 v218, 16, v28
    v_and_b32 v219, 0xffff0000, v28
    v_add_f32 v212, v212, v218
    v_add_f32 v213, v213, v219
    v_lshlrev_b32 v218, 16, v29
    v_and_b32 v219, 0xffff0000, v29
    v_add_f32 v212, v212, v218
    v_add_f32 v213, v213, v219
    v_lshlrev_b32 v218, 16, v30
    v_and_b32 v219, 0xffff0000, v30
    v_add_f32 v212, v212, v218
    v_add_f32 v213, v213, v219
    v_lshlrev_b32 v218, 16, v31
    v_and_b32 v219, 0xffff0000, v31
    v_add_f32 v212, v212, v218
    v_add_f32 v213, v213, v219
    v_lshlrev_b32 v218, 16, v32
    v_and_b32 v219, 0xffff0000, v32
    v_add_f32 v214, v214, v218
    v_add_f32 v215, v215, v219
    v_lshlrev_b32 v218, 16, v33
    v_and_b32 v219, 0xffff0000, v33
    v_add_f32 v214, v214, v218
    v_add_f32 v215, v215, v219
    v_lshlrev_b32 v218, 16, v34
    v_and_b32 v219, 0xffff0000, v34
    v_add_f32 v214, v214, v218
    v_add_f32 v215, v215, v219
    v_lshlrev_b32 v218, 16, v35
    v_and_b32 v219, 0xffff0000, v35
    v_add_f32 v214, v214, v218
    v_add_f32 v215, v215, v219
K1_CS_65:
    s_add_u32 m0, s32, 65536
    s_nop 0
    buffer_load_dwordx4 v4, s[12:15], s29 offen offset:0 lds
    buffer_load_dwordx4 v5, s[12:15], s29 offen offset:1024 lds
    ds_read_b128 v[20:23], v12 offset:0
    ds_read_b128 v[24:27], v202 offset:0
    ds_read_b64_tr_b16 v[28:29], v18 offset:4096
    ds_read_b64_tr_b16 v[30:31], v18 offset:4608
    ds_read_b64_tr_b16 v[32:33], v19 offset:4096
    ds_read_b64_tr_b16 v[34:35], v19 offset:4608
    s_waitcnt lgkmcnt(6)
    v_mfma_f32_32x32x16_bf16 v[64:79], v[44:47], v[36:39], v[64:79]
    v_mfma_f32_32x32x16_bf16 v[80:95], v[48:51], v[36:39], v[80:95]
    v_mfma_f32_32x32x16_bf16 v[96:111], v[44:47], v[40:43], v[96:111]
    v_mfma_f32_32x32x16_bf16 v[112:127], v[48:51], v[40:43], v[112:127]
    s_cmp_lg_u32 s36, 1
    s_cbranch_scc1 K1_CS_66
    v_lshlrev_b32 v218, 16, v44
    v_and_b32 v219, 0xffff0000, v44
    v_add_f32 v212, v212, v218
    v_add_f32 v213, v213, v219
    v_lshlrev_b32 v218, 16, v45
    v_and_b32 v219, 0xffff0000, v45
    v_add_f32 v212, v212, v218
    v_add_f32 v213, v213, v219
    v_lshlrev_b32 v218, 16, v46
    v_and_b32 v219, 0xffff0000, v46
    v_add_f32 v212, v212, v218
    v_add_f32 v213, v213, v219
    v_lshlrev_b32 v218, 16, v47
    v_and_b32 v219, 0xffff0000, v47
    v_add_f32 v212, v212, v218
    v_add_f32 v213, v213, v219
    v_lshlrev_b32 v218, 16, v48
    v_and_b32 v219, 0xffff0000, v48
    v_add_f32 v214, v214, v218
    v_add_f32 v215, v215, v219
    v_lshlrev_b32 v218, 16, v49
    v_and_b32 v219, 0xffff0000, v49
    v_add_f32 v214, v214, v218
    v_add_f32 v215, v215, v219
    v_lshlrev_b32 v218, 16, v50
    v_and_b32 v219, 0xffff0000, v50
    v_add_f32 v214, v214, v218
    v_add_f32 v215, v215, v219
    v_lshlrev_b32 v218, 16, v51
    v_and_b32 v219, 0xffff0000, v51
    v_add_f32 v214, v214, v218
    v_add_f32 v215, v215, v219
K1_CS_66:
    s_add_u32 m0, s32, 65536
    s_nop 0
    buffer_load_dwordx4 v6, s[12:15], s29 offen offset:2048 lds
    buffer_load_dwordx4 v7, s[12:15], s29 offen offset:3072 lds
    s_add_u32 s29, s29, 128
    ds_read_b128 v[36:39], v13 offset:0
    ds_read_b128 v[40:43], v203 offset:0
    ds_read_b64_tr_b16 v[44:45], v18 offset:6144
    ds_read_b64_tr_b16 v[46:47], v18 offset:6656
    ds_read_b64_tr_b16 v[48:49], v19 offset:6144
    ds_read_b64_tr_b16 v[50:51], v19 offset:6656
    s_waitcnt lgkmcnt(6)
    v_mfma_f32_32x32x16_bf16 v[64:79], v[28:31], v[20:23], v[64:79]
    v_mfma_f32_32x32x16_bf16 v[80:95], v[32:35], v[20:23], v[80:95]
    v_mfma_f32_32x32x16_bf16 v[96:111], v[28:31], v[24:27], v[96:111]
    v_mfma_f32_32x32x16_bf16 v[112:127], v[32:35], v[24:27], v[112:127]
    s_cmp_lg_u32 s36, 2
    s_cbranch_scc1 K1_CS_67
    v_lshlrev_b32 v218, 16, v28
    v_and_b32 v219, 0xffff0000, v28
    v_add_f32 v212, v212, v218
    v_add_f32 v213, v213, v219
    v_lshlrev_b32 v218, 16, v29
    v_and_b32 v219, 0xffff0000, v29
    v_add_f32 v212, v212, v218
    v_add_f32 v213, v213, v219
    v_lshlrev_b32 v218, 16, v30
    v_and_b32 v219, 0xffff0000, v30
    v_add_f32 v212, v212, v218
    v_add_f32 v213, v213, v219
    v_lshlrev_b32 v218, 16, v31
    v_and_b32 v219, 0xffff0000, v31
    v_add_f32 v212, v212, v218
    v_add_f32 v213, v213, v219
    v_lshlrev_b32 v218, 16, v32
    v_and_b32 v219, 0xffff0000, v32
    v_add_f32 v214, v214, v218
    v_add_f32 v215, v215, v219
    v_lshlrev_b32 v218, 16, v33
    v_and_b32 v219, 0xffff0000, v33
    v_add_f32 v214, v214, v218
    v_add_f32 v215, v215, v219
    v_lshlrev_b32 v218, 16, v34
    v_and_b32 v219, 0xffff0000, v34
    v_add_f32 v214, v214, v218
    v_add_f32 v215, v215, v219
    v_lshlrev_b32 v218, 16, v35
    v_and_b32 v219, 0xffff0000, v35
    v_add_f32 v214, v214, v218
    v_add_f32 v215, v215, v219
K1_CS_67:
    s_add_u32 m0, s33, 32768
    s_nop 0
    buffer_load_dwordx4 v8, s[16:19], s30 offen offset:0 lds
    buffer_load_dwordx4 v9, s[16:19], s30 offen offset:1024 lds
    s_add_u32 s30, s30, s31
    s_waitcnt vmcnt(6) lgkmcnt(0)
    s_barrier
    ds_read_b128 v[20:23], v10 offset:32768
    ds_read_b128 v[24:27], v200 offset:32768
    ds_read_b64_tr_b16 v[28:29], v18 offset:16384
    ds_read_b64_tr_b16 v[30:31], v18 offset:16896
    ds_read_b64_tr_b16 v[32:33], v19 offset:16384
    ds_read_b64_tr_b16 v[34:35], v19 offset:16896
    v_mfma_f32_32x32x16_bf16 v[64:79], v[44:47], v[36:39], v[64:79]
    v_mfma_f32_32x32x16_bf16 v[80:95], v[48:51], v[36:39], v[80:95]
    v_mfma_f32_32x32x16_bf16 v[96:111], v[44:47], v[40:43], v[96:111]
    v_mfma_f32_32x32x16_bf16 v[112:127], v[48:51], v[40:43], v[112:127]
    s_cmp_lg_u32 s36, 3
    s_cbranch_scc1 K1_CS_68
    v_lshlrev_b32 v218, 16, v44
    v_and_b32 v219, 0xffff0000, v44
    v_add_f32 v212, v212, v218
    v_add_f32 v213, v213, v219
    v_lshlrev_b32 v218, 16, v45
    v_and_b32 v219, 0xffff0000, v45
    v_add_f32 v212, v212, v218
    v_add_f32 v213, v213, v219
    v_lshlrev_b32 v218, 16, v46
    v_and_b32 v219, 0xffff0000, v46
    v_add_f32 v212, v212, v218
    v_add_f32 v213, v213, v219
    v_lshlrev_b32 v218, 16, v47
    v_and_b32 v219, 0xffff0000, v47
    v_add_f32 v212, v212, v218
    v_add_f32 v213, v213, v219
    v_lshlrev_b32 v218, 16, v48
    v_and_b32 v219, 0xffff0000, v48
    v_add_f32 v214, v214, v218
    v_add_f32 v215, v215, v219
    v_lshlrev_b32 v218, 16, v49
    v_and_b32 v219, 0xffff0000, v49
    v_add_f32 v214, v214, v218
    v_add_f32 v215, v215, v219
    v_lshlrev_b32 v218, 16, v50
    v_and_b32 v219, 0xffff0000, v50
    v_add_f32 v214, v214, v218
    v_add_f32 v215, v215, v219
    v_lshlrev_b32 v218, 16, v51
    v_and_b32 v219, 0xffff0000, v51
    v_add_f32 v214, v214, v218
    v_add_f32 v215, v215, v219
K1_CS_68:
    ds_read_b128 v[36:39], v11 offset:32768
    ds_read_b128 v[40:43], v201 offset:32768
    ds_read_b64_tr_b16 v[44:45], v18 offset:18432
    ds_read_b64_tr_b16 v[46:47], v18 offset:18944
    ds_read_b64_tr_b16 v[48:49], v19 offset:18432
    ds_read_b64_tr_b16 v[50:51], v19 offset:18944
    s_waitcnt lgkmcnt(6)
    v_mfma_f32_32x32x16_bf16 v[64:79], v[28:31], v[20:23], v[64:79]
    v_mfma_f32_32x32x16_bf16 v[80:95], v[32:35], v[20:23], v[80:95]
    v_mfma_f32_32x32x16_bf16 v[96:111], v[28:31], v[24:27], v[96:111]
    v_mfma_f32_32x32x16_bf16 v[112:127], v[32:35], v[24:27], v[112:127]
    s_cmp_lg_u32 s36, 0
    s_cbranch_scc1 K1_CS_69
    v_lshlrev_b32 v218, 16, v28
    v_and_b32 v219, 0xffff0000, v28
    v_add_f32 v212, v212, v218
    v_add_f32 v213, v213, v219
    v_lshlrev_b32 v218, 16, v29
    v_and_b32 v219, 0xffff0000, v29
    v_add_f32 v212, v212, v218
    v_add_f32 v213, v213, v219
    v_lshlrev_b32 v218, 16, v30
    v_and_b32 v219, 0xffff0000, v30
    v_add_f32 v212, v212, v218
    v_add_f32 v213, v213, v219
    v_lshlrev_b32 v218, 16, v31
    v_and_b32 v219, 0xffff0000, v31
    v_add_f32 v212, v212, v218
    v_add_f32 v213, v213, v219
    v_lshlrev_b32 v218, 16, v32
    v_and_b32 v219, 0xffff0000, v32
    v_add_f32 v214, v214, v218
    v_add_f32 v215, v215, v219
    v_lshlrev_b32 v218, 16, v33
    v_and_b32 v219, 0xffff0000, v33
    v_add_f32 v214, v214, v218
    v_add_f32 v215, v215, v219
    v_lshlrev_b32 v218, 16, v34
    v_and_b32 v219, 0xffff0000, v34
    v_add_f32 v214, v214, v218
    v_add_f32 v215, v215, v219
    v_lshlrev_b32 v218, 16, v35
    v_and_b32 v219, 0xffff0000, v35
    v_add_f32 v214, v214, v218
    v_add_f32 v215, v215, v219
K1_CS_69:
    s_add_u32 m0, s32, 0
    s_nop 0
    buffer_load_dwordx4 v4, s[12:15], s29 offen offset:0 lds
    buffer_load_dwordx4 v5, s[12:15], s29 offen offset:1024 lds
    ds_read_b128 v[20:23], v12 offset:32768
    ds_read_b128 v[24:27], v202 offset:32768
    ds_read_b64_tr_b16 v[28:29], v18 offset:20480
    ds_read_b64_tr_b16 v[30:31], v18 offset:20992
    ds_read_b64_tr_b16 v[32:33], v19 offset:20480
    ds_read_b64_tr_b16 v[34:35], v19 offset:20992
    s_waitcnt lgkmcnt(6)
    v_mfma_f32_32x32x16_bf16 v[64:79], v[44:47], v[36:39], v[64:79]
    v_mfma_f32_32x32x16_bf16 v[80:95], v[48:51], v[36:39], v[80:95]
    v_mfma_f32_32x32x16_bf16 v[96:111], v[44:47], v[40:43], v[96:111]
    v_mfma_f32_32x32x16_bf16 v[112:127], v[48:51], v[40:43], v[112:127]
    s_cmp_lg_u32 s36, 1
    s_cbranch_scc1 K1_CS_70
    v_lshlrev_b32 v218, 16, v44
    v_and_b32 v219, 0xffff0000, v44
    v_add_f32 v212, v212, v218
    v_add_f32 v213, v213, v219
    v_lshlrev_b32 v218, 16, v45
    v_and_b32 v219, 0xffff0000, v45
    v_add_f32 v212, v212, v218
    v_add_f32 v213, v213, v219
    v_lshlrev_b32 v218, 16, v46
    v_and_b32 v219, 0xffff0000, v46
    v_add_f32 v212, v212, v218
    v_add_f32 v213, v213, v219
    v_lshlrev_b32 v218, 16, v47
    v_and_b32 v219, 0xffff0000, v47
    v_add_f32 v212, v212, v218
    v_add_f32 v213, v213, v219
    v_lshlrev_b32 v218, 16, v48
    v_and_b32 v219, 0xffff0000, v48
    v_add_f32 v214, v214, v218
    v_add_f32 v215, v215, v219
    v_lshlrev_b32 v218, 16, v49
    v_and_b32 v219, 0xffff0000, v49
    v_add_f32 v214, v214, v218
    v_add_f32 v215, v215, v219
    v_lshlrev_b32 v218, 16, v50
    v_and_b32 v219, 0xffff0000, v50
    v_add_f32 v214, v214, v218
    v_add_f32 v215, v215, v219
    v_lshlrev_b32 v218, 16, v51
    v_and_b32 v219, 0xffff0000, v51
    v_add_f32 v214, v214, v218
    v_add_f32 v215, v215, v219
K1_CS_70:
    s_add_u32 m0, s32, 0
    s_nop 0
    buffer_load_dwordx4 v6, s[12:15], s29 offen offset:2048 lds
    buffer_load_dwordx4 v7, s[12:15], s29 offen offset:3072 lds
    s_add_u32 s29, s29, 128
    ds_read_b128 v[36:39], v13 offset:32768
    ds_read_b128 v[40:43], v203 offset:32768
    ds_read_b64_tr_b16 v[44:45], v18 offset:22528
    ds_read_b64_tr_b16 v[46:47], v18 offset:23040
    ds_read_b64_tr_b16 v[48:49], v19 offset:22528
    ds_read_b64_tr_b16 v[50:51], v19 offset:23040
    s_waitcnt lgkmcnt(6)
    v_mfma_f32_32x32x16_bf16 v[64:79], v[28:31], v[20:23], v[64:79]
    v_mfma_f32_32x32x16_bf16 v[80:95], v[32:35], v[20:23], v[80:95]
    v_mfma_f32_32x32x16_bf16 v[96:111], v[28:31], v[24:27], v[96:111]
    v_mfma_f32_32x32x16_bf16 v[112:127], v[32:35], v[24:27], v[112:127]
    s_cmp_lg_u32 s36, 2
    s_cbranch_scc1 K1_CS_71
    v_lshlrev_b32 v218, 16, v28
    v_and_b32 v219, 0xffff0000, v28
    v_add_f32 v212, v212, v218
    v_add_f32 v213, v213, v219
    v_lshlrev_b32 v218, 16, v29
    v_and_b32 v219, 0xffff0000, v29
    v_add_f32 v212, v212, v218
    v_add_f32 v213, v213, v219
    v_lshlrev_b32 v218, 16, v30
    v_and_b32 v219, 0xffff0000, v30
    v_add_f32 v212, v212, v218
    v_add_f32 v213, v213, v219
    v_lshlrev_b32 v218, 16, v31
    v_and_b32 v219, 0xffff0000, v31
    v_add_f32 v212, v212, v218
    v_add_f32 v213, v213, v219
    v_lshlrev_b32 v218, 16, v32
    v_and_b32 v219, 0xffff0000, v32
    v_add_f32 v214, v214, v218
    v_add_f32 v215, v215, v219
    v_lshlrev_b32 v218, 16, v33
    v_and_b32 v219, 0xffff0000, v33
    v_add_f32 v214, v214, v218
    v_add_f32 v215, v215, v219
    v_lshlrev_b32 v218, 16, v34
    v_and_b32 v219, 0xffff0000, v34
    v_add_f32 v214, v214, v218
    v_add_f32 v215, v215, v219
    v_lshlrev_b32 v218, 16, v35
    v_and_b32 v219, 0xffff0000, v35
    v_add_f32 v214, v214, v218
    v_add_f32 v215, v215, v219
K1_CS_71:
    s_add_u32 m0, s33, 0
    s_nop 0
    buffer_load_dwordx4 v8, s[16:19], s30 offen offset:0 lds
    buffer_load_dwordx4 v9, s[16:19], s30 offen offset:1024 lds
    s_add_u32 s30, s30, s31
    s_waitcnt vmcnt(6) lgkmcnt(0)
    s_barrier
    global_load_dword v223, v222, s[52:53] sc1
    ds_read_b128 v[20:23], v14 offset:0
    ds_read_b128 v[24:27], v204 offset:0
    ds_read_b64_tr_b16 v[28:29], v18 offset:32768
    ds_read_b64_tr_b16 v[30:31], v18 offset:33280
    ds_read_b64_tr_b16 v[32:33], v19 offset:32768
    ds_read_b64_tr_b16 v[34:35], v19 offset:33280
    v_mfma_f32_32x32x16_bf16 v[64:79], v[44:47], v[36:39], v[64:79]
    v_mfma_f32_32x32x16_bf16 v[80:95], v[48:51], v[36:39], v[80:95]
    v_mfma_f32_32x32x16_bf16 v[96:111], v[44:47], v[40:43], v[96:111]
    v_mfma_f32_32x32x16_bf16 v[112:127], v[48:51], v[40:43], v[112:127]
    s_cmp_lg_u32 s36, 3
    s_cbranch_scc1 K1_CS_72
    v_lshlrev_b32 v218, 16, v44
    v_and_b32 v219, 0xffff0000, v44
    v_add_f32 v212, v212, v218
    v_add_f32 v213, v213, v219
    v_lshlrev_b32 v218, 16, v45
    v_and_b32 v219, 0xffff0000, v45
    v_add_f32 v212, v212, v218
    v_add_f32 v213, v213, v219
    v_lshlrev_b32 v218, 16, v46
    v_and_b32 v219, 0xffff0000, v46
    v_add_f32 v212, v212, v218
    v_add_f32 v213, v213, v219
    v_lshlrev_b32 v218, 16, v47
    v_and_b32 v219, 0xffff0000, v47
    v_add_f32 v212, v212, v218
    v_add_f32 v213, v213, v219
    v_lshlrev_b32 v218, 16, v48
    v_and_b32 v219, 0xffff0000, v48
    v_add_f32 v214, v214, v218
    v_add_f32 v215, v215, v219
    v_lshlrev_b32 v218, 16, v49
    v_and_b32 v219, 0xffff0000, v49
    v_add_f32 v214, v214, v218
    v_add_f32 v215, v215, v219
    v_lshlrev_b32 v218, 16, v50
    v_and_b32 v219, 0xffff0000, v50
    v_add_f32 v214, v214, v218
    v_add_f32 v215, v215, v219
    v_lshlrev_b32 v218, 16, v51
    v_and_b32 v219, 0xffff0000, v51
    v_add_f32 v214, v214, v218
    v_add_f32 v215, v215, v219
K1_CS_72:
    ds_read_b128 v[36:39], v15 offset:0
    ds_read_b128 v[40:43], v205 offset:0
    ds_read_b64_tr_b16 v[44:45], v18 offset:34816
    ds_read_b64_tr_b16 v[46:47], v18 offset:35328
    ds_read_b64_tr_b16 v[48:49], v19 offset:34816
    ds_read_b64_tr_b16 v[50:51], v19 offset:35328
    s_waitcnt lgkmcnt(6)
    v_mfma_f32_32x32x16_bf16 v[64:79], v[28:31], v[20:23], v[64:79]
    v_mfma_f32_32x32x16_bf16 v[80:95], v[32:35], v[20:23], v[80:95]
    v_mfma_f32_32x32x16_bf16 v[96:111], v[28:31], v[24:27], v[96:111]
    v_mfma_f32_32x32x16_bf16 v[112:127], v[32:35], v[24:27], v[112:127]
    s_cmp_lg_u32 s36, 0
    s_cbranch_scc1 K1_CS_73
    v_lshlrev_b32 v218, 16, v28
    v_and_b32 v219, 0xffff0000, v28
    v_add_f32 v212, v212, v218
    v_add_f32 v213, v213, v219
    v_lshlrev_b32 v218, 16, v29
    v_and_b32 v219, 0xffff0000, v29
    v_add_f32 v212, v212, v218
    v_add_f32 v213, v213, v219
    v_lshlrev_b32 v218, 16, v30
    v_and_b32 v219, 0xffff0000, v30
    v_add_f32 v212, v212, v218
    v_add_f32 v213, v213, v219
    v_lshlrev_b32 v218, 16, v31
    v_and_b32 v219, 0xffff0000, v31
    v_add_f32 v212, v212, v218
    v_add_f32 v213, v213, v219
    v_lshlrev_b32 v218, 16, v32
    v_and_b32 v219, 0xffff0000, v32
    v_add_f32 v214, v214, v218
    v_add_f32 v215, v215, v219
    v_lshlrev_b32 v218, 16, v33
    v_and_b32 v219, 0xffff0000, v33
    v_add_f32 v214, v214, v218
    v_add_f32 v215, v215, v219
    v_lshlrev_b32 v218, 16, v34
    v_and_b32 v219, 0xffff0000, v34
    v_add_f32 v214, v214, v218
    v_add_f32 v215, v215, v219
    v_lshlrev_b32 v218, 16, v35
    v_and_b32 v219, 0xffff0000, v35
    v_add_f32 v214, v214, v218
    v_add_f32 v215, v215, v219
K1_CS_73:
    s_cmp_eq_u32 s64, 0
    s_cbranch_scc1 K1_NOBIAS
    s_mov_b32 s24, s10
    s_and_b32 s25, s11, 0xffff
    s_mov_b32 s26, 3072
    s_mov_b32 s27, 0x20000
    s_lshl_b32 s60, s65, 7
    v_lshlrev_b32 v60, 3, v3

    buffer_load_dwordx2 v[164:165], v60, s[24:27], s60 offen offset:0
    buffer_load_dwordx2 v[166:167], v60, s[24:27], s60 offen offset:16
    buffer_load_dwordx2 v[168:169], v60, s[24:27], s60 offen offset:32
    buffer_load_dwordx2 v[170:171], v60, s[24:27], s60 offen offset:48
    buffer_load_dwordx2 v[172:173], v60, s[24:27], s60 offen offset:64
    buffer_load_dwordx2 v[174:175], v60, s[24:27], s60 offen offset:80
    buffer_load_dwordx2 v[176:177], v60, s[24:27], s60 offen offset:96
    buffer_load_dwordx2 v[178:179], v60, s[24:27], s60 offen offset:112
K1_NOBIAS:
    ds_read_b128 v[20:23], v16 offset:0
    ds_read_b128 v[24:27], v206 offset:0
    ds_read_b64_tr_b16 v[28:29], v18 offset:36864
    ds_read_b64_tr_b16 v[30:31], v18 offset:37376
    ds_read_b64_tr_b16 v[32:33], v19 offset:36864
    ds_read_b64_tr_b16 v[34:35], v19 offset:37376
    s_waitcnt lgkmcnt(6)
    v_mfma_f32_32x32x16_bf16 v[64:79], v[44:47], v[36:39], v[64:79]
    v_mfma_f32_32x32x16_bf16 v[80:95], v[48:51], v[36:39], v[80:95]
    v_mfma_f32_32x32x16_bf16 v[96:111], v[44:47], v[40:43], v[96:111]
    v_mfma_f32_32x32x16_bf16 v[112:127], v[48:51], v[40:43], v[112:127]
    s_cmp_lg_u32 s36, 1
    s_cbranch_scc1 K1_CS_74
    v_lshlrev_b32 v218, 16, v44
    v_and_b32 v219, 0xffff0000, v44
    v_add_f32 v212, v212, v218
    v_add_f32 v213, v213, v219
    v_lshlrev_b32 v218, 16, v45
    v_and_b32 v219, 0xffff0000, v45
    v_add_f32 v212, v212, v218
    v_add_f32 v213, v213, v219
    v_lshlrev_b32 v218, 16, v46
    v_and_b32 v219, 0xffff0000, v46
    v_add_f32 v212, v212, v218
    v_add_f32 v213, v213, v219
    v_lshlrev_b32 v218, 16, v47
    v_and_b32 v219, 0xffff0000, v47
    v_add_f32 v212, v212, v218
    v_add_f32 v213, v213, v219
    v_lshlrev_b32 v218, 16, v48
    v_and_b32 v219, 0xffff0000, v48
    v_add_f32 v214, v214, v218
    v_add_f32 v215, v215, v219
    v_lshlrev_b32 v218, 16, v49
    v_and_b32 v219, 0xffff0000, v49
    v_add_f32 v214, v214, v218
    v_add_f32 v215, v215, v219
    v_lshlrev_b32 v218, 16, v50
    v_and_b32 v219, 0xffff0000, v50
    v_add_f32 v214, v214, v218
    v_add_f32 v215, v215, v219
    v_lshlrev_b32 v218, 16, v51
    v_and_b32 v219, 0xffff0000, v51
    v_add_f32 v214, v214, v218
    v_add_f32 v215, v215, v219
K1_CS_74:
    ds_read_b128 v[36:39], v17 offset:0
    ds_read_b128 v[40:43], v207 offset:0
    ds_read_b64_tr_b16 v[44:45], v18 offset:38912
    ds_read_b64_tr_b16 v[46:47], v18 offset:39424
    ds_read_b64_tr_b16 v[48:49], v19 offset:38912
    ds_read_b64_tr_b16 v[50:51], v19 offset:39424
    s_waitcnt lgkmcnt(6)
    v_mfma_f32_32x32x16_bf16 v[64:79], v[28:31], v[20:23], v[64:79]
    v_mfma_f32_32x32x16_bf16 v[80:95], v[32:35], v[20:23], v[80:95]
    v_mfma_f32_32x32x16_bf16 v[96:111], v[28:31], v[24:27], v[96:111]
    v_mfma_f32_32x32x16_bf16 v[112:127], v[32:35], v[24:27], v[112:127]
    s_cmp_lg_u32 s36, 2
    s_cbranch_scc1 K1_CS_75
    v_lshlrev_b32 v218, 16, v28
    v_and_b32 v219, 0xffff0000, v28
    v_add_f32 v212, v212, v218
    v_add_f32 v213, v213, v219
    v_lshlrev_b32 v218, 16, v29
    v_and_b32 v219, 0xffff0000, v29
    v_add_f32 v212, v212, v218
    v_add_f32 v213, v213, v219
    v_lshlrev_b32 v218, 16, v30
    v_and_b32 v219, 0xffff0000, v30
    v_add_f32 v212, v212, v218
    v_add_f32 v213, v213, v219
    v_lshlrev_b32 v218, 16, v31
    v_and_b32 v219, 0xffff0000, v31
    v_add_f32 v212, v212, v218
    v_add_f32 v213, v213, v219
    v_lshlrev_b32 v218, 16, v32
    v_and_b32 v219, 0xffff0000, v32
    v_add_f32 v214, v214, v218
    v_add_f32 v215, v215, v219
    v_lshlrev_b32 v218, 16, v33
    v_and_b32 v219, 0xffff0000, v33
    v_add_f32 v214, v214, v218
    v_add_f32 v215, v215, v219
    v_lshlrev_b32 v218, 16, v34
    v_and_b32 v219, 0xffff0000, v34
    v_add_f32 v214, v214, v218
    v_add_f32 v215, v215, v219
    v_lshlrev_b32 v218, 16, v35
    v_and_b32 v219, 0xffff0000, v35
    v_add_f32 v214, v214, v218
    v_add_f32 v215, v215, v219
K1_CS_75:
    s_waitcnt vmcnt(0) lgkmcnt(0)
    s_barrier
    v_readfirstlane_b32 s39, v223
    s_cmp_lt_u32 s39, 40
    s_cbranch_scc1 K1_NOTREADY_N
    buffer_load_dword v128, v220, s[20:23], s58 offen sc1
    buffer_load_dword v129, v220, s[20:23], s61 offen sc1
    buffer_load_dword v130, v220, s[20:23], s59 offen sc1
    buffer_load_dword v131, v220, s[20:23], s63 offen sc1
    s_mov_b32 s62, 1
    s_branch K1_READY1_N
K1_NOTREADY_N:
    global_load_dword v223, v222, s[52:53] sc1
K1_READY1_N:
    ds_read_b128 v[20:23], v10 offset:0
    ds_read_b128 v[24:27], v200 offset:0
    ds_read_b64_tr_b16 v[28:29], v18 offset:0
    ds_read_b64_tr_b16 v[30:31], v18 offset:512
    ds_read_b64_tr_b16 v[32:33], v19 offset:0
    ds_read_b64_tr_b16 v[34:35], v19 offset:512
    v_mfma_f32_32x32x16_bf16 v[64:79], v[44:47], v[36:39], v[64:79]
    v_mfma_f32_32x32x16_bf16 v[80:95], v[48:51], v[36:39], v[80:95]
    v_mfma_f32_32x32x16_bf16 v[96:111], v[44:47], v[40:43], v[96:111]
    v_mfma_f32_32x32x16_bf16 v[112:127], v[48:51], v[40:43], v[112:127]
    s_cmp_lg_u32 s36, 3
    s_cbranch_scc1 K1_CS_76
    v_lshlrev_b32 v218, 16, v44
    v_and_b32 v219, 0xffff0000, v44
    v_add_f32 v212, v212, v218
    v_add_f32 v213, v213, v219
    v_lshlrev_b32 v218, 16, v45
    v_and_b32 v219, 0xffff0000, v45
    v_add_f32 v212, v212, v218
    v_add_f32 v213, v213, v219
    v_lshlrev_b32 v218, 16, v46
    v_and_b32 v219, 0xffff0000, v46
    v_add_f32 v212, v212, v218
    v_add_f32 v213, v213, v219
    v_lshlrev_b32 v218, 16, v47
    v_and_b32 v219, 0xffff0000, v47
    v_add_f32 v212, v212, v218
    v_add_f32 v213, v213, v219
    v_lshlrev_b32 v218, 16, v48
    v_and_b32 v219, 0xffff0000, v48
    v_add_f32 v214, v214, v218
    v_add_f32 v215, v215, v219
    v_lshlrev_b32 v218, 16, v49
    v_and_b32 v219, 0xffff0000, v49
    v_add_f32 v214, v214, v218
    v_add_f32 v215, v215, v219
    v_lshlrev_b32 v218, 16, v50
    v_and_b32 v219, 0xffff0000, v50
    v_add_f32 v214, v214, v218
    v_add_f32 v215, v215, v219
    v_lshlrev_b32 v218, 16, v51
    v_and_b32 v219, 0xffff0000, v51
    v_add_f32 v214, v214, v218
    v_add_f32 v215, v215, v219
K1_CS_76:
    ds_read_b128 v[36:39], v11 offset:0
    ds_read_b128 v[40:43], v201 offset:0
    ds_read_b64_tr_b16 v[44:45], v18 offset:2048
    ds_read_b64_tr_b16 v[46:47], v18 offset:2560
    ds_read_b64_tr_b16 v[48:49], v19 offset:2048
    ds_read_b64_tr_b16 v[50:51], v19 offset:2560
    s_waitcnt lgkmcnt(6)
    v_mfma_f32_32x32x16_bf16 v[64:79], v[28:31], v[20:23], v[64:79]
    v_mfma_f32_32x32x16_bf16 v[80:95], v[32:35], v[20:23], v[80:95]
    v_mfma_f32_32x32x16_bf16 v[96:111], v[28:31], v[24:27], v[96:111]
    v_mfma_f32_32x32x16_bf16 v[112:127], v[32:35], v[24:27], v[112:127]
    s_cmp_lg_u32 s36, 0
    s_cbranch_scc1 K1_CS_77
    v_lshlrev_b32 v218, 16, v28
    v_and_b32 v219, 0xffff0000, v28
    v_add_f32 v212, v212, v218
    v_add_f32 v213, v213, v219
    v_lshlrev_b32 v218, 16, v29
    v_and_b32 v219, 0xffff0000, v29
    v_add_f32 v212, v212, v218
    v_add_f32 v213, v213, v219
    v_lshlrev_b32 v218, 16, v30
    v_and_b32 v219, 0xffff0000, v30
    v_add_f32 v212, v212, v218
    v_add_f32 v213, v213, v219
    v_lshlrev_b32 v218, 16, v31
    v_and_b32 v219, 0xffff0000, v31
    v_add_f32 v212, v212, v218
    v_add_f32 v213, v213, v219
    v_lshlrev_b32 v218, 16, v32
    v_and_b32 v219, 0xffff0000, v32
    v_add_f32 v214, v214, v218
    v_add_f32 v215, v215, v219
    v_lshlrev_b32 v218, 16, v33
    v_and_b32 v219, 0xffff0000, v33
    v_add_f32 v214, v214, v218
    v_add_f32 v215, v215, v219
    v_lshlrev_b32 v218, 16, v34
    v_and_b32 v219, 0xffff0000, v34
    v_add_f32 v214, v214, v218
    v_add_f32 v215, v215, v219
    v_lshlrev_b32 v218, 16, v35
    v_and_b32 v219, 0xffff0000, v35
    v_add_f32 v214, v214, v218
    v_add_f32 v215, v215, v219
K1_CS_77:
    ds_read_b128 v[20:23], v12 offset:0
    ds_read_b128 v[24:27], v202 offset:0
    ds_read_b64_tr_b16 v[28:29], v18 offset:4096
    ds_read_b64_tr_b16 v[30:31], v18 offset:4608
    ds_read_b64_tr_b16 v[32:33], v19 offset:4096
    ds_read_b64_tr_b16 v[34:35], v19 offset:4608
    s_waitcnt lgkmcnt(6)
    v_mfma_f32_32x32x16_bf16 v[64:79], v[44:47], v[36:39], v[64:79]
    v_mfma_f32_32x32x16_bf16 v[80:95], v[48:51], v[36:39], v[80:95]
    v_mfma_f32_32x32x16_bf16 v[96:111], v[44:47], v[40:43], v[96:111]
    v_mfma_f32_32x32x16_bf16 v[112:127], v[48:51], v[40:43], v[112:127]
    s_cmp_lg_u32 s36, 1
    s_cbranch_scc1 K1_CS_78
    v_lshlrev_b32 v218, 16, v44
    v_and_b32 v219, 0xffff0000, v44
    v_add_f32 v212, v212, v218
    v_add_f32 v213, v213, v219
    v_lshlrev_b32 v218, 16, v45
    v_and_b32 v219, 0xffff0000, v45
    v_add_f32 v212, v212, v218
    v_add_f32 v213, v213, v219
    v_lshlrev_b32 v218, 16, v46
    v_and_b32 v219, 0xffff0000, v46
    v_add_f32 v212, v212, v218
    v_add_f32 v213, v213, v219
    v_lshlrev_b32 v218, 16, v47
    v_and_b32 v219, 0xffff0000, v47
    v_add_f32 v212, v212, v218
    v_add_f32 v213, v213, v219
    v_lshlrev_b32 v218, 16, v48
    v_and_b32 v219, 0xffff0000, v48
    v_add_f32 v214, v214, v218
    v_add_f32 v215, v215, v219
    v_lshlrev_b32 v218, 16, v49
    v_and_b32 v219, 0xffff0000, v49
    v_add_f32 v214, v214, v218
    v_add_f32 v215, v215, v219
    v_lshlrev_b32 v218, 16, v50
    v_and_b32 v219, 0xffff0000, v50
    v_add_f32 v214, v214, v218
    v_add_f32 v215, v215, v219
    v_lshlrev_b32 v218, 16, v51
    v_and_b32 v219, 0xffff0000, v51
    v_add_f32 v214, v214, v218
    v_add_f32 v215, v215, v219
K1_CS_78:
    s_cmp_lg_u32 s62, 0
    s_cbranch_scc1 K1_READY2_N
    s_waitcnt vmcnt(0)
    v_readfirstlane_b32 s39, v223
    s_cmp_lt_u32 s39, 40
    s_cbranch_scc1 K1_READY2_N

    buffer_load_dword v128, v220, s[20:23], s58 offen sc1
    buffer_load_dword v129, v220, s[20:23], s61 offen sc1
    buffer_load_dword v130, v220, s[20:23], s59 offen sc1
    buffer_load_dword v131, v220, s[20:23], s63 offen sc1
    s_mov_b32 s62, 1
K1_READY2_N:
    ds_read_b128 v[36:39], v13 offset:0
    ds_read_b128 v[40:43], v203 offset:0
    ds_read_b64_tr_b16 v[44:45], v18 offset:6144
    ds_read_b64_tr_b16 v[46:47], v18 offset:6656
    ds_read_b64_tr_b16 v[48:49], v19 offset:6144
    ds_read_b64_tr_b16 v[50:51], v19 offset:6656
    s_waitcnt lgkmcnt(6)
    v_mfma_f32_32x32x16_bf16 v[64:79], v[28:31], v[20:23], v[64:79]
    v_mfma_f32_32x32x16_bf16 v[80:95], v[32:35], v[20:23], v[80:95]
    v_mfma_f32_32x32x16_bf16 v[96:111], v[28:31], v[24:27], v[96:111]
    v_mfma_f32_32x32x16_bf16 v[112:127], v[32:35], v[24:27], v[112:127]
    s_cmp_lg_u32 s36, 2
    s_cbranch_scc1 K1_CS_79
    v_lshlrev_b32 v218, 16, v28
    v_and_b32 v219, 0xffff0000, v28
    v_add_f32 v212, v212, v218
    v_add_f32 v213, v213, v219
    v_lshlrev_b32 v218, 16, v29
    v_and_b32 v219, 0xffff0000, v29
    v_add_f32 v212, v212, v218
    v_add_f32 v213, v213, v219
    v_lshlrev_b32 v218, 16, v30
    v_and_b32 v219, 0xffff0000, v30
    v_add_f32 v212, v212, v218
    v_add_f32 v213, v213, v219
    v_lshlrev_b32 v218, 16, v31
    v_and_b32 v219, 0xffff0000, v31
    v_add_f32 v212, v212, v218
    v_add_f32 v213, v213, v219
    v_lshlrev_b32 v218, 16, v32
    v_and_b32 v219, 0xffff0000, v32
    v_add_f32 v214, v214, v218
    v_add_f32 v215, v215, v219
    v_lshlrev_b32 v218, 16, v33
    v_and_b32 v219, 0xffff0000, v33
    v_add_f32 v214, v214, v218
    v_add_f32 v215, v215, v219
    v_lshlrev_b32 v218, 16, v34
    v_and_b32 v219, 0xffff0000, v34
    v_add_f32 v214, v214, v218
    v_add_f32 v215, v215, v219
    v_lshlrev_b32 v218, 16, v35
    v_and_b32 v219, 0xffff0000, v35
    v_add_f32 v214, v214, v218
    v_add_f32 v215, v215, v219
K1_CS_79:
    s_waitcnt lgkmcnt(0)
    v_mfma_f32_32x32x16_bf16 v[64:79], v[44:47], v[36:39], v[64:79]
    v_mfma_f32_32x32x16_bf16 v[80:95], v[48:51], v[36:39], v[80:95]
    v_mfma_f32_32x32x16_bf16 v[96:111], v[44:47], v[40:43], v[96:111]
    v_mfma_f32_32x32x16_bf16 v[112:127], v[48:51], v[40:43], v[112:127]
    s_cmp_lg_u32 s36, 3
    s_cbranch_scc1 K1_CS_80
    v_lshlrev_b32 v218, 16, v44
    v_and_b32 v219, 0xffff0000, v44
    v_add_f32 v212, v212, v218
    v_add_f32 v213, v213, v219
    v_lshlrev_b32 v218, 16, v45
    v_and_b32 v219, 0xffff0000, v45
    v_add_f32 v212, v212, v218
    v_add_f32 v213, v213, v219
    v_lshlrev_b32 v218, 16, v46
    v_and_b32 v219, 0xffff0000, v46
    v_add_f32 v212, v212, v218
    v_add_f32 v213, v213, v219
    v_lshlrev_b32 v218, 16, v47
    v_and_b32 v219, 0xffff0000, v47
    v_add_f32 v212, v212, v218
    v_add_f32 v213, v213, v219
    v_lshlrev_b32 v218, 16, v48
    v_and_b32 v219, 0xffff0000, v48
    v_add_f32 v214, v214, v218
    v_add_f32 v215, v215, v219
    v_lshlrev_b32 v218, 16, v49
    v_and_b32 v219, 0xffff0000, v49
    v_add_f32 v214, v214, v218
    v_add_f32 v215, v215, v219
    v_lshlrev_b32 v218, 16, v50
    v_and_b32 v219, 0xffff0000, v50
    v_add_f32 v214, v214, v218
    v_add_f32 v215, v215, v219
    v_lshlrev_b32 v218, 16, v51
    v_and_b32 v219, 0xffff0000, v51
    v_add_f32 v214, v214, v218
    v_add_f32 v215, v215, v219
K1_CS_80:
    v_add_f32 v212, v212, v213
    v_add_f32 v214, v214, v215
    v_mov_b32 v213, v212
    v_mov_b32 v215, v214
    s_nop 1
    v_permlane32_swap_b32 v212, v213
    v_permlane32_swap_b32 v214, v215
    s_nop 1
    v_add_f32 v212, v212, v213
    v_add_f32 v214, v214, v215
    v_cndmask_b32 v212, v212, v214, s[48:49]
    s_lshl_b32 s39, s3, 8
    s_add_u32 s39, s39, 151552
    v_lshlrev_b32 v52, 2, v1
    v_add_u32 v53, s39, v52
    ds_write_b32 v53, v212
    s_lshl_b32 s39, s37, 10
    s_add_u32 s39, s39, 151552
    v_add_u32 v53, s39, v52
    s_waitcnt lgkmcnt(0)
    s_barrier
    ds_read_b32 v56, v53
    ds_read_b32 v57, v53 offset:256
    ds_read_b32 v58, v53 offset:512
    ds_read_b32 v59, v53 offset:768
    s_cmp_lg_u32 s62, 0
    s_cbranch_scc1 K1_READY_N
    s_mov_b32 s40, 0
K1_SPIN_N:
    global_load_dword v223, v222, s[52:53] sc1
    s_waitcnt vmcnt(0)
    v_readfirstlane_b32 s39, v223
    s_cmp_ge_u32 s39, 40
    s_cbranch_scc1 K1_SPINDONE_N
    s_sleep 4
    s_add_u32 s40, s40, 1
    s_cmp_lt_u32 s40, 0x40000
    s_cbranch_scc1 K1_SPIN_N
K1_SPINDONE_N:

    buffer_load_dword v128, v220, s[20:23], s58 offen sc1
    buffer_load_dword v129, v220, s[20:23], s61 offen sc1
    buffer_load_dword v130, v220, s[20:23], s59 offen sc1
    buffer_load_dword v131, v220, s[20:23], s63 offen sc1
K1_READY_N:
    s_waitcnt lgkmcnt(0)
    v_add_f32 v56, v56, v57
    v_add_f32 v58, v58, v59
    v_add_f32 v56, v56, v58

    s_lshl_b32 s39, s3, 8
    s_add_u32 s39, s39, 153600
    v_add_u32 v53, s39, v52
    ds_write_b32 v53, v56
    v_lshlrev_b32 v55, 4, v3
    v_add_u32 v55, s39, v55
    s_waitcnt lgkmcnt(0)

    ds_read_b128 v[132:135], v55 offset:0
    ds_read_b128 v[136:139], v55 offset:32
    ds_read_b128 v[140:143], v55 offset:64
    ds_read_b128 v[144:147], v55 offset:96
    ds_read_b128 v[148:151], v55 offset:128
    ds_read_b128 v[152:155], v55 offset:160
    ds_read_b128 v[156:159], v55 offset:192
    ds_read_b128 v[160:163], v55 offset:224
    s_waitcnt vmcnt(0) lgkmcnt(0)
    s_lshl_b32 s40, s34, 3
    s_lshl_b32 s41, s36, 1
    s_add_u32 s40, s40, s41
    s_add_u32 s40, s40, s37
    s_xor_b32 s41, s40, 1
    s_cmp_lg_u32 s64, 0
    s_cbranch_scc1 K1_EPI_H

    s_cmp_lt_u32 s66, 640
    s_cselect_b32 s39, 0, 640
    s_mov_b32 s43, 163840
    s_cselect_b32 s43, 81920, s43
    s_mov_b32 s44, 2560
    s_cselect_b32 s44, 1280, s44
    s_mov_b32 s45, 7864320
    s_cselect_b32 s45, 5242880, s45
    s_mov_b32 s46, 0x3f800000
    s_cselect_b32 s46, 0x3ea52b5c, s46
    s_sub_u32 s39, s66, s39
    s_lshr_b32 s39, s39, 3
    v_add_u32 v52, s39, v3
    s_mul_i32 s40, s40, s44
    s_mul_i32 s41, s41, s44
    s_add_u32 s40, s40, s45
    s_add_u32 s41, s41, s45
    s_add_u32 s60, s40, s43
    s_add_u32 s61, s41, s43
    s_movk_i32 s42, 0x3334
    v_and_b32 v53, 31, v1
    v_lshlrev_b32 v54, 4, v53
    v_lshlrev_b32 v53, 3, v53
    v_add_u32 v53, 1024, v53

    v_mul_f32 v128, s46, v128
    v_mul_f32 v129, s46, v129
    v_mul_f32 v130, s46, v130
    v_mul_f32 v131, s46, v131
    v_add_u32 v55, 0, v52
    v_mul_u32_u24 v56, s42, v55
    v_lshrrev_b32 v56, 16, v56
    v_mul_u32_u24 v57, 5, v56
    v_sub_u32 v57, v55, v57
    v_lshlrev_b32 v56, 1, v56
    v_cmp_lt_u32 vcc, 2, v57
    v_cmp_eq_u32 s[58:59], 2, v57
    v_mul_lo_u32 v59, v56, s43
    v_subrev_u32 v58, 3, v57
    v_cndmask_b32 v58, v57, v58, vcc
    v_mov_b32 v62, s43
    v_cndmask_b32 v62, 0, v62, vcc
    v_lshl_add_u32 v58, v58, 9, v54
    v_add3_u32 v58, v58, v59, v62
    v_add_u32 v59, v59, v53

    v_mul_f32 v192, v129, v132
    v_mul_f32 v193, v129, v133
    v_mul_f32 v194, v129, v134
    v_mul_f32 v195, v129, v135
    v_fma_f32 v64, v64, v128, v192
    v_fma_f32 v65, v65, v128, v193
    v_fma_f32 v66, v66, v128, v194
    v_fma_f32 v67, v67, v128, v195
    v_cvt_pk_bf16_f32 v20, v64, v65
    v_cvt_pk_bf16_f32 v21, v66, v67
    v_mul_f32 v192, v129, v136
    v_mul_f32 v193, v129, v137
    v_mul_f32 v194, v129, v138
    v_mul_f32 v195, v129, v139
    v_fma_f32 v68, v68, v128, v192
    v_fma_f32 v69, v69, v128, v193
    v_fma_f32 v70, v70, v128, v194
    v_fma_f32 v71, v71, v128, v195
    v_cvt_pk_bf16_f32 v22, v68, v69
    v_cvt_pk_bf16_f32 v23, v70, v71
    s_nop 1
    v_permlane32_swap_b32 v20, v22
    v_permlane32_swap_b32 v21, v23
    v_mul_f32 v192, v131, v132
    v_mul_f32 v193, v131, v133
    v_mul_f32 v194, v131, v134
    v_mul_f32 v195, v131, v135
    v_fma_f32 v96, v96, v130, v192
    v_fma_f32 v97, v97, v130, v193
    v_fma_f32 v98, v98, v130, v194
    v_fma_f32 v99, v99, v130, v195
    v_cvt_pk_bf16_f32 v24, v96, v97
    v_cvt_pk_bf16_f32 v25, v98, v99
    v_mul_f32 v192, v131, v136
    v_mul_f32 v193, v131, v137
    v_mul_f32 v194, v131, v138
    v_mul_f32 v195, v131, v139
    v_fma_f32 v100, v100, v130, v192
    v_fma_f32 v101, v101, v130, v193
    v_fma_f32 v102, v102, v130, v194
    v_fma_f32 v103, v103, v130, v195
    v_cvt_pk_bf16_f32 v26, v100, v101
    v_cvt_pk_bf16_f32 v27, v102, v103
    s_nop 1
    v_permlane32_swap_b32 v24, v26
    v_permlane32_swap_b32 v25, v27
    s_andn2_b64 exec, exec, s[58:59]
    buffer_store_dwordx4 v[20:23], v58, s[20:23], s40 offen
    buffer_store_dwordx4 v[24:27], v58, s[20:23], s41 offen
    s_mov_b64 exec, s[58:59]
    s_cbranch_execz K1_QKB_81
    buffer_store_dwordx2 v[20:21], v59, s[20:23], s40 offen
    buffer_store_dwordx2 v[22:23], v59, s[20:23], s60 offen
    buffer_store_dwordx2 v[24:25], v59, s[20:23], s41 offen
    buffer_store_dwordx2 v[26:27], v59, s[20:23], s61 offen
K1_QKB_81:
    s_mov_b64 exec, -1
    v_add_u32 v55, 2, v52
    v_mul_u32_u24 v56, s42, v55
    v_lshrrev_b32 v56, 16, v56
    v_mul_u32_u24 v57, 5, v56
    v_sub_u32 v57, v55, v57
    v_lshlrev_b32 v56, 1, v56
    v_cmp_lt_u32 vcc, 2, v57
    v_cmp_eq_u32 s[58:59], 2, v57
    v_mul_lo_u32 v59, v56, s43
    v_subrev_u32 v58, 3, v57
    v_cndmask_b32 v58, v57, v58, vcc
    v_mov_b32 v62, s43
    v_cndmask_b32 v62, 0, v62, vcc
    v_lshl_add_u32 v58, v58, 9, v54
    v_add3_u32 v58, v58, v59, v62
    v_add_u32 v59, v59, v53

    v_mul_f32 v192, v129, v140
    v_mul_f32 v193, v129, v141
    v_mul_f32 v194, v129, v142
    v_mul_f32 v195, v129, v143
    v_fma_f32 v72, v72, v128, v192
    v_fma_f32 v73, v73, v128, v193
    v_fma_f32 v74, v74, v128, v194
    v_fma_f32 v75, v75, v128, v195
    v_cvt_pk_bf16_f32 v28, v72, v73
    v_cvt_pk_bf16_f32 v29, v74, v75
    v_mul_f32 v192, v129, v144
    v_mul_f32 v193, v129, v145
    v_mul_f32 v194, v129, v146
    v_mul_f32 v195, v129, v147
    v_fma_f32 v76, v76, v128, v192
    v_fma_f32 v77, v77, v128, v193
    v_fma_f32 v78, v78, v128, v194
    v_fma_f32 v79, v79, v128, v195
    v_cvt_pk_bf16_f32 v30, v76, v77
    v_cvt_pk_bf16_f32 v31, v78, v79
    s_nop 1
    v_permlane32_swap_b32 v28, v30
    v_permlane32_swap_b32 v29, v31
    v_mul_f32 v192, v131, v140
    v_mul_f32 v193, v131, v141
    v_mul_f32 v194, v131, v142
    v_mul_f32 v195, v131, v143
    v_fma_f32 v104, v104, v130, v192
    v_fma_f32 v105, v105, v130, v193
    v_fma_f32 v106, v106, v130, v194
    v_fma_f32 v107, v107, v130, v195
    v_cvt_pk_bf16_f32 v32, v104, v105
    v_cvt_pk_bf16_f32 v33, v106, v107
    v_mul_f32 v192, v131, v144
    v_mul_f32 v193, v131, v145
    v_mul_f32 v194, v131, v146
    v_mul_f32 v195, v131, v147
    v_fma_f32 v108, v108, v130, v192
    v_fma_f32 v109, v109, v130, v193
    v_fma_f32 v110, v110, v130, v194
    v_fma_f32 v111, v111, v130, v195
    v_cvt_pk_bf16_f32 v34, v108, v109
    v_cvt_pk_bf16_f32 v35, v110, v111
    s_nop 1
    v_permlane32_swap_b32 v32, v34
    v_permlane32_swap_b32 v33, v35
    s_andn2_b64 exec, exec, s[58:59]
    buffer_store_dwordx4 v[28:31], v58, s[20:23], s40 offen
    buffer_store_dwordx4 v[32:35], v58, s[20:23], s41 offen
    s_mov_b64 exec, s[58:59]
    s_cbranch_execz K1_QKB_82
    buffer_store_dwordx2 v[28:29], v59, s[20:23], s40 offen
    buffer_store_dwordx2 v[30:31], v59, s[20:23], s60 offen
    buffer_store_dwordx2 v[32:33], v59, s[20:23], s41 offen
    buffer_store_dwordx2 v[34:35], v59, s[20:23], s61 offen
K1_QKB_82:
    s_mov_b64 exec, -1
    v_add_u32 v55, 4, v52
    v_mul_u32_u24 v56, s42, v55
    v_lshrrev_b32 v56, 16, v56
    v_mul_u32_u24 v57, 5, v56
    v_sub_u32 v57, v55, v57
    v_lshlrev_b32 v56, 1, v56
    v_cmp_lt_u32 vcc, 2, v57
    v_cmp_eq_u32 s[58:59], 2, v57
    v_mul_lo_u32 v59, v56, s43
    v_subrev_u32 v58, 3, v57
    v_cndmask_b32 v58, v57, v58, vcc
    v_mov_b32 v62, s43
    v_cndmask_b32 v62, 0, v62, vcc
    v_lshl_add_u32 v58, v58, 9, v54
    v_add3_u32 v58, v58, v59, v62
    v_add_u32 v59, v59, v53

    v_mul_f32 v192, v129, v148
    v_mul_f32 v193, v129, v149
    v_mul_f32 v194, v129, v150
    v_mul_f32 v195, v129, v151
    v_fma_f32 v80, v80, v128, v192
    v_fma_f32 v81, v81, v128, v193
    v_fma_f32 v82, v82, v128, v194
    v_fma_f32 v83, v83, v128, v195
    v_cvt_pk_bf16_f32 v36, v80, v81
    v_cvt_pk_bf16_f32 v37, v82, v83
    v_mul_f32 v192, v129, v152
    v_mul_f32 v193, v129, v153
    v_mul_f32 v194, v129, v154
    v_mul_f32 v195, v129, v155
    v_fma_f32 v84, v84, v128, v192
    v_fma_f32 v85, v85, v128, v193
    v_fma_f32 v86, v86, v128, v194
    v_fma_f32 v87, v87, v128, v195
    v_cvt_pk_bf16_f32 v38, v84, v85
    v_cvt_pk_bf16_f32 v39, v86, v87
    s_nop 1
    v_permlane32_swap_b32 v36, v38
    v_permlane32_swap_b32 v37, v39
    v_mul_f32 v192, v131, v148
    v_mul_f32 v193, v131, v149
    v_mul_f32 v194, v131, v150
    v_mul_f32 v195, v131, v151
    v_fma_f32 v112, v112, v130, v192
    v_fma_f32 v113, v113, v130, v193
    v_fma_f32 v114, v114, v130, v194
    v_fma_f32 v115, v115, v130, v195
    v_cvt_pk_bf16_f32 v40, v112, v113
    v_cvt_pk_bf16_f32 v41, v114, v115
    v_mul_f32 v192, v131, v152
    v_mul_f32 v193, v131, v153
    v_mul_f32 v194, v131, v154
    v_mul_f32 v195, v131, v155
    v_fma_f32 v116, v116, v130, v192
    v_fma_f32 v117, v117, v130, v193
    v_fma_f32 v118, v118, v130, v194
    v_fma_f32 v119, v119, v130, v195
    v_cvt_pk_bf16_f32 v42, v116, v117
    v_cvt_pk_bf16_f32 v43, v118, v119
    s_nop 1
    v_permlane32_swap_b32 v40, v42
    v_permlane32_swap_b32 v41, v43
    s_andn2_b64 exec, exec, s[58:59]
    buffer_store_dwordx4 v[36:39], v58, s[20:23], s40 offen
    buffer_store_dwordx4 v[40:43], v58, s[20:23], s41 offen
    s_mov_b64 exec, s[58:59]
    s_cbranch_execz K1_QKB_83
    buffer_store_dwordx2 v[36:37], v59, s[20:23], s40 offen
    buffer_store_dwordx2 v[38:39], v59, s[20:23], s60 offen
    buffer_store_dwordx2 v[40:41], v59, s[20:23], s41 offen
    buffer_store_dwordx2 v[42:43], v59, s[20:23], s61 offen
K1_QKB_83:
    s_mov_b64 exec, -1
    v_add_u32 v55, 6, v52
    v_mul_u32_u24 v56, s42, v55
    v_lshrrev_b32 v56, 16, v56
    v_mul_u32_u24 v57, 5, v56
    v_sub_u32 v57, v55, v57
    v_lshlrev_b32 v56, 1, v56
    v_cmp_lt_u32 vcc, 2, v57
    v_cmp_eq_u32 s[58:59], 2, v57
    v_mul_lo_u32 v59, v56, s43
    v_subrev_u32 v58, 3, v57
    v_cndmask_b32 v58, v57, v58, vcc
    v_mov_b32 v62, s43
    v_cndmask_b32 v62, 0, v62, vcc
    v_lshl_add_u32 v58, v58, 9, v54
    v_add3_u32 v58, v58, v59, v62
    v_add_u32 v59, v59, v53

    v_mul_f32 v192, v129, v156
    v_mul_f32 v193, v129, v157
    v_mul_f32 v194, v129, v158
    v_mul_f32 v195, v129, v159
    v_fma_f32 v88, v88, v128, v192
    v_fma_f32 v89, v89, v128, v193
    v_fma_f32 v90, v90, v128, v194
    v_fma_f32 v91, v91, v128, v195
    v_cvt_pk_bf16_f32 v44, v88, v89
    v_cvt_pk_bf16_f32 v45, v90, v91
    v_mul_f32 v192, v129, v160
    v_mul_f32 v193, v129, v161
    v_mul_f32 v194, v129, v162
    v_mul_f32 v195, v129, v163
    v_fma_f32 v92, v92, v128, v192
    v_fma_f32 v93, v93, v128, v193
    v_fma_f32 v94, v94, v128, v194
    v_fma_f32 v95, v95, v128, v195
    v_cvt_pk_bf16_f32 v46, v92, v93
    v_cvt_pk_bf16_f32 v47, v94, v95
    s_nop 1
    v_permlane32_swap_b32 v44, v46
    v_permlane32_swap_b32 v45, v47
    v_mul_f32 v192, v131, v156
    v_mul_f32 v193, v131, v157
    v_mul_f32 v194, v131, v158
    v_mul_f32 v195, v131, v159
    v_fma_f32 v120, v120, v130, v192
    v_fma_f32 v121, v121, v130, v193
    v_fma_f32 v122, v122, v130, v194
    v_fma_f32 v123, v123, v130, v195
    v_cvt_pk_bf16_f32 v48, v120, v121
    v_cvt_pk_bf16_f32 v49, v122, v123
    v_mul_f32 v192, v131, v160
    v_mul_f32 v193, v131, v161
    v_mul_f32 v194, v131, v162
    v_mul_f32 v195, v131, v163
    v_fma_f32 v124, v124, v130, v192
    v_fma_f32 v125, v125, v130, v193
    v_fma_f32 v126, v126, v130, v194
    v_fma_f32 v127, v127, v130, v195
    v_cvt_pk_bf16_f32 v50, v124, v125
    v_cvt_pk_bf16_f32 v51, v126, v127
    s_nop 1
    v_permlane32_swap_b32 v48, v50
    v_permlane32_swap_b32 v49, v51
    s_andn2_b64 exec, exec, s[58:59]
    buffer_store_dwordx4 v[44:47], v58, s[20:23], s40 offen
    buffer_store_dwordx4 v[48:51], v58, s[20:23], s41 offen
    s_mov_b64 exec, s[58:59]
    s_cbranch_execz K1_QKB_84
    buffer_store_dwordx2 v[44:45], v59, s[20:23], s40 offen
    buffer_store_dwordx2 v[46:47], v59, s[20:23], s60 offen
    buffer_store_dwordx2 v[48:49], v59, s[20:23], s41 offen
    buffer_store_dwordx2 v[50:51], v59, s[20:23], s61 offen
K1_QKB_84:
    s_mov_b64 exec, -1
    s_endpgm
K1_EPI_H:
    v_and_b32 v52, 31, v1
    v_lshlrev_b32 v52, 4, v52
    v_lshl_add_u32 v52, v3, 3, v52
    s_mul_i32 s40, s40, 147456
    s_mul_i32 s41, s41, 147456
    s_lshl_b32 s39, s65, 2
    s_add_u32 s39, s39, 48
    s_lshl_b32 s39, s39, 10
    s_add_u32 s39, s39, 13172736
    s_add_u32 s40, s40, s39
    s_add_u32 s41, s41, s39
    v_mov_b32 v53, 0xbdd2d3e8

    v_lshlrev_b32 v52, 4, v1
    v_lshlrev_b32 v180, 16, v164
    v_and_b32 v181, 0xffff0000, v164
    v_lshlrev_b32 v182, 16, v165
    v_and_b32 v183, 0xffff0000, v165
    v_lshlrev_b32 v184, 16, v166
    v_and_b32 v185, 0xffff0000, v166
    v_lshlrev_b32 v186, 16, v167
    v_and_b32 v187, 0xffff0000, v167
    v_fma_f32 v58, v129, v132, v180
    v_fma_f32 v59, v129, v133, v181
    v_fma_f32 v60, v129, v134, v182
    v_fma_f32 v61, v129, v135, v183
    v_fma_f32 v64, v64, v128, v58
    v_fma_f32 v65, v65, v128, v59
    v_fma_f32 v66, v66, v128, v60
    v_fma_f32 v67, v67, v128, v61
    v_mul_f32 v54, v64, v64
    v_mul_f32 v55, v65, v65
    v_mul_f32 v56, v66, v66
    v_mul_f32 v57, v67, v67
    v_fmaak_f32 v54, v54, v53, 0xc0135761
    v_fmaak_f32 v55, v55, v53, 0xc0135761
    v_fmaak_f32 v56, v56, v53, 0xc0135761
    v_fmaak_f32 v57, v57, v53, 0xc0135761
    v_mul_f32 v54, v54, v64
    v_mul_f32 v55, v55, v65
    v_mul_f32 v56, v56, v66
    v_mul_f32 v57, v57, v67
    v_exp_f32 v54, v54
    v_exp_f32 v55, v55
    v_exp_f32 v56, v56
    v_exp_f32 v57, v57
    v_add_f32 v54, 1.0, v54
    v_add_f32 v55, 1.0, v55
    v_add_f32 v56, 1.0, v56
    v_add_f32 v57, 1.0, v57
    v_rcp_f32 v54, v54
    v_rcp_f32 v55, v55
    v_rcp_f32 v56, v56
    v_rcp_f32 v57, v57
    v_mul_f32 v54, v54, v64
    v_mul_f32 v55, v55, v65
    v_mul_f32 v56, v56, v66
    v_mul_f32 v57, v57, v67
    v_cvt_pk_bf16_f32 v20, v54, v55
    v_cvt_pk_bf16_f32 v21, v56, v57
    v_fma_f32 v58, v129, v136, v184
    v_fma_f32 v59, v129, v137, v185
    v_fma_f32 v60, v129, v138, v186
    v_fma_f32 v61, v129, v139, v187
    v_fma_f32 v68, v68, v128, v58
    v_fma_f32 v69, v69, v128, v59
    v_fma_f32 v70, v70, v128, v60
    v_fma_f32 v71, v71, v128, v61
    v_mul_f32 v54, v68, v68
    v_mul_f32 v55, v69, v69
    v_mul_f32 v56, v70, v70
    v_mul_f32 v57, v71, v71
    v_fmaak_f32 v54, v54, v53, 0xc0135761
    v_fmaak_f32 v55, v55, v53, 0xc0135761
    v_fmaak_f32 v56, v56, v53, 0xc0135761
    v_fmaak_f32 v57, v57, v53, 0xc0135761
    v_mul_f32 v54, v54, v68
    v_mul_f32 v55, v55, v69
    v_mul_f32 v56, v56, v70
    v_mul_f32 v57, v57, v71
    v_exp_f32 v54, v54
    v_exp_f32 v55, v55
    v_exp_f32 v56, v56
    v_exp_f32 v57, v57
    v_add_f32 v54, 1.0, v54
    v_add_f32 v55, 1.0, v55
    v_add_f32 v56, 1.0, v56
    v_add_f32 v57, 1.0, v57
    v_rcp_f32 v54, v54
    v_rcp_f32 v55, v55
    v_rcp_f32 v56, v56
    v_rcp_f32 v57, v57
    v_mul_f32 v54, v54, v68
    v_mul_f32 v55, v55, v69
    v_mul_f32 v56, v56, v70
    v_mul_f32 v57, v57, v71
    v_cvt_pk_bf16_f32 v22, v54, v55
    v_cvt_pk_bf16_f32 v23, v56, v57
    s_nop 1
    v_permlane32_swap_b32 v20, v22
    v_permlane32_swap_b32 v21, v23
    buffer_store_dwordx4 v[20:23], v52, s[20:23], s40 offen offset:0
    v_fma_f32 v58, v131, v132, v180
    v_fma_f32 v59, v131, v133, v181
    v_fma_f32 v60, v131, v134, v182
    v_fma_f32 v61, v131, v135, v183
    v_fma_f32 v96, v96, v130, v58
    v_fma_f32 v97, v97, v130, v59
    v_fma_f32 v98, v98, v130, v60
    v_fma_f32 v99, v99, v130, v61
    v_mul_f32 v54, v96, v96
    v_mul_f32 v55, v97, v97
    v_mul_f32 v56, v98, v98
    v_mul_f32 v57, v99, v99
    v_fmaak_f32 v54, v54, v53, 0xc0135761
    v_fmaak_f32 v55, v55, v53, 0xc0135761
    v_fmaak_f32 v56, v56, v53, 0xc0135761
    v_fmaak_f32 v57, v57, v53, 0xc0135761
    v_mul_f32 v54, v54, v96
    v_mul_f32 v55, v55, v97
    v_mul_f32 v56, v56, v98
    v_mul_f32 v57, v57, v99
    v_exp_f32 v54, v54
    v_exp_f32 v55, v55
    v_exp_f32 v56, v56
    v_exp_f32 v57, v57
    v_add_f32 v54, 1.0, v54
    v_add_f32 v55, 1.0, v55
    v_add_f32 v56, 1.0, v56
    v_add_f32 v57, 1.0, v57
    v_rcp_f32 v54, v54
    v_rcp_f32 v55, v55
    v_rcp_f32 v56, v56
    v_rcp_f32 v57, v57
    v_mul_f32 v54, v54, v96
    v_mul_f32 v55, v55, v97
    v_mul_f32 v56, v56, v98
    v_mul_f32 v57, v57, v99
    v_cvt_pk_bf16_f32 v24, v54, v55
    v_cvt_pk_bf16_f32 v25, v56, v57
    v_fma_f32 v58, v131, v136, v184
    v_fma_f32 v59, v131, v137, v185
    v_fma_f32 v60, v131, v138, v186
    v_fma_f32 v61, v131, v139, v187
    v_fma_f32 v100, v100, v130, v58
    v_fma_f32 v101, v101, v130, v59
    v_fma_f32 v102, v102, v130, v60
    v_fma_f32 v103, v103, v130, v61
    v_mul_f32 v54, v100, v100
    v_mul_f32 v55, v101, v101
    v_mul_f32 v56, v102, v102
    v_mul_f32 v57, v103, v103
    v_fmaak_f32 v54, v54, v53, 0xc0135761
    v_fmaak_f32 v55, v55, v53, 0xc0135761
    v_fmaak_f32 v56, v56, v53, 0xc0135761
    v_fmaak_f32 v57, v57, v53, 0xc0135761
    v_mul_f32 v54, v54, v100
    v_mul_f32 v55, v55, v101
    v_mul_f32 v56, v56, v102
    v_mul_f32 v57, v57, v103
    v_exp_f32 v54, v54
    v_exp_f32 v55, v55
    v_exp_f32 v56, v56
    v_exp_f32 v57, v57
    v_add_f32 v54, 1.0, v54
    v_add_f32 v55, 1.0, v55
    v_add_f32 v56, 1.0, v56
    v_add_f32 v57, 1.0, v57
    v_rcp_f32 v54, v54
    v_rcp_f32 v55, v55
    v_rcp_f32 v56, v56
    v_rcp_f32 v57, v57
    v_mul_f32 v54, v54, v100
    v_mul_f32 v55, v55, v101
    v_mul_f32 v56, v56, v102
    v_mul_f32 v57, v57, v103
    v_cvt_pk_bf16_f32 v26, v54, v55
    v_cvt_pk_bf16_f32 v27, v56, v57
    s_nop 1
    v_permlane32_swap_b32 v24, v26
    v_permlane32_swap_b32 v25, v27
    buffer_store_dwordx4 v[24:27], v52, s[20:23], s41 offen offset:0
    v_lshlrev_b32 v180, 16, v168
    v_and_b32 v181, 0xffff0000, v168
    v_lshlrev_b32 v182, 16, v169
    v_and_b32 v183, 0xffff0000, v169
    v_lshlrev_b32 v184, 16, v170
    v_and_b32 v185, 0xffff0000, v170
    v_lshlrev_b32 v186, 16, v171
    v_and_b32 v187, 0xffff0000, v171
    v_fma_f32 v58, v129, v140, v180
    v_fma_f32 v59, v129, v141, v181
    v_fma_f32 v60, v129, v142, v182
    v_fma_f32 v61, v129, v143, v183
    v_fma_f32 v72, v72, v128, v58
    v_fma_f32 v73, v73, v128, v59
    v_fma_f32 v74, v74, v128, v60
    v_fma_f32 v75, v75, v128, v61
    v_mul_f32 v54, v72, v72
    v_mul_f32 v55, v73, v73
    v_mul_f32 v56, v74, v74
    v_mul_f32 v57, v75, v75
    v_fmaak_f32 v54, v54, v53, 0xc0135761
    v_fmaak_f32 v55, v55, v53, 0xc0135761
    v_fmaak_f32 v56, v56, v53, 0xc0135761
    v_fmaak_f32 v57, v57, v53, 0xc0135761
    v_mul_f32 v54, v54, v72
    v_mul_f32 v55, v55, v73
    v_mul_f32 v56, v56, v74
    v_mul_f32 v57, v57, v75
    v_exp_f32 v54, v54
    v_exp_f32 v55, v55
    v_exp_f32 v56, v56
    v_exp_f32 v57, v57
    v_add_f32 v54, 1.0, v54
    v_add_f32 v55, 1.0, v55
    v_add_f32 v56, 1.0, v56
    v_add_f32 v57, 1.0, v57
    v_rcp_f32 v54, v54
    v_rcp_f32 v55, v55
    v_rcp_f32 v56, v56
    v_rcp_f32 v57, v57
    v_mul_f32 v54, v54, v72
    v_mul_f32 v55, v55, v73
    v_mul_f32 v56, v56, v74
    v_mul_f32 v57, v57, v75
    v_cvt_pk_bf16_f32 v28, v54, v55
    v_cvt_pk_bf16_f32 v29, v56, v57
    v_fma_f32 v58, v129, v144, v184
    v_fma_f32 v59, v129, v145, v185
    v_fma_f32 v60, v129, v146, v186
    v_fma_f32 v61, v129, v147, v187
    v_fma_f32 v76, v76, v128, v58
    v_fma_f32 v77, v77, v128, v59
    v_fma_f32 v78, v78, v128, v60
    v_fma_f32 v79, v79, v128, v61
    v_mul_f32 v54, v76, v76
    v_mul_f32 v55, v77, v77
    v_mul_f32 v56, v78, v78
    v_mul_f32 v57, v79, v79
    v_fmaak_f32 v54, v54, v53, 0xc0135761
    v_fmaak_f32 v55, v55, v53, 0xc0135761
    v_fmaak_f32 v56, v56, v53, 0xc0135761
    v_fmaak_f32 v57, v57, v53, 0xc0135761
    v_mul_f32 v54, v54, v76
    v_mul_f32 v55, v55, v77
    v_mul_f32 v56, v56, v78
    v_mul_f32 v57, v57, v79
    v_exp_f32 v54, v54
    v_exp_f32 v55, v55
    v_exp_f32 v56, v56
    v_exp_f32 v57, v57
    v_add_f32 v54, 1.0, v54
    v_add_f32 v55, 1.0, v55
    v_add_f32 v56, 1.0, v56
    v_add_f32 v57, 1.0, v57
    v_rcp_f32 v54, v54
    v_rcp_f32 v55, v55
    v_rcp_f32 v56, v56
    v_rcp_f32 v57, v57
    v_mul_f32 v54, v54, v76
    v_mul_f32 v55, v55, v77
    v_mul_f32 v56, v56, v78
    v_mul_f32 v57, v57, v79
    v_cvt_pk_bf16_f32 v30, v54, v55
    v_cvt_pk_bf16_f32 v31, v56, v57
    s_nop 1
    v_permlane32_swap_b32 v28, v30
    v_permlane32_swap_b32 v29, v31
    buffer_store_dwordx4 v[28:31], v52, s[20:23], s40 offen offset:1024
    v_fma_f32 v58, v131, v140, v180
    v_fma_f32 v59, v131, v141, v181
    v_fma_f32 v60, v131, v142, v182
    v_fma_f32 v61, v131, v143, v183
    v_fma_f32 v104, v104, v130, v58
    v_fma_f32 v105, v105, v130, v59
    v_fma_f32 v106, v106, v130, v60
    v_fma_f32 v107, v107, v130, v61
    v_mul_f32 v54, v104, v104
    v_mul_f32 v55, v105, v105
    v_mul_f32 v56, v106, v106
    v_mul_f32 v57, v107, v107
    v_fmaak_f32 v54, v54, v53, 0xc0135761
    v_fmaak_f32 v55, v55, v53, 0xc0135761
    v_fmaak_f32 v56, v56, v53, 0xc0135761
    v_fmaak_f32 v57, v57, v53, 0xc0135761
    v_mul_f32 v54, v54, v104
    v_mul_f32 v55, v55, v105
    v_mul_f32 v56, v56, v106
    v_mul_f32 v57, v57, v107
    v_exp_f32 v54, v54
    v_exp_f32 v55, v55
    v_exp_f32 v56, v56
    v_exp_f32 v57, v57
    v_add_f32 v54, 1.0, v54
    v_add_f32 v55, 1.0, v55
    v_add_f32 v56, 1.0, v56
    v_add_f32 v57, 1.0, v57
    v_rcp_f32 v54, v54
    v_rcp_f32 v55, v55
    v_rcp_f32 v56, v56
    v_rcp_f32 v57, v57
    v_mul_f32 v54, v54, v104
    v_mul_f32 v55, v55, v105
    v_mul_f32 v56, v56, v106
    v_mul_f32 v57, v57, v107
    v_cvt_pk_bf16_f32 v32, v54, v55
    v_cvt_pk_bf16_f32 v33, v56, v57
    v_fma_f32 v58, v131, v144, v184
    v_fma_f32 v59, v131, v145, v185
    v_fma_f32 v60, v131, v146, v186
    v_fma_f32 v61, v131, v147, v187
    v_fma_f32 v108, v108, v130, v58
    v_fma_f32 v109, v109, v130, v59
    v_fma_f32 v110, v110, v130, v60
    v_fma_f32 v111, v111, v130, v61
    v_mul_f32 v54, v108, v108
    v_mul_f32 v55, v109, v109
    v_mul_f32 v56, v110, v110
    v_mul_f32 v57, v111, v111
    v_fmaak_f32 v54, v54, v53, 0xc0135761
    v_fmaak_f32 v55, v55, v53, 0xc0135761
    v_fmaak_f32 v56, v56, v53, 0xc0135761
    v_fmaak_f32 v57, v57, v53, 0xc0135761
    v_mul_f32 v54, v54, v108
    v_mul_f32 v55, v55, v109
    v_mul_f32 v56, v56, v110
    v_mul_f32 v57, v57, v111
    v_exp_f32 v54, v54
    v_exp_f32 v55, v55
    v_exp_f32 v56, v56
    v_exp_f32 v57, v57
    v_add_f32 v54, 1.0, v54
    v_add_f32 v55, 1.0, v55
    v_add_f32 v56, 1.0, v56
    v_add_f32 v57, 1.0, v57
    v_rcp_f32 v54, v54
    v_rcp_f32 v55, v55
    v_rcp_f32 v56, v56
    v_rcp_f32 v57, v57
    v_mul_f32 v54, v54, v108
    v_mul_f32 v55, v55, v109
    v_mul_f32 v56, v56, v110
    v_mul_f32 v57, v57, v111
    v_cvt_pk_bf16_f32 v34, v54, v55
    v_cvt_pk_bf16_f32 v35, v56, v57
    s_nop 1
    v_permlane32_swap_b32 v32, v34
    v_permlane32_swap_b32 v33, v35
    buffer_store_dwordx4 v[32:35], v52, s[20:23], s41 offen offset:1024
    v_lshlrev_b32 v180, 16, v172
    v_and_b32 v181, 0xffff0000, v172
    v_lshlrev_b32 v182, 16, v173
    v_and_b32 v183, 0xffff0000, v173
    v_lshlrev_b32 v184, 16, v174
    v_and_b32 v185, 0xffff0000, v174
    v_lshlrev_b32 v186, 16, v175
    v_and_b32 v187, 0xffff0000, v175
    v_fma_f32 v58, v129, v148, v180
    v_fma_f32 v59, v129, v149, v181
    v_fma_f32 v60, v129, v150, v182
    v_fma_f32 v61, v129, v151, v183
    v_fma_f32 v80, v80, v128, v58
    v_fma_f32 v81, v81, v128, v59
    v_fma_f32 v82, v82, v128, v60
    v_fma_f32 v83, v83, v128, v61
    v_mul_f32 v54, v80, v80
    v_mul_f32 v55, v81, v81
    v_mul_f32 v56, v82, v82
    v_mul_f32 v57, v83, v83
    v_fmaak_f32 v54, v54, v53, 0xc0135761
    v_fmaak_f32 v55, v55, v53, 0xc0135761
    v_fmaak_f32 v56, v56, v53, 0xc0135761
    v_fmaak_f32 v57, v57, v53, 0xc0135761
    v_mul_f32 v54, v54, v80
    v_mul_f32 v55, v55, v81
    v_mul_f32 v56, v56, v82
    v_mul_f32 v57, v57, v83
    v_exp_f32 v54, v54
    v_exp_f32 v55, v55
    v_exp_f32 v56, v56
    v_exp_f32 v57, v57
    v_add_f32 v54, 1.0, v54
    v_add_f32 v55, 1.0, v55
    v_add_f32 v56, 1.0, v56
    v_add_f32 v57, 1.0, v57
    v_rcp_f32 v54, v54
    v_rcp_f32 v55, v55
    v_rcp_f32 v56, v56
    v_rcp_f32 v57, v57
    v_mul_f32 v54, v54, v80
    v_mul_f32 v55, v55, v81
    v_mul_f32 v56, v56, v82
    v_mul_f32 v57, v57, v83
    v_cvt_pk_bf16_f32 v36, v54, v55
    v_cvt_pk_bf16_f32 v37, v56, v57
    v_fma_f32 v58, v129, v152, v184
    v_fma_f32 v59, v129, v153, v185
    v_fma_f32 v60, v129, v154, v186
    v_fma_f32 v61, v129, v155, v187
    v_fma_f32 v84, v84, v128, v58
    v_fma_f32 v85, v85, v128, v59
    v_fma_f32 v86, v86, v128, v60
    v_fma_f32 v87, v87, v128, v61
    v_mul_f32 v54, v84, v84
    v_mul_f32 v55, v85, v85
    v_mul_f32 v56, v86, v86
    v_mul_f32 v57, v87, v87
    v_fmaak_f32 v54, v54, v53, 0xc0135761
    v_fmaak_f32 v55, v55, v53, 0xc0135761
    v_fmaak_f32 v56, v56, v53, 0xc0135761
    v_fmaak_f32 v57, v57, v53, 0xc0135761
    v_mul_f32 v54, v54, v84
    v_mul_f32 v55, v55, v85
    v_mul_f32 v56, v56, v86
    v_mul_f32 v57, v57, v87
    v_exp_f32 v54, v54
    v_exp_f32 v55, v55
    v_exp_f32 v56, v56
    v_exp_f32 v57, v57
    v_add_f32 v54, 1.0, v54
    v_add_f32 v55, 1.0, v55
    v_add_f32 v56, 1.0, v56
    v_add_f32 v57, 1.0, v57
    v_rcp_f32 v54, v54
    v_rcp_f32 v55, v55
    v_rcp_f32 v56, v56
    v_rcp_f32 v57, v57
    v_mul_f32 v54, v54, v84
    v_mul_f32 v55, v55, v85
    v_mul_f32 v56, v56, v86
    v_mul_f32 v57, v57, v87
    v_cvt_pk_bf16_f32 v38, v54, v55
    v_cvt_pk_bf16_f32 v39, v56, v57
    s_nop 1
    v_permlane32_swap_b32 v36, v38
    v_permlane32_swap_b32 v37, v39
    buffer_store_dwordx4 v[36:39], v52, s[20:23], s40 offen offset:2048
    v_fma_f32 v58, v131, v148, v180
    v_fma_f32 v59, v131, v149, v181
    v_fma_f32 v60, v131, v150, v182
    v_fma_f32 v61, v131, v151, v183
    v_fma_f32 v112, v112, v130, v58
    v_fma_f32 v113, v113, v130, v59
    v_fma_f32 v114, v114, v130, v60
    v_fma_f32 v115, v115, v130, v61
    v_mul_f32 v54, v112, v112
    v_mul_f32 v55, v113, v113
    v_mul_f32 v56, v114, v114
    v_mul_f32 v57, v115, v115
    v_fmaak_f32 v54, v54, v53, 0xc0135761
    v_fmaak_f32 v55, v55, v53, 0xc0135761
    v_fmaak_f32 v56, v56, v53, 0xc0135761
    v_fmaak_f32 v57, v57, v53, 0xc0135761
    v_mul_f32 v54, v54, v112
    v_mul_f32 v55, v55, v113
    v_mul_f32 v56, v56, v114
    v_mul_f32 v57, v57, v115
    v_exp_f32 v54, v54
    v_exp_f32 v55, v55
    v_exp_f32 v56, v56
    v_exp_f32 v57, v57
    v_add_f32 v54, 1.0, v54
    v_add_f32 v55, 1.0, v55
    v_add_f32 v56, 1.0, v56
    v_add_f32 v57, 1.0, v57
    v_rcp_f32 v54, v54
    v_rcp_f32 v55, v55
    v_rcp_f32 v56, v56
    v_rcp_f32 v57, v57
    v_mul_f32 v54, v54, v112
    v_mul_f32 v55, v55, v113
    v_mul_f32 v56, v56, v114
    v_mul_f32 v57, v57, v115
    v_cvt_pk_bf16_f32 v40, v54, v55
    v_cvt_pk_bf16_f32 v41, v56, v57
    v_fma_f32 v58, v131, v152, v184
    v_fma_f32 v59, v131, v153, v185
    v_fma_f32 v60, v131, v154, v186
    v_fma_f32 v61, v131, v155, v187
    v_fma_f32 v116, v116, v130, v58
    v_fma_f32 v117, v117, v130, v59
    v_fma_f32 v118, v118, v130, v60
    v_fma_f32 v119, v119, v130, v61
    v_mul_f32 v54, v116, v116
    v_mul_f32 v55, v117, v117
    v_mul_f32 v56, v118, v118
    v_mul_f32 v57, v119, v119
    v_fmaak_f32 v54, v54, v53, 0xc0135761
    v_fmaak_f32 v55, v55, v53, 0xc0135761
    v_fmaak_f32 v56, v56, v53, 0xc0135761
    v_fmaak_f32 v57, v57, v53, 0xc0135761
    v_mul_f32 v54, v54, v116
    v_mul_f32 v55, v55, v117
    v_mul_f32 v56, v56, v118
    v_mul_f32 v57, v57, v119
    v_exp_f32 v54, v54
    v_exp_f32 v55, v55
    v_exp_f32 v56, v56
    v_exp_f32 v57, v57
    v_add_f32 v54, 1.0, v54
    v_add_f32 v55, 1.0, v55
    v_add_f32 v56, 1.0, v56
    v_add_f32 v57, 1.0, v57
    v_rcp_f32 v54, v54
    v_rcp_f32 v55, v55
    v_rcp_f32 v56, v56
    v_rcp_f32 v57, v57
    v_mul_f32 v54, v54, v116
    v_mul_f32 v55, v55, v117
    v_mul_f32 v56, v56, v118
    v_mul_f32 v57, v57, v119
    v_cvt_pk_bf16_f32 v42, v54, v55
    v_cvt_pk_bf16_f32 v43, v56, v57
    s_nop 1
    v_permlane32_swap_b32 v40, v42
    v_permlane32_swap_b32 v41, v43
    buffer_store_dwordx4 v[40:43], v52, s[20:23], s41 offen offset:2048
    v_lshlrev_b32 v180, 16, v176
    v_and_b32 v181, 0xffff0000, v176
    v_lshlrev_b32 v182, 16, v177
    v_and_b32 v183, 0xffff0000, v177
    v_lshlrev_b32 v184, 16, v178
    v_and_b32 v185, 0xffff0000, v178
    v_lshlrev_b32 v186, 16, v179
    v_and_b32 v187, 0xffff0000, v179
    v_fma_f32 v58, v129, v156, v180
    v_fma_f32 v59, v129, v157, v181
    v_fma_f32 v60, v129, v158, v182
    v_fma_f32 v61, v129, v159, v183
    v_fma_f32 v88, v88, v128, v58
    v_fma_f32 v89, v89, v128, v59
    v_fma_f32 v90, v90, v128, v60
    v_fma_f32 v91, v91, v128, v61
    v_mul_f32 v54, v88, v88
    v_mul_f32 v55, v89, v89
    v_mul_f32 v56, v90, v90
    v_mul_f32 v57, v91, v91
    v_fmaak_f32 v54, v54, v53, 0xc0135761
    v_fmaak_f32 v55, v55, v53, 0xc0135761
    v_fmaak_f32 v56, v56, v53, 0xc0135761
    v_fmaak_f32 v57, v57, v53, 0xc0135761
    v_mul_f32 v54, v54, v88
    v_mul_f32 v55, v55, v89
    v_mul_f32 v56, v56, v90
    v_mul_f32 v57, v57, v91
    v_exp_f32 v54, v54
    v_exp_f32 v55, v55
    v_exp_f32 v56, v56
    v_exp_f32 v57, v57
    v_add_f32 v54, 1.0, v54
    v_add_f32 v55, 1.0, v55
    v_add_f32 v56, 1.0, v56
    v_add_f32 v57, 1.0, v57
    v_rcp_f32 v54, v54
    v_rcp_f32 v55, v55
    v_rcp_f32 v56, v56
    v_rcp_f32 v57, v57
    v_mul_f32 v54, v54, v88
    v_mul_f32 v55, v55, v89
    v_mul_f32 v56, v56, v90
    v_mul_f32 v57, v57, v91
    v_cvt_pk_bf16_f32 v44, v54, v55
    v_cvt_pk_bf16_f32 v45, v56, v57
    v_fma_f32 v58, v129, v160, v184
    v_fma_f32 v59, v129, v161, v185
    v_fma_f32 v60, v129, v162, v186
    v_fma_f32 v61, v129, v163, v187
    v_fma_f32 v92, v92, v128, v58
    v_fma_f32 v93, v93, v128, v59
    v_fma_f32 v94, v94, v128, v60
    v_fma_f32 v95, v95, v128, v61
    v_mul_f32 v54, v92, v92
    v_mul_f32 v55, v93, v93
    v_mul_f32 v56, v94, v94
    v_mul_f32 v57, v95, v95
    v_fmaak_f32 v54, v54, v53, 0xc0135761
    v_fmaak_f32 v55, v55, v53, 0xc0135761
    v_fmaak_f32 v56, v56, v53, 0xc0135761
    v_fmaak_f32 v57, v57, v53, 0xc0135761
    v_mul_f32 v54, v54, v92
    v_mul_f32 v55, v55, v93
    v_mul_f32 v56, v56, v94
    v_mul_f32 v57, v57, v95
    v_exp_f32 v54, v54
    v_exp_f32 v55, v55
    v_exp_f32 v56, v56
    v_exp_f32 v57, v57
    v_add_f32 v54, 1.0, v54
    v_add_f32 v55, 1.0, v55
    v_add_f32 v56, 1.0, v56
    v_add_f32 v57, 1.0, v57
    v_rcp_f32 v54, v54
    v_rcp_f32 v55, v55
    v_rcp_f32 v56, v56
    v_rcp_f32 v57, v57
    v_mul_f32 v54, v54, v92
    v_mul_f32 v55, v55, v93
    v_mul_f32 v56, v56, v94
    v_mul_f32 v57, v57, v95
    v_cvt_pk_bf16_f32 v46, v54, v55
    v_cvt_pk_bf16_f32 v47, v56, v57
    s_nop 1
    v_permlane32_swap_b32 v44, v46
    v_permlane32_swap_b32 v45, v47
    buffer_store_dwordx4 v[44:47], v52, s[20:23], s40 offen offset:3072
    v_fma_f32 v58, v131, v156, v180
    v_fma_f32 v59, v131, v157, v181
    v_fma_f32 v60, v131, v158, v182
    v_fma_f32 v61, v131, v159, v183
    v_fma_f32 v120, v120, v130, v58
    v_fma_f32 v121, v121, v130, v59
    v_fma_f32 v122, v122, v130, v60
    v_fma_f32 v123, v123, v130, v61
    v_mul_f32 v54, v120, v120
    v_mul_f32 v55, v121, v121
    v_mul_f32 v56, v122, v122
    v_mul_f32 v57, v123, v123
    v_fmaak_f32 v54, v54, v53, 0xc0135761
    v_fmaak_f32 v55, v55, v53, 0xc0135761
    v_fmaak_f32 v56, v56, v53, 0xc0135761
    v_fmaak_f32 v57, v57, v53, 0xc0135761
    v_mul_f32 v54, v54, v120
    v_mul_f32 v55, v55, v121
    v_mul_f32 v56, v56, v122
    v_mul_f32 v57, v57, v123
    v_exp_f32 v54, v54
    v_exp_f32 v55, v55
    v_exp_f32 v56, v56
    v_exp_f32 v57, v57
    v_add_f32 v54, 1.0, v54
    v_add_f32 v55, 1.0, v55
    v_add_f32 v56, 1.0, v56
    v_add_f32 v57, 1.0, v57
    v_rcp_f32 v54, v54
    v_rcp_f32 v55, v55
    v_rcp_f32 v56, v56
    v_rcp_f32 v57, v57
    v_mul_f32 v54, v54, v120
    v_mul_f32 v55, v55, v121
    v_mul_f32 v56, v56, v122
    v_mul_f32 v57, v57, v123
    v_cvt_pk_bf16_f32 v48, v54, v55
    v_cvt_pk_bf16_f32 v49, v56, v57
    v_fma_f32 v58, v131, v160, v184
    v_fma_f32 v59, v131, v161, v185
    v_fma_f32 v60, v131, v162, v186
    v_fma_f32 v61, v131, v163, v187
    v_fma_f32 v124, v124, v130, v58
    v_fma_f32 v125, v125, v130, v59
    v_fma_f32 v126, v126, v130, v60
    v_fma_f32 v127, v127, v130, v61
    v_mul_f32 v54, v124, v124
    v_mul_f32 v55, v125, v125
    v_mul_f32 v56, v126, v126
    v_mul_f32 v57, v127, v127
    v_fmaak_f32 v54, v54, v53, 0xc0135761
    v_fmaak_f32 v55, v55, v53, 0xc0135761
    v_fmaak_f32 v56, v56, v53, 0xc0135761
    v_fmaak_f32 v57, v57, v53, 0xc0135761
    v_mul_f32 v54, v54, v124
    v_mul_f32 v55, v55, v125
    v_mul_f32 v56, v56, v126
    v_mul_f32 v57, v57, v127
    v_exp_f32 v54, v54
    v_exp_f32 v55, v55
    v_exp_f32 v56, v56
    v_exp_f32 v57, v57
    v_add_f32 v54, 1.0, v54
    v_add_f32 v55, 1.0, v55
    v_add_f32 v56, 1.0, v56
    v_add_f32 v57, 1.0, v57
    v_rcp_f32 v54, v54
    v_rcp_f32 v55, v55
    v_rcp_f32 v56, v56
    v_rcp_f32 v57, v57
    v_mul_f32 v54, v54, v124
    v_mul_f32 v55, v55, v125
    v_mul_f32 v56, v56, v126
    v_mul_f32 v57, v57, v127
    v_cvt_pk_bf16_f32 v50, v54, v55
    v_cvt_pk_bf16_f32 v51, v56, v57
    s_nop 1
    v_permlane32_swap_b32 v48, v50
    v_permlane32_swap_b32 v49, v51
    buffer_store_dwordx4 v[48:51], v52, s[20:23], s41 offen offset:3072
K1_END:
    s_endpgm
K1_SIDE:
    s_cmp_lg_u32 s2, 0
    s_cbranch_scc1 K1_SIDE_NZ
    v_lshlrev_b32 v5, 4, v0
    v_mov_b32 v8, 0
    v_mov_b32 v9, 0
    v_mov_b32 v10, 0
    v_mov_b32 v11, 0
    s_mov_b32 s37, 32768
    buffer_store_dwordx4 v[8:11], v5, s[20:23], s37 offen
K1_SIDE_NZ:
    s_lshl_b32 s35, s2, 3
    s_add_u32 s35, s35, s3
    s_mov_b32 s12, s50
    s_and_b32 s13, s51, 0xffff
    s_mov_b32 s14, 2621440
    s_mov_b32 s15, 0x20000
    s_lshl_b32 s36, s35, 1
    v_lshrrev_b32 v3, 5, v1
    v_add_u32 v3, s36, v3
    v_and_b32 v4, 31, v1
    s_movk_i32 s36, 1280
    v_mul_lo_u32 v5, v3, s36
    v_lshl_add_u32 v5, v4, 3, v5
    v_lshlrev_b32 v3, 2, v3

    s_mov_b32 s37, 0
    buffer_load_dwordx2 v[64:65], v5, s[12:15], s37 offen offset:0
    buffer_load_dwordx2 v[66:67], v5, s[12:15], s37 offen offset:256
    buffer_load_dwordx2 v[68:69], v5, s[12:15], s37 offen offset:512
    buffer_load_dwordx2 v[70:71], v5, s[12:15], s37 offen offset:768
    buffer_load_dwordx2 v[72:73], v5, s[12:15], s37 offen offset:1024
    s_mov_b32 s37, 819200
    buffer_load_dwordx2 v[74:75], v5, s[12:15], s37 offen offset:0
    buffer_load_dwordx2 v[76:77], v5, s[12:15], s37 offen offset:256
    buffer_load_dwordx2 v[78:79], v5, s[12:15], s37 offen offset:512
    buffer_load_dwordx2 v[80:81], v5, s[12:15], s37 offen offset:768
    buffer_load_dwordx2 v[82:83], v5, s[12:15], s37 offen offset:1024
    s_mov_b32 s37, 1638400
    buffer_load_dwordx2 v[84:85], v5, s[12:15], s37 offen offset:0
    buffer_load_dwordx2 v[86:87], v5, s[12:15], s37 offen offset:256
    buffer_load_dwordx2 v[88:89], v5, s[12:15], s37 offen offset:512
    buffer_load_dwordx2 v[90:91], v5, s[12:15], s37 offen offset:768
    buffer_load_dwordx2 v[92:93], v5, s[12:15], s37 offen offset:1024
    s_mov_b32 s37, 2457600
    buffer_load_dwordx2 v[94:95], v5, s[12:15], s37 offen offset:0
    buffer_load_dwordx2 v[96:97], v5, s[12:15], s37 offen offset:256
    buffer_load_dwordx2 v[98:99], v5, s[12:15], s37 offen offset:512
    buffer_load_dwordx2 v[100:101], v5, s[12:15], s37 offen offset:768
    buffer_load_dwordx2 v[102:103], v5, s[12:15], s37 offen offset:1024
    v_mov_b32 v6, 0x3f803f80
    v_mov_b32 v20, 0
    v_mov_b32 v26, 0
    v_mov_b32 v21, 0
    v_mov_b32 v27, 0
    v_mov_b32 v22, 0
    v_mov_b32 v28, 0
    v_mov_b32 v23, 0
    v_mov_b32 v29, 0
    s_waitcnt vmcnt(15)
    v_dot2_f32_bf16 v20, v64, v6, v20
    v_dot2_f32_bf16 v26, v64, v64, v26
    v_dot2_f32_bf16 v20, v65, v6, v20
    v_dot2_f32_bf16 v26, v65, v65, v26
    v_dot2_f32_bf16 v20, v66, v6, v20
    v_dot2_f32_bf16 v26, v66, v66, v26
    v_dot2_f32_bf16 v20, v67, v6, v20
    v_dot2_f32_bf16 v26, v67, v67, v26
    v_dot2_f32_bf16 v20, v68, v6, v20
    v_dot2_f32_bf16 v26, v68, v68, v26
    v_dot2_f32_bf16 v20, v69, v6, v20
    v_dot2_f32_bf16 v26, v69, v69, v26
    v_dot2_f32_bf16 v20, v70, v6, v20
    v_dot2_f32_bf16 v26, v70, v70, v26
    v_dot2_f32_bf16 v20, v71, v6, v20
    v_dot2_f32_bf16 v26, v71, v71, v26
    v_dot2_f32_bf16 v20, v72, v6, v20
    v_dot2_f32_bf16 v26, v72, v72, v26
    v_dot2_f32_bf16 v20, v73, v6, v20
    v_dot2_f32_bf16 v26, v73, v73, v26
    s_waitcnt vmcnt(10)
    v_dot2_f32_bf16 v21, v74, v6, v21
    v_dot2_f32_bf16 v27, v74, v74, v27
    v_dot2_f32_bf16 v21, v75, v6, v21
    v_dot2_f32_bf16 v27, v75, v75, v27
    v_dot2_f32_bf16 v21, v76, v6, v21
    v_dot2_f32_bf16 v27, v76, v76, v27
    v_dot2_f32_bf16 v21, v77, v6, v21
    v_dot2_f32_bf16 v27, v77, v77, v27
    v_dot2_f32_bf16 v21, v78, v6, v21
    v_dot2_f32_bf16 v27, v78, v78, v27
    v_dot2_f32_bf16 v21, v79, v6, v21
    v_dot2_f32_bf16 v27, v79, v79, v27
    v_dot2_f32_bf16 v21, v80, v6, v21
    v_dot2_f32_bf16 v27, v80, v80, v27
    v_dot2_f32_bf16 v21, v81, v6, v21
    v_dot2_f32_bf16 v27, v81, v81, v27
    v_dot2_f32_bf16 v21, v82, v6, v21
    v_dot2_f32_bf16 v27, v82, v82, v27
    v_dot2_f32_bf16 v21, v83, v6, v21
    v_dot2_f32_bf16 v27, v83, v83, v27
    s_waitcnt vmcnt(5)
    v_dot2_f32_bf16 v22, v84, v6, v22
    v_dot2_f32_bf16 v28, v84, v84, v28
    v_dot2_f32_bf16 v22, v85, v6, v22
    v_dot2_f32_bf16 v28, v85, v85, v28
    v_dot2_f32_bf16 v22, v86, v6, v22
    v_dot2_f32_bf16 v28, v86, v86, v28
    v_dot2_f32_bf16 v22, v87, v6, v22
    v_dot2_f32_bf16 v28, v87, v87, v28
    v_dot2_f32_bf16 v22, v88, v6, v22
    v_dot2_f32_bf16 v28, v88, v88, v28
    v_dot2_f32_bf16 v22, v89, v6, v22
    v_dot2_f32_bf16 v28, v89, v89, v28
    v_dot2_f32_bf16 v22, v90, v6, v22
    v_dot2_f32_bf16 v28, v90, v90, v28
    v_dot2_f32_bf16 v22, v91, v6, v22
    v_dot2_f32_bf16 v28, v91, v91, v28
    v_dot2_f32_bf16 v22, v92, v6, v22
    v_dot2_f32_bf16 v28, v92, v92, v28
    v_dot2_f32_bf16 v22, v93, v6, v22
    v_dot2_f32_bf16 v28, v93, v93, v28
    s_waitcnt vmcnt(0)
    v_dot2_f32_bf16 v23, v94, v6, v23
    v_dot2_f32_bf16 v29, v94, v94, v29
    v_dot2_f32_bf16 v23, v95, v6, v23
    v_dot2_f32_bf16 v29, v95, v95, v29
    v_dot2_f32_bf16 v23, v96, v6, v23
    v_dot2_f32_bf16 v29, v96, v96, v29
    v_dot2_f32_bf16 v23, v97, v6, v23
    v_dot2_f32_bf16 v29, v97, v97, v29
    v_dot2_f32_bf16 v23, v98, v6, v23
    v_dot2_f32_bf16 v29, v98, v98, v29
    v_dot2_f32_bf16 v23, v99, v6, v23
    v_dot2_f32_bf16 v29, v99, v99, v29
    v_dot2_f32_bf16 v23, v100, v6, v23
    v_dot2_f32_bf16 v29, v100, v100, v29
    v_dot2_f32_bf16 v23, v101, v6, v23
    v_dot2_f32_bf16 v29, v101, v101, v29
    v_dot2_f32_bf16 v23, v102, v6, v23
    v_dot2_f32_bf16 v29, v102, v102, v29
    v_dot2_f32_bf16 v23, v103, v6, v23
    v_dot2_f32_bf16 v29, v103, v103, v29
    s_nop 3
    v_add_f32_dpp v20, v20, v20 row_ror:8 row_mask:0xf bank_mask:0xf
    v_add_f32_dpp v21, v21, v21 row_ror:8 row_mask:0xf bank_mask:0xf
    v_add_f32_dpp v22, v22, v22 row_ror:8 row_mask:0xf bank_mask:0xf
    v_add_f32_dpp v23, v23, v23 row_ror:8 row_mask:0xf bank_mask:0xf
    v_add_f32_dpp v26, v26, v26 row_ror:8 row_mask:0xf bank_mask:0xf
    v_add_f32_dpp v27, v27, v27 row_ror:8 row_mask:0xf bank_mask:0xf
    v_add_f32_dpp v28, v28, v28 row_ror:8 row_mask:0xf bank_mask:0xf
    v_add_f32_dpp v29, v29, v29 row_ror:8 row_mask:0xf bank_mask:0xf
    v_add_f32_dpp v20, v20, v20 row_ror:4 row_mask:0xf bank_mask:0xf
    v_add_f32_dpp v21, v21, v21 row_ror:4 row_mask:0xf bank_mask:0xf
    v_add_f32_dpp v22, v22, v22 row_ror:4 row_mask:0xf bank_mask:0xf
    v_add_f32_dpp v23, v23, v23 row_ror:4 row_mask:0xf bank_mask:0xf
    v_add_f32_dpp v26, v26, v26 row_ror:4 row_mask:0xf bank_mask:0xf
    v_add_f32_dpp v27, v27, v27 row_ror:4 row_mask:0xf bank_mask:0xf
    v_add_f32_dpp v28, v28, v28 row_ror:4 row_mask:0xf bank_mask:0xf
    v_add_f32_dpp v29, v29, v29 row_ror:4 row_mask:0xf bank_mask:0xf
    v_add_f32_dpp v20, v20, v20 row_ror:2 row_mask:0xf bank_mask:0xf
    v_add_f32_dpp v21, v21, v21 row_ror:2 row_mask:0xf bank_mask:0xf
    v_add_f32_dpp v22, v22, v22 row_ror:2 row_mask:0xf bank_mask:0xf
    v_add_f32_dpp v23, v23, v23 row_ror:2 row_mask:0xf bank_mask:0xf
    v_add_f32_dpp v26, v26, v26 row_ror:2 row_mask:0xf bank_mask:0xf
    v_add_f32_dpp v27, v27, v27 row_ror:2 row_mask:0xf bank_mask:0xf
    v_add_f32_dpp v28, v28, v28 row_ror:2 row_mask:0xf bank_mask:0xf
    v_add_f32_dpp v29, v29, v29 row_ror:2 row_mask:0xf bank_mask:0xf
    v_add_f32_dpp v20, v20, v20 row_ror:1 row_mask:0xf bank_mask:0xf
    v_add_f32_dpp v21, v21, v21 row_ror:1 row_mask:0xf bank_mask:0xf
    v_add_f32_dpp v22, v22, v22 row_ror:1 row_mask:0xf bank_mask:0xf
    v_add_f32_dpp v23, v23, v23 row_ror:1 row_mask:0xf bank_mask:0xf
    v_add_f32_dpp v26, v26, v26 row_ror:1 row_mask:0xf bank_mask:0xf
    v_add_f32_dpp v27, v27, v27 row_ror:1 row_mask:0xf bank_mask:0xf
    v_add_f32_dpp v28, v28, v28 row_ror:1 row_mask:0xf bank_mask:0xf
    v_add_f32_dpp v29, v29, v29 row_ror:1 row_mask:0xf bank_mask:0xf
    ds_swizzle_b32 v32, v20 offset:0x401F
    ds_swizzle_b32 v33, v21 offset:0x401F
    ds_swizzle_b32 v34, v22 offset:0x401F
    ds_swizzle_b32 v35, v23 offset:0x401F
    ds_swizzle_b32 v36, v26 offset:0x401F
    ds_swizzle_b32 v37, v27 offset:0x401F
    ds_swizzle_b32 v38, v28 offset:0x401F
    ds_swizzle_b32 v39, v29 offset:0x401F
    s_waitcnt lgkmcnt(0)
    v_add_f32 v20, v20, v32
    v_add_f32 v21, v21, v33
    v_add_f32 v22, v22, v34
    v_add_f32 v23, v23, v35
    v_add_f32 v26, v26, v36
    v_add_f32 v27, v27, v37
    v_add_f32 v28, v28, v38
    v_add_f32 v29, v29, v39
    v_mov_b32 v40, v20
    v_mov_b32 v42, v26
    v_cmp_eq_u32 vcc, 1, v4
    s_nop 1
    v_cndmask_b32 v40, v40, v21, vcc
    v_cndmask_b32 v42, v42, v27, vcc
    v_cmp_eq_u32 vcc, 2, v4
    s_nop 1
    v_cndmask_b32 v40, v40, v22, vcc
    v_cndmask_b32 v42, v42, v28, vcc
    v_cmp_eq_u32 vcc, 3, v4
    s_nop 1
    v_cndmask_b32 v40, v40, v23, vcc
    v_cndmask_b32 v42, v42, v29, vcc
    v_mul_f32 v41, 0x3acccccd, v40
    v_mul_f32 v42, 0x3acccccd, v42
    v_fma_f32 v48, -v41, v41, v42
    v_max_f32 v48, 0, v48
    v_mov_b32 v47, v41
    v_cvt_pk_bf16_f32 v47, v47, v47
    v_lshlrev_b32 v47, 16, v47
    v_mov_b32 v42, v48
    v_cvt_pk_bf16_f32 v42, v42, v42
    v_lshlrev_b32 v42, 16, v42
    v_add_f32 v42, 0x3727c5ac, v42
    v_cvt_pk_bf16_f32 v42, v42, v42
    v_lshlrev_b32 v42, 16, v42
    v_sqrt_f32 v42, v42
    s_nop 0
    v_cvt_pk_bf16_f32 v42, v42, v42
    v_lshlrev_b32 v42, 16, v42
    v_rcp_f32 v44, v42
    s_nop 0
    v_sub_f32 v45, v41, v47
    v_mul_f32 v45, v45, v44
    v_cvt_pk_bf16_f32 v45, v45, v45
    v_lshlrev_b32 v45, 16, v45
    v_mul_f32 v46, v48, v44
    v_mul_f32 v46, v46, v44
    v_cvt_pk_bf16_f32 v46, v46, v46
    v_lshlrev_b32 v46, 16, v46
    v_add_f32 v46, 0x3727c5ac, v46
    v_cvt_pk_bf16_f32 v46, v46, v46
    v_lshlrev_b32 v46, 16, v46
    v_sqrt_f32 v46, v46
    s_nop 0
    v_cvt_pk_bf16_f32 v46, v46, v46
    v_lshlrev_b32 v46, 16, v46
    v_rcp_f32 v46, v46
    s_nop 0
    v_mov_b32 v50, v44
    v_mul_f32 v51, v44, v47
    v_mul_f32 v52, v44, v46
    v_add_f32 v53, v51, v45
    v_mul_f32 v53, v53, v46
    v_sub_f32 v51, 0, v51
    v_sub_f32 v53, 0, v53
    v_mul_u32_u24 v7, 2560, v4
    v_add_u32 v7, v7, v3
    v_cmp_gt_u32 s[40:41], 4, v4
    v_cmp_gt_u32 vcc, 8192, v7
    s_and_b64 s[40:41], s[40:41], vcc
    s_mov_b64 exec, s[40:41]
    s_mov_b32 s37, 0
    buffer_store_dword v50, v7, s[20:23], s37 offen sc1
    s_mov_b32 s37, 8192
    buffer_store_dword v51, v7, s[20:23], s37 offen sc1
    s_mov_b32 s37, 16384
    buffer_store_dword v52, v7, s[20:23], s37 offen sc1
    s_mov_b32 s37, 24576
    buffer_store_dword v53, v7, s[20:23], s37 offen sc1
    s_mov_b64 exec, -1
    s_waitcnt vmcnt(0)
    s_barrier
    s_cmp_lg_u32 s3, 0
    s_cbranch_scc1 K1_SIDE_RELAYOUT
    s_mov_b64 exec, 1
    v_mov_b32 v6, 0
    v_mov_b32 v7, 1
    global_atomic_add v6, v7, s[52:53] sc1
    s_mov_b64 exec, -1
K1_SIDE_RELAYOUT:

    v_lshrrev_b32 v8, 5, v1
    v_and_b32 v4, 31, v1
    v_lshlrev_b32 v5, 4, v1
    v_add_u32 v6, 4096, v5
    s_movk_i32 s33, 1280
K1_RL_LOOP:
    s_lshr_b32 s36, s35, 2
    s_and_b32 s37, s35, 3
    s_mul_i32 s37, s37, 5
    s_cmp_lt_u32 s36, 48
    s_cselect_b32 s12, s54, s56
    s_cselect_b32 s13, s55, s57
    s_mov_b32 s14, 1966080
    s_cselect_b32 s14, 819200, s14
    s_and_b32 s13, s13, 0xffff
    s_mov_b32 s15, 0x20000
    s_lshl_b32 s38, s36, 1
    v_add_u32 v3, s38, v8
    s_cmp_lt_u32 s36, 48
    s_cbranch_scc1 K1_RL_WO
    v_subrev_u32 v3, 96, v3
    v_lshlrev_b32 v3, 3, v3
    v_mov_b32 v7, 0
    s_branch K1_RL_GO
K1_RL_WO:
    v_mul_u32_u24 v7, 0x5556, v3
    v_lshrrev_b32 v7, 16, v7
    v_mul_u32_u24 v9, 3, v7
    v_sub_u32 v9, v3, v9
    v_mul_u32_u24 v3, 20, v7
    v_lshl_add_u32 v3, v9, 3, v3
    v_cmp_eq_u32 vcc, 2, v9
    v_mov_b32 v7, 0
    v_mov_b32 v9, 0x40000000
    v_cndmask_b32 v7, v7, v9, vcc
K1_RL_GO:
    v_mul_lo_u32 v3, v3, s33
    v_lshl_add_u32 v3, v4, 1, v3
    v_add_u32 v7, v7, v3
    s_lshl_b32 s38, s37, 6

    s_add_u32 s24, s38, 0
    s_add_u32 s25, s38, 1280
    s_add_u32 s26, s38, 2560
    s_add_u32 s27, s38, 3840
    s_add_u32 s28, s38, 5120
    s_add_u32 s29, s38, 6400
    s_add_u32 s30, s38, 7680
    s_add_u32 s31, s38, 8960
    buffer_load_ushort v10, v3, s[12:15], s24 offen offset:0
    buffer_load_ushort v11, v3, s[12:15], s25 offen offset:0
    buffer_load_ushort v12, v3, s[12:15], s26 offen offset:0
    buffer_load_ushort v13, v3, s[12:15], s27 offen offset:0
    buffer_load_ushort v14, v7, s[12:15], s28 offen offset:0
    buffer_load_ushort v15, v7, s[12:15], s29 offen offset:0
    buffer_load_ushort v16, v7, s[12:15], s30 offen offset:0
    buffer_load_ushort v17, v7, s[12:15], s31 offen offset:0
    buffer_load_ushort v18, v3, s[12:15], s24 offen offset:64
    buffer_load_ushort v19, v3, s[12:15], s25 offen offset:64
    buffer_load_ushort v20, v3, s[12:15], s26 offen offset:64
    buffer_load_ushort v21, v3, s[12:15], s27 offen offset:64
    buffer_load_ushort v22, v7, s[12:15], s28 offen offset:64
    buffer_load_ushort v23, v7, s[12:15], s29 offen offset:64
    buffer_load_ushort v24, v7, s[12:15], s30 offen offset:64
    buffer_load_ushort v25, v7, s[12:15], s31 offen offset:64
    buffer_load_ushort v26, v3, s[12:15], s24 offen offset:128
    buffer_load_ushort v27, v3, s[12:15], s25 offen offset:128
    buffer_load_ushort v28, v3, s[12:15], s26 offen offset:128
    buffer_load_ushort v29, v3, s[12:15], s27 offen offset:128
    buffer_load_ushort v30, v7, s[12:15], s28 offen offset:128
    buffer_load_ushort v31, v7, s[12:15], s29 offen offset:128
    buffer_load_ushort v32, v7, s[12:15], s30 offen offset:128
    buffer_load_ushort v33, v7, s[12:15], s31 offen offset:128
    buffer_load_ushort v34, v3, s[12:15], s24 offen offset:192
    buffer_load_ushort v35, v3, s[12:15], s25 offen offset:192
    buffer_load_ushort v36, v3, s[12:15], s26 offen offset:192
    buffer_load_ushort v37, v3, s[12:15], s27 offen offset:192
    buffer_load_ushort v38, v7, s[12:15], s28 offen offset:192
    buffer_load_ushort v39, v7, s[12:15], s29 offen offset:192
    buffer_load_ushort v40, v7, s[12:15], s30 offen offset:192
    buffer_load_ushort v41, v7, s[12:15], s31 offen offset:192
    buffer_load_ushort v42, v3, s[12:15], s24 offen offset:256
    buffer_load_ushort v43, v3, s[12:15], s25 offen offset:256
    buffer_load_ushort v44, v3, s[12:15], s26 offen offset:256
    buffer_load_ushort v45, v3, s[12:15], s27 offen offset:256
    buffer_load_ushort v46, v7, s[12:15], s28 offen offset:256
    buffer_load_ushort v47, v7, s[12:15], s29 offen offset:256
    buffer_load_ushort v48, v7, s[12:15], s30 offen offset:256
    buffer_load_ushort v49, v7, s[12:15], s31 offen offset:256
    s_mul_i32 s38, s36, 20
    s_add_u32 s38, s38, s37
    s_lshl_b32 s38, s38, 10
    s_add_u32 s38, s38, 23068672

    s_waitcnt vmcnt(32)
    v_lshl_or_b32 v52, v11, 16, v10
    v_lshl_or_b32 v53, v13, 16, v12
    v_lshl_or_b32 v54, v15, 16, v14
    v_lshl_or_b32 v55, v17, 16, v16
    buffer_store_dwordx4 v[52:55], v5, s[20:23], s38 offen offset:0
    s_waitcnt vmcnt(25)
    v_lshl_or_b32 v56, v19, 16, v18
    v_lshl_or_b32 v57, v21, 16, v20
    v_lshl_or_b32 v58, v23, 16, v22
    v_lshl_or_b32 v59, v25, 16, v24
    buffer_store_dwordx4 v[56:59], v5, s[20:23], s38 offen offset:1024
    s_waitcnt vmcnt(18)
    v_lshl_or_b32 v60, v27, 16, v26
    v_lshl_or_b32 v61, v29, 16, v28
    v_lshl_or_b32 v62, v31, 16, v30
    v_lshl_or_b32 v63, v33, 16, v32
    buffer_store_dwordx4 v[60:63], v5, s[20:23], s38 offen offset:2048
    s_waitcnt vmcnt(11)
    v_lshl_or_b32 v52, v35, 16, v34
    v_lshl_or_b32 v53, v37, 16, v36
    v_lshl_or_b32 v54, v39, 16, v38
    v_lshl_or_b32 v55, v41, 16, v40
    buffer_store_dwordx4 v[52:55], v5, s[20:23], s38 offen offset:3072
    s_waitcnt vmcnt(4)
    v_lshl_or_b32 v56, v43, 16, v42
    v_lshl_or_b32 v57, v45, 16, v44
    v_lshl_or_b32 v58, v47, 16, v46
    v_lshl_or_b32 v59, v49, 16, v48
    buffer_store_dwordx4 v[56:59], v6, s[20:23], s38 offen
    s_waitcnt vmcnt(0)
    s_add_u32 s35, s35, 320
    s_cmp_lt_u32 s35, 576
    s_cbranch_scc1 K1_RL_LOOP

    s_endpgm
.globl k2_attn_kernel
.p2align 8
.type k2_attn_kernel,@function
k2_attn_kernel:

    s_cmp_ge_u32 s2, 256
    s_cbranch_scc1 K2_END
    s_load_dwordx2 s[6:7], s[0:1], 80
    s_load_dwordx2 s[8:9], s[0:1], 0
    s_load_dwordx2 s[10:11], s[0:1], 56
    s_load_dwordx2 s[4:5], s[0:1], 64
    v_lshrrev_b32 v2, 6, v0
    v_and_b32 v1, 63, v0
    s_and_b32 s34, s2, 7
    s_lshl_b32 s34, s34, 2
    s_bfe_u32 s35, s2, 0x20003
    s_add_u32 s34, s34, s35
    s_lshr_b32 s35, s2, 5
    v_readfirstlane_b32 s3, v2
    v_lshrrev_b32 v3, 5, v1
    v_and_b32 v2, 31, v1
    s_waitcnt lgkmcnt(0)

    s_mov_b32 s20, s6
    s_and_b32 s21, s7, 0xffff
    s_mov_b32 s22, 26214400
    s_mov_b32 s23, 0x20000
    s_cmp_ge_u32 s3, 8
    s_cbranch_scc1 K2_GEMM

    s_lshl_b32 s35, s35, 3
    s_mul_i32 s36, s3, 1
    s_add_u32 s35, s35, s36
    s_mov_b32 s40, 0x000fffff
    s_mov_b32 s41, 0x000fffff
    s_mov_b32 s42, 0
    s_mov_b32 s43, -1
    s_mov_b32 s44, -1
    s_mov_b32 s45, 0
    s_mov_b32 s46, 0
    s_mul_i32 s36, s34, 81920
    s_mul_i32 s37, s35, 1280
    s_add_u32 s36, s36, s37
    s_add_u32 s36, s36, 5242880
    s_mul_i32 s37, s34, 163840
    s_add_u32 s37, s37, 7864320
    v_lshlrev_b32 v112, 4, v1
    v_lshlrev_b32 v113, 3, v2
    v_add_u32 v113, 1024, v113
    v_mul_u32_u24 v114, 20, v3
    v_add_u32 v114, v114, v2
    v_lshlrev_b32 v114, 4, v114
    v_add_u32 v114, 1280, v114
    s_mul_i32 s38, s3, 1024
    v_add_u32 v115, s38, v112

    v_mov_b32 v8, 0
    v_mov_b32 v9, 0
    buffer_load_dwordx4 v[4:7], v112, s[20:23], s36 offen offset:0
    s_mov_b64 exec, s[44:45]
    buffer_load_dwordx2 v[8:9], v113, s[20:23], s36 offen offset:0
    s_mov_b64 exec, -1
    v_mov_b32 v116, 40960
    v_mov_b32 v117, 0
    ds_write_b32 v116, v117
    ds_write_b32 v116, v117 offset:4
    v_mov_b32 v118, 0
    v_mov_b32 v119, 0x3f803f80
    v_cmp_eq_u32 vcc, 20, v2
    v_cmp_eq_u32 s[48:49], 24, v2
    s_or_b64 vcc, vcc, s[48:49]
    s_nop 1
    v_cndmask_b32 v118, v118, v119, vcc

    v_mov_b32 v96, v118
    v_mov_b32 v97, v118
    v_mov_b32 v98, v118
    v_mov_b32 v99, v118
    v_mov_b32 v100, v118
    v_mov_b32 v101, v118
    v_mov_b32 v102, v118
    v_mov_b32 v103, v118
    v_mov_b32 v104, v118
    v_mov_b32 v105, v118
    v_mov_b32 v106, v118
    v_mov_b32 v107, v118
    v_mov_b32 v108, v118
    v_mov_b32 v109, v118
    v_mov_b32 v110, v118
    v_mov_b32 v111, v118
K2_RESTART:
    s_mov_b32 s39, s37
    s_add_u32 m0, s38, 0
    s_nop 0
    buffer_load_dwordx4 v115, s[20:23], s39 offen offset:0 lds
    s_add_u32 s39, s39, 8192
    s_add_u32 m0, s38, 8192
    s_nop 0
    buffer_load_dwordx4 v115, s[20:23], s39 offen offset:0 lds
    s_add_u32 s39, s39, 8192
    s_add_u32 m0, s38, 16384
    s_nop 0
    buffer_load_dwordx4 v115, s[20:23], s39 offen offset:0 lds
    s_add_u32 s39, s39, 8192
    v_mov_b32 v32, 0
    v_mov_b32 v33, 0
    v_mov_b32 v34, 0
    v_mov_b32 v35, 0
    v_mov_b32 v36, 0
    v_mov_b32 v37, 0
    v_mov_b32 v38, 0
    v_mov_b32 v39, 0
    v_mov_b32 v40, 0
    v_mov_b32 v41, 0
    v_mov_b32 v42, 0
    v_mov_b32 v43, 0
    v_mov_b32 v44, 0
    v_mov_b32 v45, 0
    v_mov_b32 v46, 0
    v_mov_b32 v47, 0
    v_mov_b32 v84, 0
    v_mov_b32 v85, 0
    v_mov_b32 v86, 0
    v_mov_b32 v87, 0
    s_waitcnt vmcnt(2) lgkmcnt(0)
    s_barrier
    s_add_u32 m0, s38, 24576
    s_nop 0
    buffer_load_dwordx4 v115, s[20:23], s39 offen offset:0 lds
    s_add_u32 s39, s39, 8192
    ds_read_b128 v[88:91], v112 offset:0
    ds_read_b64 v[92:93], v113 offset:0
    s_waitcnt lgkmcnt(0)
    s_cmp_lg_u32 s46, 0
    s_cbranch_scc1 K2_HAVE_NC

    v_mfma_f32_32x32x16_bf16 v[48:63], v[88:91], v[4:7], 0
    v_mfma_f32_32x32x8_bf16 v[48:63], v[92:93], v[8:9], v[48:63]
    s_nop 15
    v_max3_f32 v120, v48, v49, v50
    v_max_f32 v120, v120, v51
    v_max3_f32 v120, v120, v52, v53
    v_max3_f32 v120, v120, v54, v55
    v_max3_f32 v120, v120, v56, v57
    v_max3_f32 v120, v120, v58, v59
    v_max3_f32 v120, v120, v60, v61
    v_max3_f32 v120, v120, v62, v63
    v_mov_b32 v118, v120
    v_mov_b32 v119, v120
    s_nop 1
    v_permlane32_swap_b32 v118, v119
    s_nop 1
    v_max_f32 v118, v118, v119

    v_sub_f32 v16, 0, v118
    v_sub_f32 v17, 0, v118
    v_sub_f32 v18, 0, v118
    v_sub_f32 v19, 0, v118
    v_sub_f32 v20, 0, v118
    v_sub_f32 v21, 0, v118
    v_sub_f32 v22, 0, v118
    v_sub_f32 v23, 0, v118
    v_sub_f32 v24, 0, v118
    v_sub_f32 v25, 0, v118
    v_sub_f32 v26, 0, v118
    v_sub_f32 v27, 0, v118
    v_sub_f32 v28, 0, v118
    v_sub_f32 v29, 0, v118
    v_sub_f32 v30, 0, v118
    v_sub_f32 v31, 0, v118
    s_nop 1
K2_HAVE_NC:
    v_mfma_f32_32x32x16_bf16 v[48:63], v[88:91], v[4:7], v[16:31]
    v_mfma_f32_32x32x8_bf16 v[48:63], v[92:93], v[8:9], v[48:63]
    ds_read_b128 v[10:13], v112 offset:2560
    ds_read_b64 v[14:15], v113 offset:2560
    s_mov_b64 exec, s[40:41]
    ds_read_b128 v[96:99], v114 offset:0
    ds_read_b128 v[100:103], v114 offset:640
    s_mov_b64 exec, -1
    s_mov_b32 s47, 0
K2_LOOP:
    s_waitcnt lgkmcnt(2)
    v_mfma_f32_32x32x16_bf16 v[64:79], v[10:13], v[4:7], v[16:31]
    v_exp_f32 v48, v48
    v_exp_f32 v49, v49
    v_exp_f32 v50, v50
    v_cvt_pk_bf16_f32 v80, v48, v49
    v_exp_f32 v51, v51
    v_mfma_f32_32x32x16_bf16 v[32:47], v[108:111], v[84:87], v[32:47]
    ds_read_b128 v[88:91], v112 offset:5120
    ds_read_b64 v[92:93], v113 offset:5120
    s_mov_b64 exec, s[40:41]
    ds_read_b128 v[104:107], v114 offset:2560
    ds_read_b128 v[108:111], v114 offset:3200
    s_mov_b64 exec, -1
    v_exp_f32 v52, v52
    v_cvt_pk_bf16_f32 v81, v50, v51
    v_exp_f32 v53, v53
    v_exp_f32 v54, v54
    v_cvt_pk_bf16_f32 v82, v52, v53
    v_exp_f32 v55, v55
    v_mfma_f32_32x32x8_bf16 v[64:79], v[14:15], v[8:9], v[64:79]
    v_exp_f32 v56, v56
    v_cvt_pk_bf16_f32 v83, v54, v55
    v_exp_f32 v57, v57
    v_exp_f32 v58, v58
    v_cvt_pk_bf16_f32 v84, v56, v57
    v_exp_f32 v59, v59
    s_waitcnt lgkmcnt(4)
    v_mfma_f32_32x32x16_bf16 v[32:47], v[96:99], v[80:83], v[32:47]
    v_exp_f32 v60, v60
    v_exp_f32 v61, v61
    v_cvt_pk_bf16_f32 v85, v58, v59
    v_exp_f32 v62, v62
    v_exp_f32 v63, v63
    v_cvt_pk_bf16_f32 v86, v60, v61
    v_cvt_pk_bf16_f32 v87, v62, v63
    s_waitcnt lgkmcnt(2)
    v_mfma_f32_32x32x16_bf16 v[48:63], v[88:91], v[4:7], v[16:31]
    v_exp_f32 v64, v64
    v_exp_f32 v65, v65
    v_exp_f32 v66, v66
    v_cvt_pk_bf16_f32 v80, v64, v65
    v_exp_f32 v67, v67
    v_mfma_f32_32x32x16_bf16 v[32:47], v[100:103], v[84:87], v[32:47]
    s_waitcnt vmcnt(2) lgkmcnt(0)
    s_barrier
    s_add_u32 m0, s38, 32768
    s_nop 0
    buffer_load_dwordx4 v115, s[20:23], s39 offen offset:0 lds
    s_add_u32 s39, s39, 8192
    ds_read_b128 v[10:13], v112 offset:7680
    ds_read_b64 v[14:15], v113 offset:7680
    s_mov_b64 exec, s[40:41]
    ds_read_b128 v[96:99], v114 offset:5120
    ds_read_b128 v[100:103], v114 offset:5760
    s_mov_b64 exec, -1
    v_exp_f32 v68, v68
    v_cvt_pk_bf16_f32 v81, v66, v67
    v_exp_f32 v69, v69
    v_exp_f32 v70, v70
    v_cvt_pk_bf16_f32 v82, v68, v69
    v_exp_f32 v71, v71
    v_mfma_f32_32x32x8_bf16 v[48:63], v[92:93], v[8:9], v[48:63]
    v_exp_f32 v72, v72
    v_cvt_pk_bf16_f32 v83, v70, v71
    v_exp_f32 v73, v73
    v_exp_f32 v74, v74
    v_cvt_pk_bf16_f32 v84, v72, v73
    v_exp_f32 v75, v75
    s_waitcnt lgkmcnt(4)
    v_mfma_f32_32x32x16_bf16 v[32:47], v[104:107], v[80:83], v[32:47]
    v_exp_f32 v76, v76
    v_exp_f32 v77, v77
    v_cvt_pk_bf16_f32 v85, v74, v75
    v_exp_f32 v78, v78
    v_exp_f32 v79, v79
    v_cvt_pk_bf16_f32 v86, v76, v77
    v_cvt_pk_bf16_f32 v87, v78, v79
    s_waitcnt lgkmcnt(2)
    v_mfma_f32_32x32x16_bf16 v[64:79], v[10:13], v[4:7], v[16:31]
    v_exp_f32 v48, v48
    v_exp_f32 v49, v49
    v_exp_f32 v50, v50
    v_cvt_pk_bf16_f32 v80, v48, v49
    v_exp_f32 v51, v51
    v_mfma_f32_32x32x16_bf16 v[32:47], v[108:111], v[84:87], v[32:47]
    ds_read_b128 v[88:91], v112 offset:10240
    ds_read_b64 v[92:93], v113 offset:10240
    s_mov_b64 exec, s[40:41]
    ds_read_b128 v[104:107], v114 offset:7680
    ds_read_b128 v[108:111], v114 offset:8320
    s_mov_b64 exec, -1
    v_exp_f32 v52, v52
    v_cvt_pk_bf16_f32 v81, v50, v51
    v_exp_f32 v53, v53
    v_exp_f32 v54, v54
    v_cvt_pk_bf16_f32 v82, v52, v53
    v_exp_f32 v55, v55
    v_mfma_f32_32x32x8_bf16 v[64:79], v[14:15], v[8:9], v[64:79]
    v_exp_f32 v56, v56
    v_cvt_pk_bf16_f32 v83, v54, v55
    v_exp_f32 v57, v57
    v_exp_f32 v58, v58
    v_cvt_pk_bf16_f32 v84, v56, v57
    v_exp_f32 v59, v59
    s_waitcnt lgkmcnt(4)
    v_mfma_f32_32x32x16_bf16 v[32:47], v[96:99], v[80:83], v[32:47]
    v_exp_f32 v60, v60
    v_exp_f32 v61, v61
    v_cvt_pk_bf16_f32 v85, v58, v59
    v_exp_f32 v62, v62
    v_exp_f32 v63, v63
    v_cvt_pk_bf16_f32 v86, v60, v61
    v_cvt_pk_bf16_f32 v87, v62, v63
    s_waitcnt lgkmcnt(2)
    v_mfma_f32_32x32x16_bf16 v[48:63], v[88:91], v[4:7], v[16:31]
    v_exp_f32 v64, v64
    v_exp_f32 v65, v65
    v_exp_f32 v66, v66
    v_cvt_pk_bf16_f32 v80, v64, v65
    v_exp_f32 v67, v67
    v_mfma_f32_32x32x16_bf16 v[32:47], v[100:103], v[84:87], v[32:47]
    ds_read_b128 v[10:13], v112 offset:12800
    ds_read_b64 v[14:15], v113 offset:12800
    s_mov_b64 exec, s[40:41]
    ds_read_b128 v[96:99], v114 offset:10240
    ds_read_b128 v[100:103], v114 offset:10880
    s_mov_b64 exec, -1
    v_exp_f32 v68, v68
    v_cvt_pk_bf16_f32 v81, v66, v67
    v_exp_f32 v69, v69
    v_exp_f32 v70, v70
    v_cvt_pk_bf16_f32 v82, v68, v69
    v_exp_f32 v71, v71
    v_mfma_f32_32x32x8_bf16 v[48:63], v[92:93], v[8:9], v[48:63]
    v_exp_f32 v72, v72
    v_cvt_pk_bf16_f32 v83, v70, v71
    v_exp_f32 v73, v73
    v_exp_f32 v74, v74
    v_cvt_pk_bf16_f32 v84, v72, v73
    v_exp_f32 v75, v75
    s_waitcnt lgkmcnt(4)
    v_mfma_f32_32x32x16_bf16 v[32:47], v[104:107], v[80:83], v[32:47]
    v_exp_f32 v76, v76
    v_exp_f32 v77, v77
    v_cvt_pk_bf16_f32 v85, v74, v75
    v_exp_f32 v78, v78
    v_exp_f32 v79, v79
    v_cvt_pk_bf16_f32 v86, v76, v77
    v_cvt_pk_bf16_f32 v87, v78, v79
    s_waitcnt lgkmcnt(2)
    v_mfma_f32_32x32x16_bf16 v[64:79], v[10:13], v[4:7], v[16:31]
    v_exp_f32 v48, v48
    v_exp_f32 v49, v49
    v_exp_f32 v50, v50
    v_cvt_pk_bf16_f32 v80, v48, v49
    v_exp_f32 v51, v51
    v_mfma_f32_32x32x16_bf16 v[32:47], v[108:111], v[84:87], v[32:47]
    s_waitcnt vmcnt(2) lgkmcnt(0)
    s_barrier
    s_add_u32 m0, s38, 0
    s_nop 0
    buffer_load_dwordx4 v115, s[20:23], s39 offen offset:0 lds
    s_add_u32 s39, s39, 8192
    ds_read_b128 v[88:91], v112 offset:15360
    ds_read_b64 v[92:93], v113 offset:15360
    s_mov_b64 exec, s[40:41]
    ds_read_b128 v[104:107], v114 offset:12800
    ds_read_b128 v[108:111], v114 offset:13440
    s_mov_b64 exec, -1
    v_exp_f32 v52, v52
    v_cvt_pk_bf16_f32 v81, v50, v51
    v_exp_f32 v53, v53
    v_exp_f32 v54, v54
    v_cvt_pk_bf16_f32 v82, v52, v53
    v_exp_f32 v55, v55
    v_mfma_f32_32x32x8_bf16 v[64:79], v[14:15], v[8:9], v[64:79]
    v_exp_f32 v56, v56
    v_cvt_pk_bf16_f32 v83, v54, v55
    v_exp_f32 v57, v57
    v_exp_f32 v58, v58
    v_cvt_pk_bf16_f32 v84, v56, v57
    v_exp_f32 v59, v59
    s_waitcnt lgkmcnt(4)
    v_mfma_f32_32x32x16_bf16 v[32:47], v[96:99], v[80:83], v[32:47]
    v_exp_f32 v60, v60
    v_exp_f32 v61, v61
    v_cvt_pk_bf16_f32 v85, v58, v59
    v_exp_f32 v62, v62
    v_exp_f32 v63, v63
    v_cvt_pk_bf16_f32 v86, v60, v61
    v_cvt_pk_bf16_f32 v87, v62, v63
    s_waitcnt lgkmcnt(2)
    v_mfma_f32_32x32x16_bf16 v[48:63], v[88:91], v[4:7], v[16:31]
    v_exp_f32 v64, v64
    v_exp_f32 v65, v65
    v_exp_f32 v66, v66
    v_cvt_pk_bf16_f32 v80, v64, v65
    v_exp_f32 v67, v67
    v_mfma_f32_32x32x16_bf16 v[32:47], v[100:103], v[84:87], v[32:47]
    ds_read_b128 v[10:13], v112 offset:17920
    ds_read_b64 v[14:15], v113 offset:17920
    s_mov_b64 exec, s[40:41]
    ds_read_b128 v[96:99], v114 offset:15360
    ds_read_b128 v[100:103], v114 offset:16000
    s_mov_b64 exec, -1
    v_exp_f32 v68, v68
    v_cvt_pk_bf16_f32 v81, v66, v67
    v_exp_f32 v69, v69
    v_exp_f32 v70, v70
    v_cvt_pk_bf16_f32 v82, v68, v69
    v_exp_f32 v71, v71
    v_mfma_f32_32x32x8_bf16 v[48:63], v[92:93], v[8:9], v[48:63]
    v_exp_f32 v72, v72
    v_cvt_pk_bf16_f32 v83, v70, v71
    v_exp_f32 v73, v73
    v_exp_f32 v74, v74
    v_cvt_pk_bf16_f32 v84, v72, v73
    v_exp_f32 v75, v75
    s_waitcnt lgkmcnt(4)
    v_mfma_f32_32x32x16_bf16 v[32:47], v[104:107], v[80:83], v[32:47]
    v_exp_f32 v76, v76
    v_exp_f32 v77, v77
    v_cvt_pk_bf16_f32 v85, v74, v75
    v_exp_f32 v78, v78
    v_exp_f32 v79, v79
    v_cvt_pk_bf16_f32 v86, v76, v77
    v_cvt_pk_bf16_f32 v87, v78, v79
    s_waitcnt lgkmcnt(2)
    v_mfma_f32_32x32x16_bf16 v[64:79], v[10:13], v[4:7], v[16:31]
    v_exp_f32 v48, v48
    v_exp_f32 v49, v49
    v_exp_f32 v50, v50
    v_cvt_pk_bf16_f32 v80, v48, v49
    v_exp_f32 v51, v51
    v_mfma_f32_32x32x16_bf16 v[32:47], v[108:111], v[84:87], v[32:47]
    ds_read_b128 v[88:91], v112 offset:20480
    ds_read_b64 v[92:93], v113 offset:20480
    s_mov_b64 exec, s[40:41]
    ds_read_b128 v[104:107], v114 offset:17920
    ds_read_b128 v[108:111], v114 offset:18560
    s_mov_b64 exec, -1
    v_exp_f32 v52, v52
    v_cvt_pk_bf16_f32 v81, v50, v51
    v_exp_f32 v53, v53
    v_exp_f32 v54, v54
    v_cvt_pk_bf16_f32 v82, v52, v53
    v_exp_f32 v55, v55
    v_mfma_f32_32x32x8_bf16 v[64:79], v[14:15], v[8:9], v[64:79]
    v_exp_f32 v56, v56
    v_cvt_pk_bf16_f32 v83, v54, v55
    v_exp_f32 v57, v57
    v_exp_f32 v58, v58
    v_cvt_pk_bf16_f32 v84, v56, v57
    v_exp_f32 v59, v59
    s_waitcnt lgkmcnt(4)
    v_mfma_f32_32x32x16_bf16 v[32:47], v[96:99], v[80:83], v[32:47]
    v_exp_f32 v60, v60
    v_exp_f32 v61, v61
    v_cvt_pk_bf16_f32 v85, v58, v59
    v_exp_f32 v62, v62
    v_exp_f32 v63, v63
    v_cvt_pk_bf16_f32 v86, v60, v61
    v_cvt_pk_bf16_f32 v87, v62, v63
    s_waitcnt lgkmcnt(2)
    v_mfma_f32_32x32x16_bf16 v[48:63], v[88:91], v[4:7], v[16:31]
    v_exp_f32 v64, v64
    v_exp_f32 v65, v65
    v_exp_f32 v66, v66
    v_cvt_pk_bf16_f32 v80, v64, v65
    v_exp_f32 v67, v67
    v_mfma_f32_32x32x16_bf16 v[32:47], v[100:103], v[84:87], v[32:47]
    s_waitcnt vmcnt(2) lgkmcnt(0)
    s_barrier
    s_add_u32 m0, s38, 8192
    s_nop 0
    buffer_load_dwordx4 v115, s[20:23], s39 offen offset:0 lds
    s_add_u32 s39, s39, 8192
    ds_read_b128 v[10:13], v112 offset:23040
    ds_read_b64 v[14:15], v113 offset:23040
    s_mov_b64 exec, s[40:41]
    ds_read_b128 v[96:99], v114 offset:20480
    ds_read_b128 v[100:103], v114 offset:21120
    s_mov_b64 exec, -1
    v_exp_f32 v68, v68
    v_cvt_pk_bf16_f32 v81, v66, v67
    v_exp_f32 v69, v69
    v_exp_f32 v70, v70
    v_cvt_pk_bf16_f32 v82, v68, v69
    v_exp_f32 v71, v71
    v_mfma_f32_32x32x8_bf16 v[48:63], v[92:93], v[8:9], v[48:63]
    v_exp_f32 v72, v72
    v_cvt_pk_bf16_f32 v83, v70, v71
    v_exp_f32 v73, v73
    v_exp_f32 v74, v74
    v_cvt_pk_bf16_f32 v84, v72, v73
    v_exp_f32 v75, v75
    s_waitcnt lgkmcnt(4)
    v_mfma_f32_32x32x16_bf16 v[32:47], v[104:107], v[80:83], v[32:47]
    v_exp_f32 v76, v76
    v_exp_f32 v77, v77
    v_cvt_pk_bf16_f32 v85, v74, v75
    v_exp_f32 v78, v78
    v_exp_f32 v79, v79
    v_cvt_pk_bf16_f32 v86, v76, v77
    v_cvt_pk_bf16_f32 v87, v78, v79
    s_waitcnt lgkmcnt(2)
    v_mfma_f32_32x32x16_bf16 v[64:79], v[10:13], v[4:7], v[16:31]
    v_exp_f32 v48, v48
    v_exp_f32 v49, v49
    v_exp_f32 v50, v50
    v_cvt_pk_bf16_f32 v80, v48, v49
    v_exp_f32 v51, v51
    v_mfma_f32_32x32x16_bf16 v[32:47], v[108:111], v[84:87], v[32:47]
    ds_read_b128 v[88:91], v112 offset:25600
    ds_read_b64 v[92:93], v113 offset:25600
    s_mov_b64 exec, s[40:41]
    ds_read_b128 v[104:107], v114 offset:23040
    ds_read_b128 v[108:111], v114 offset:23680
    s_mov_b64 exec, -1
    v_exp_f32 v52, v52
    v_cvt_pk_bf16_f32 v81, v50, v51
    v_exp_f32 v53, v53
    v_exp_f32 v54, v54
    v_cvt_pk_bf16_f32 v82, v52, v53
    v_exp_f32 v55, v55
    v_mfma_f32_32x32x8_bf16 v[64:79], v[14:15], v[8:9], v[64:79]
    v_exp_f32 v56, v56
    v_cvt_pk_bf16_f32 v83, v54, v55
    v_exp_f32 v57, v57
    v_exp_f32 v58, v58
    v_cvt_pk_bf16_f32 v84, v56, v57
    v_exp_f32 v59, v59
    s_waitcnt lgkmcnt(4)
    v_mfma_f32_32x32x16_bf16 v[32:47], v[96:99], v[80:83], v[32:47]
    v_exp_f32 v60, v60
    v_exp_f32 v61, v61
    v_cvt_pk_bf16_f32 v85, v58, v59
    v_exp_f32 v62, v62
    v_exp_f32 v63, v63
    v_cvt_pk_bf16_f32 v86, v60, v61
    v_cvt_pk_bf16_f32 v87, v62, v63
    s_waitcnt lgkmcnt(2)
    v_mfma_f32_32x32x16_bf16 v[48:63], v[88:91], v[4:7], v[16:31]
    v_exp_f32 v64, v64
    v_exp_f32 v65, v65
    v_exp_f32 v66, v66
    v_cvt_pk_bf16_f32 v80, v64, v65
    v_exp_f32 v67, v67
    v_mfma_f32_32x32x16_bf16 v[32:47], v[100:103], v[84:87], v[32:47]
    ds_read_b128 v[10:13], v112 offset:28160
    ds_read_b64 v[14:15], v113 offset:28160
    s_mov_b64 exec, s[40:41]
    ds_read_b128 v[96:99], v114 offset:25600
    ds_read_b128 v[100:103], v114 offset:26240
    s_mov_b64 exec, -1
    v_exp_f32 v68, v68
    v_cvt_pk_bf16_f32 v81, v66, v67
    v_exp_f32 v69, v69
    v_exp_f32 v70, v70
    v_cvt_pk_bf16_f32 v82, v68, v69
    v_exp_f32 v71, v71
    v_mfma_f32_32x32x8_bf16 v[48:63], v[92:93], v[8:9], v[48:63]
    v_exp_f32 v72, v72
    v_cvt_pk_bf16_f32 v83, v70, v71
    v_exp_f32 v73, v73
    v_exp_f32 v74, v74
    v_cvt_pk_bf16_f32 v84, v72, v73
    v_exp_f32 v75, v75
    s_waitcnt lgkmcnt(4)
    v_mfma_f32_32x32x16_bf16 v[32:47], v[104:107], v[80:83], v[32:47]
    v_exp_f32 v76, v76
    v_exp_f32 v77, v77
    v_cvt_pk_bf16_f32 v85, v74, v75
    v_exp_f32 v78, v78
    v_exp_f32 v79, v79
    v_cvt_pk_bf16_f32 v86, v76, v77
    v_cvt_pk_bf16_f32 v87, v78, v79
    s_waitcnt lgkmcnt(2)
    v_mfma_f32_32x32x16_bf16 v[64:79], v[10:13], v[4:7], v[16:31]
    v_exp_f32 v48, v48
    v_exp_f32 v49, v49
    v_exp_f32 v50, v50
    v_cvt_pk_bf16_f32 v80, v48, v49
    v_exp_f32 v51, v51
    v_mfma_f32_32x32x16_bf16 v[32:47], v[108:111], v[84:87], v[32:47]
    s_waitcnt vmcnt(2) lgkmcnt(0)
    s_barrier
    s_add_u32 m0, s38, 16384
    s_nop 0
    buffer_load_dwordx4 v115, s[20:23], s39 offen offset:0 lds
    s_add_u32 s39, s39, 8192
    ds_read_b128 v[88:91], v112 offset:30720
    ds_read_b64 v[92:93], v113 offset:30720
    s_mov_b64 exec, s[40:41]
    ds_read_b128 v[104:107], v114 offset:28160
    ds_read_b128 v[108:111], v114 offset:28800
    s_mov_b64 exec, -1
    v_exp_f32 v52, v52
    v_cvt_pk_bf16_f32 v81, v50, v51
    v_exp_f32 v53, v53
    v_exp_f32 v54, v54
    v_cvt_pk_bf16_f32 v82, v52, v53
    v_exp_f32 v55, v55
    v_mfma_f32_32x32x8_bf16 v[64:79], v[14:15], v[8:9], v[64:79]
    v_exp_f32 v56, v56
    v_cvt_pk_bf16_f32 v83, v54, v55
    v_exp_f32 v57, v57
    v_exp_f32 v58, v58
    v_cvt_pk_bf16_f32 v84, v56, v57
    v_exp_f32 v59, v59
    s_waitcnt lgkmcnt(4)
    v_mfma_f32_32x32x16_bf16 v[32:47], v[96:99], v[80:83], v[32:47]
    v_exp_f32 v60, v60
    v_exp_f32 v61, v61
    v_cvt_pk_bf16_f32 v85, v58, v59
    v_exp_f32 v62, v62
    v_exp_f32 v63, v63
    v_cvt_pk_bf16_f32 v86, v60, v61
    v_cvt_pk_bf16_f32 v87, v62, v63
    s_waitcnt lgkmcnt(2)
    v_mfma_f32_32x32x16_bf16 v[48:63], v[88:91], v[4:7], v[16:31]
    v_exp_f32 v64, v64
    v_exp_f32 v65, v65
    v_exp_f32 v66, v66
    v_cvt_pk_bf16_f32 v80, v64, v65
    v_exp_f32 v67, v67
    v_mfma_f32_32x32x16_bf16 v[32:47], v[100:103], v[84:87], v[32:47]
    ds_read_b128 v[10:13], v112 offset:33280
    ds_read_b64 v[14:15], v113 offset:33280
    s_mov_b64 exec, s[40:41]
    ds_read_b128 v[96:99], v114 offset:30720
    ds_read_b128 v[100:103], v114 offset:31360
    s_mov_b64 exec, -1
    v_exp_f32 v68, v68
    v_cvt_pk_bf16_f32 v81, v66, v67
    v_exp_f32 v69, v69
    v_exp_f32 v70, v70
    v_cvt_pk_bf16_f32 v82, v68, v69
    v_exp_f32 v71, v71
    v_mfma_f32_32x32x8_bf16 v[48:63], v[92:93], v[8:9], v[48:63]
    v_exp_f32 v72, v72
    v_cvt_pk_bf16_f32 v83, v70, v71
    v_exp_f32 v73, v73
    v_exp_f32 v74, v74
    v_cvt_pk_bf16_f32 v84, v72, v73
    v_exp_f32 v75, v75
    s_waitcnt lgkmcnt(4)
    v_mfma_f32_32x32x16_bf16 v[32:47], v[104:107], v[80:83], v[32:47]
    v_exp_f32 v76, v76
    v_exp_f32 v77, v77
    v_cvt_pk_bf16_f32 v85, v74, v75
    v_exp_f32 v78, v78
    v_exp_f32 v79, v79
    v_cvt_pk_bf16_f32 v86, v76, v77
    v_cvt_pk_bf16_f32 v87, v78, v79
    s_waitcnt lgkmcnt(2)
    v_mfma_f32_32x32x16_bf16 v[64:79], v[10:13], v[4:7], v[16:31]
    v_exp_f32 v48, v48
    v_exp_f32 v49, v49
    v_exp_f32 v50, v50
    v_cvt_pk_bf16_f32 v80, v48, v49
    v_exp_f32 v51, v51
    v_mfma_f32_32x32x16_bf16 v[32:47], v[108:111], v[84:87], v[32:47]
    ds_read_b128 v[88:91], v112 offset:35840
    ds_read_b64 v[92:93], v113 offset:35840
    s_mov_b64 exec, s[40:41]
    ds_read_b128 v[104:107], v114 offset:33280
    ds_read_b128 v[108:111], v114 offset:33920
    s_mov_b64 exec, -1
    v_exp_f32 v52, v52
    v_cvt_pk_bf16_f32 v81, v50, v51
    v_exp_f32 v53, v53
    v_exp_f32 v54, v54
    v_cvt_pk_bf16_f32 v82, v52, v53
    v_exp_f32 v55, v55
    v_mfma_f32_32x32x8_bf16 v[64:79], v[14:15], v[8:9], v[64:79]
    v_exp_f32 v56, v56
    v_cvt_pk_bf16_f32 v83, v54, v55
    v_exp_f32 v57, v57
    v_exp_f32 v58, v58
    v_cvt_pk_bf16_f32 v84, v56, v57
    v_exp_f32 v59, v59
    s_waitcnt lgkmcnt(4)
    v_mfma_f32_32x32x16_bf16 v[32:47], v[96:99], v[80:83], v[32:47]
    v_exp_f32 v60, v60
    v_exp_f32 v61, v61
    v_cvt_pk_bf16_f32 v85, v58, v59
    v_exp_f32 v62, v62
    v_exp_f32 v63, v63
    v_cvt_pk_bf16_f32 v86, v60, v61
    v_cvt_pk_bf16_f32 v87, v62, v63
    s_waitcnt lgkmcnt(2)
    v_mfma_f32_32x32x16_bf16 v[48:63], v[88:91], v[4:7], v[16:31]
    v_exp_f32 v64, v64
    v_exp_f32 v65, v65
    v_exp_f32 v66, v66
    v_cvt_pk_bf16_f32 v80, v64, v65
    v_exp_f32 v67, v67
    v_mfma_f32_32x32x16_bf16 v[32:47], v[100:103], v[84:87], v[32:47]
    ds_read_b128 v[10:13], v112 offset:38400
    ds_read_b64 v[14:15], v113 offset:38400
    s_mov_b64 exec, s[40:41]
    ds_read_b128 v[96:99], v114 offset:35840
    ds_read_b128 v[100:103], v114 offset:36480
    s_mov_b64 exec, -1
    v_exp_f32 v68, v68
    v_cvt_pk_bf16_f32 v81, v66, v67
    v_exp_f32 v69, v69
    v_exp_f32 v70, v70
    v_cvt_pk_bf16_f32 v82, v68, v69
    v_exp_f32 v71, v71
    v_mfma_f32_32x32x8_bf16 v[48:63], v[92:93], v[8:9], v[48:63]
    v_exp_f32 v72, v72
    v_cvt_pk_bf16_f32 v83, v70, v71
    v_exp_f32 v73, v73
    v_exp_f32 v74, v74
    v_cvt_pk_bf16_f32 v84, v72, v73
    v_exp_f32 v75, v75
    s_waitcnt lgkmcnt(4)
    v_mfma_f32_32x32x16_bf16 v[32:47], v[104:107], v[80:83], v[32:47]
    v_exp_f32 v76, v76
    v_exp_f32 v77, v77
    v_cvt_pk_bf16_f32 v85, v74, v75
    v_exp_f32 v78, v78
    v_exp_f32 v79, v79
    v_cvt_pk_bf16_f32 v86, v76, v77
    v_cvt_pk_bf16_f32 v87, v78, v79
    s_waitcnt lgkmcnt(2)
    v_mfma_f32_32x32x16_bf16 v[64:79], v[10:13], v[4:7], v[16:31]
    v_exp_f32 v48, v48
    v_exp_f32 v49, v49
    v_exp_f32 v50, v50
    v_cvt_pk_bf16_f32 v80, v48, v49
    v_exp_f32 v51, v51
    v_mfma_f32_32x32x16_bf16 v[32:47], v[108:111], v[84:87], v[32:47]
    s_waitcnt vmcnt(2) lgkmcnt(0)
    s_barrier
    s_add_u32 m0, s38, 24576
    s_nop 0
    buffer_load_dwordx4 v115, s[20:23], s39 offen offset:0 lds
    s_add_u32 s39, s39, 8192
    ds_read_b128 v[88:91], v112 offset:0
    ds_read_b64 v[92:93], v113 offset:0
    s_mov_b64 exec, s[40:41]
    ds_read_b128 v[104:107], v114 offset:38400
    ds_read_b128 v[108:111], v114 offset:39040
    s_mov_b64 exec, -1
    v_exp_f32 v52, v52
    v_cvt_pk_bf16_f32 v81, v50, v51
    v_exp_f32 v53, v53
    v_exp_f32 v54, v54
    v_cvt_pk_bf16_f32 v82, v52, v53
    v_exp_f32 v55, v55
    v_mfma_f32_32x32x8_bf16 v[64:79], v[14:15], v[8:9], v[64:79]
    v_exp_f32 v56, v56
    v_cvt_pk_bf16_f32 v83, v54, v55
    v_exp_f32 v57, v57
    v_exp_f32 v58, v58
    v_cvt_pk_bf16_f32 v84, v56, v57
    v_exp_f32 v59, v59
    s_waitcnt lgkmcnt(4)
    v_mfma_f32_32x32x16_bf16 v[32:47], v[96:99], v[80:83], v[32:47]
    v_exp_f32 v60, v60
    v_exp_f32 v61, v61
    v_cvt_pk_bf16_f32 v85, v58, v59
    v_exp_f32 v62, v62
    v_exp_f32 v63, v63
    v_cvt_pk_bf16_f32 v86, v60, v61
    v_cvt_pk_bf16_f32 v87, v62, v63
    s_waitcnt lgkmcnt(2)
    v_mfma_f32_32x32x16_bf16 v[48:63], v[88:91], v[4:7], v[16:31]
    v_exp_f32 v64, v64
    v_exp_f32 v65, v65
    v_exp_f32 v66, v66
    v_cvt_pk_bf16_f32 v80, v64, v65
    v_exp_f32 v67, v67
    v_mfma_f32_32x32x16_bf16 v[32:47], v[100:103], v[84:87], v[32:47]
    ds_read_b128 v[10:13], v112 offset:2560
    ds_read_b64 v[14:15], v113 offset:2560
    s_mov_b64 exec, s[40:41]
    ds_read_b128 v[96:99], v114 offset:0
    ds_read_b128 v[100:103], v114 offset:640
    s_mov_b64 exec, -1
    v_exp_f32 v68, v68
    v_cvt_pk_bf16_f32 v81, v66, v67
    v_exp_f32 v69, v69
    v_exp_f32 v70, v70
    v_cvt_pk_bf16_f32 v82, v68, v69
    v_exp_f32 v71, v71
    v_mfma_f32_32x32x8_bf16 v[48:63], v[92:93], v[8:9], v[48:63]
    v_exp_f32 v72, v72
    v_cvt_pk_bf16_f32 v83, v70, v71
    v_exp_f32 v73, v73
    v_exp_f32 v74, v74
    v_cvt_pk_bf16_f32 v84, v72, v73
    v_exp_f32 v75, v75
    s_waitcnt lgkmcnt(4)
    v_mfma_f32_32x32x16_bf16 v[32:47], v[104:107], v[80:83], v[32:47]
    v_exp_f32 v76, v76
    v_exp_f32 v77, v77
    v_cvt_pk_bf16_f32 v85, v74, v75
    v_exp_f32 v78, v78
    v_exp_f32 v79, v79
    v_cvt_pk_bf16_f32 v86, v76, v77
    v_cvt_pk_bf16_f32 v87, v78, v79
    s_add_u32 s47, s47, 1
    s_cmp_lt_u32 s47, 4
    s_cbranch_scc1 K2_LOOP

    v_mfma_f32_32x32x16_bf16 v[32:47], v[108:111], v[84:87], v[32:47]
    s_nop 15
    v_cndmask_b32 v120, v44, v40, s[42:43]
    v_cndmask_b32 v121, v44, v40, s[42:43]
    s_cmp_eq_u32 s46, 0
    s_cbranch_scc1 K2_CHECK
    s_waitcnt vmcnt(0) lgkmcnt(0)
    s_barrier
    s_branch K2_FINISH
K2_CHECK:
    v_mov_b32 v122, 0x5d800000
    v_cmp_nlt_f32 vcc, v120, v122
    v_cmp_nlt_f32 s[48:49], v121, v122
    v_mov_b32 v116, 40960
    v_mov_b32 v117, 1
    s_or_b64 vcc, vcc, s[48:49]
    s_and_saveexec_b64 s[48:49], vcc
    s_cbranch_execz K2_NOBAD
    ds_write_b32 v116, v117
K2_NOBAD:
    s_mov_b64 exec, -1
    s_waitcnt vmcnt(0) lgkmcnt(0)
    s_barrier
    ds_read_b32 v117, v116
    s_waitcnt lgkmcnt(0)
    v_readfirstlane_b32 s48, v117
    s_cmp_eq_u32 s48, 0
    s_cbranch_scc1 K2_FINISH
    s_mov_b32 s46, 1
    s_mov_b32 s39, s37
    s_mov_b32 s47, 0
    v_mov_b32 v120, 0xff800000
    v_mov_b32 v121, 0xff800000

K2_MAXLOOP:
    buffer_load_dwordx4 v[88:91], v112, s[20:23], s39 offen
    s_mov_b64 exec, s[44:45]
    buffer_load_dwordx2 v[92:93], v113, s[20:23], s39 offen
    s_mov_b64 exec, -1
    s_waitcnt vmcnt(0)

    v_mfma_f32_32x32x16_bf16 v[48:63], v[88:91], v[4:7], 0
    v_mfma_f32_32x32x8_bf16 v[48:63], v[92:93], v[8:9], v[48:63]
    s_nop 15
    v_max3_f32 v120, v120, v48, v49
    v_max3_f32 v120, v120, v50, v51
    v_max3_f32 v120, v120, v52, v53
    v_max3_f32 v120, v120, v54, v55
    v_max3_f32 v120, v120, v56, v57
    v_max3_f32 v120, v120, v58, v59
    v_max3_f32 v120, v120, v60, v61
    v_max3_f32 v120, v120, v62, v63
    s_add_u32 s39, s39, 2560
    s_add_u32 s47, s47, 1
    s_cmp_lt_u32 s47, 64
    s_cbranch_scc1 K2_MAXLOOP

    v_mov_b32 v118, v120
    v_mov_b32 v119, v120
    s_nop 1
    v_permlane32_swap_b32 v118, v119
    s_nop 1
    v_max_f32 v118, v118, v119

    v_sub_f32 v16, 0, v118
    v_sub_f32 v17, 0, v118
    v_sub_f32 v18, 0, v118
    v_sub_f32 v19, 0, v118
    v_sub_f32 v20, 0, v118
    v_sub_f32 v21, 0, v118
    v_sub_f32 v22, 0, v118
    v_sub_f32 v23, 0, v118
    v_sub_f32 v24, 0, v118
    v_sub_f32 v25, 0, v118
    v_sub_f32 v26, 0, v118
    v_sub_f32 v27, 0, v118
    v_sub_f32 v28, 0, v118
    v_sub_f32 v29, 0, v118
    v_sub_f32 v30, 0, v118
    v_sub_f32 v31, 0, v118
    s_barrier
    s_branch K2_RESTART
K2_FINISH:
    v_rcp_f32 v120, v120
    s_mul_i32 s48, s35, 147456
    s_mul_i32 s49, s34, 1536
    s_add_u32 s48, s48, s49
    s_add_u32 s48, s48, 13172736

    v_mul_f32 v32, v32, v120
    v_mul_f32 v33, v33, v120
    v_mul_f32 v34, v34, v120
    v_mul_f32 v35, v35, v120
    v_mul_f32 v36, v36, v120
    v_mul_f32 v37, v37, v120
    v_mul_f32 v38, v38, v120
    v_mul_f32 v39, v39, v120
    v_mul_f32 v40, v40, v120
    v_mul_f32 v41, v41, v120
    v_mul_f32 v42, v42, v120
    v_mul_f32 v43, v43, v120
    v_cvt_pk_bf16_f32 v80, v32, v33
    v_cvt_pk_bf16_f32 v81, v34, v35
    v_cvt_pk_bf16_f32 v82, v36, v37
    v_cvt_pk_bf16_f32 v83, v38, v39
    v_cvt_pk_bf16_f32 v84, v40, v41
    v_cvt_pk_bf16_f32 v85, v42, v43
    v_mov_b32 v86, 0
    v_mov_b32 v87, 0
    v_permlane32_swap_b32 v80, v82
    v_permlane32_swap_b32 v81, v83
    buffer_store_dwordx4 v[80:83], v112, s[20:23], s48 offen sc1
    s_mov_b64 exec, s[44:45]
    buffer_store_dwordx4 v[84:87], v112, s[20:23], s48 offen offset:1024 sc1

    s_mov_b64 exec, 1
    s_lshl_b32 s54, s35, 7
    s_add_u32 s54, s54, 32768
    v_mov_b32 v116, s54
    v_mov_b32 v117, 1
    s_waitcnt vmcnt(0)
    global_atomic_add v116, v117, s[6:7] sc1
    s_mov_b64 exec, -1

    s_endpgm
K2_GEMM:
    s_sub_u32 s36, s3, 8
    s_lshl_b32 s35, s35, 3
    s_lshr_b32 s39, s34, 2
    s_add_u32 s39, s39, s35
    s_and_b32 s35, s34, 3
    s_mov_b32 s34, s39
    v_lshlrev_b32 v4, 4, v1
    v_add_u32 v5, 4096, v4
    s_mul_i32 s39, s36, 24
    s_add_u32 s39, s39, 48
    s_mul_i32 s37, s34, 147456
    s_add_u32 s37, s37, 13172736
    s_mul_i32 s38, s36, 12288
    s_add_u32 s55, s37, s38
    s_lshl_b32 s38, s39, 10
    s_add_u32 s37, s37, s38
    s_mul_i32 s38, s39, 20
    s_mul_i32 s39, s35, 5
    s_add_u32 s38, s38, s39
    s_lshl_b32 s38, s38, 10
    s_add_u32 s38, s38, 23068672
    s_mul_i32 s56, s36, 240
    s_add_u32 s56, s56, s39
    s_lshl_b32 s56, s56, 10
    s_add_u32 s56, s56, 23068672

    buffer_load_dwordx4 v[96:99], v4, s[20:23], s37 offen
    buffer_load_dwordx4 v[100:103], v4, s[20:23], s38 offen offset:0
    buffer_load_dwordx4 v[104:107], v4, s[20:23], s38 offen offset:1024
    buffer_load_dwordx4 v[108:111], v4, s[20:23], s38 offen offset:2048
    buffer_load_dwordx4 v[112:115], v4, s[20:23], s38 offen offset:3072
    buffer_load_dwordx4 v[116:119], v5, s[20:23], s38 offen
    s_add_u32 s38, s38, 20480
    s_add_u32 s37, s37, 1024
    buffer_load_dwordx4 v[120:123], v4, s[20:23], s37 offen
    buffer_load_dwordx4 v[124:127], v4, s[20:23], s38 offen offset:0
    buffer_load_dwordx4 v[128:131], v4, s[20:23], s38 offen offset:1024
    buffer_load_dwordx4 v[132:135], v4, s[20:23], s38 offen offset:2048
    buffer_load_dwordx4 v[136:139], v4, s[20:23], s38 offen offset:3072
    buffer_load_dwordx4 v[140:143], v5, s[20:23], s38 offen
    s_add_u32 s38, s38, 20480
    s_add_u32 s37, s37, 1024
    v_mov_b32 v16, 0
    v_mov_b32 v17, 0
    v_mov_b32 v18, 0
    v_mov_b32 v19, 0
    v_mov_b32 v20, 0
    v_mov_b32 v21, 0
    v_mov_b32 v22, 0
    v_mov_b32 v23, 0
    v_mov_b32 v24, 0
    v_mov_b32 v25, 0
    v_mov_b32 v26, 0
    v_mov_b32 v27, 0
    v_mov_b32 v28, 0
    v_mov_b32 v29, 0
    v_mov_b32 v30, 0
    v_mov_b32 v31, 0
    v_mov_b32 v32, 0
    v_mov_b32 v33, 0
    v_mov_b32 v34, 0
    v_mov_b32 v35, 0
    v_mov_b32 v36, 0
    v_mov_b32 v37, 0
    v_mov_b32 v38, 0
    v_mov_b32 v39, 0
    v_mov_b32 v40, 0
    v_mov_b32 v41, 0
    v_mov_b32 v42, 0
    v_mov_b32 v43, 0
    v_mov_b32 v44, 0
    v_mov_b32 v45, 0
    v_mov_b32 v46, 0
    v_mov_b32 v47, 0
    v_mov_b32 v48, 0
    v_mov_b32 v49, 0
    v_mov_b32 v50, 0
    v_mov_b32 v51, 0
    v_mov_b32 v52, 0
    v_mov_b32 v53, 0
    v_mov_b32 v54, 0
    v_mov_b32 v55, 0
    v_mov_b32 v56, 0
    v_mov_b32 v57, 0
    v_mov_b32 v58, 0
    v_mov_b32 v59, 0
    v_mov_b32 v60, 0
    v_mov_b32 v61, 0
    v_mov_b32 v62, 0
    v_mov_b32 v63, 0
    v_mov_b32 v64, 0
    v_mov_b32 v65, 0
    v_mov_b32 v66, 0
    v_mov_b32 v67, 0
    v_mov_b32 v68, 0
    v_mov_b32 v69, 0
    v_mov_b32 v70, 0
    v_mov_b32 v71, 0
    v_mov_b32 v72, 0
    v_mov_b32 v73, 0
    v_mov_b32 v74, 0
    v_mov_b32 v75, 0
    v_mov_b32 v76, 0
    v_mov_b32 v77, 0
    v_mov_b32 v78, 0
    v_mov_b32 v79, 0
    v_mov_b32 v80, 0
    v_mov_b32 v81, 0
    v_mov_b32 v82, 0
    v_mov_b32 v83, 0
    v_mov_b32 v84, 0
    v_mov_b32 v85, 0
    v_mov_b32 v86, 0
    v_mov_b32 v87, 0
    v_mov_b32 v88, 0
    v_mov_b32 v89, 0
    v_mov_b32 v90, 0
    v_mov_b32 v91, 0
    v_mov_b32 v92, 0
    v_mov_b32 v93, 0
    v_mov_b32 v94, 0
    v_mov_b32 v95, 0
    s_barrier
    buffer_load_dwordx4 v[144:147], v4, s[20:23], s37 offen
    buffer_load_dwordx4 v[148:151], v4, s[20:23], s38 offen offset:0
    buffer_load_dwordx4 v[152:155], v4, s[20:23], s38 offen offset:1024
    buffer_load_dwordx4 v[156:159], v4, s[20:23], s38 offen offset:2048
    buffer_load_dwordx4 v[160:163], v4, s[20:23], s38 offen offset:3072
    buffer_load_dwordx4 v[164:167], v5, s[20:23], s38 offen
    s_add_u32 s38, s38, 20480
    s_add_u32 s37, s37, 1024
    s_waitcnt vmcnt(12)
    v_mfma_f32_32x32x16_bf16 v[16:31], v[100:103], v[96:99], v[16:31]
    v_mfma_f32_32x32x16_bf16 v[32:47], v[104:107], v[96:99], v[32:47]
    v_mfma_f32_32x32x16_bf16 v[48:63], v[108:111], v[96:99], v[48:63]
    v_mfma_f32_32x32x16_bf16 v[64:79], v[112:115], v[96:99], v[64:79]
    v_mfma_f32_32x32x16_bf16 v[80:95], v[116:119], v[96:99], v[80:95]
    s_barrier
    buffer_load_dwordx4 v[96:99], v4, s[20:23], s37 offen
    buffer_load_dwordx4 v[100:103], v4, s[20:23], s38 offen offset:0
    buffer_load_dwordx4 v[104:107], v4, s[20:23], s38 offen offset:1024
    buffer_load_dwordx4 v[108:111], v4, s[20:23], s38 offen offset:2048
    buffer_load_dwordx4 v[112:115], v4, s[20:23], s38 offen offset:3072
    buffer_load_dwordx4 v[116:119], v5, s[20:23], s38 offen
    s_add_u32 s38, s38, 20480
    s_add_u32 s37, s37, 1024
    s_waitcnt vmcnt(12)
    v_mfma_f32_32x32x16_bf16 v[16:31], v[124:127], v[120:123], v[16:31]
    v_mfma_f32_32x32x16_bf16 v[32:47], v[128:131], v[120:123], v[32:47]
    v_mfma_f32_32x32x16_bf16 v[48:63], v[132:135], v[120:123], v[48:63]
    v_mfma_f32_32x32x16_bf16 v[64:79], v[136:139], v[120:123], v[64:79]
    v_mfma_f32_32x32x16_bf16 v[80:95], v[140:143], v[120:123], v[80:95]
    s_barrier
    buffer_load_dwordx4 v[120:123], v4, s[20:23], s37 offen
    buffer_load_dwordx4 v[124:127], v4, s[20:23], s38 offen offset:0
    buffer_load_dwordx4 v[128:131], v4, s[20:23], s38 offen offset:1024
    buffer_load_dwordx4 v[132:135], v4, s[20:23], s38 offen offset:2048
    buffer_load_dwordx4 v[136:139], v4, s[20:23], s38 offen offset:3072
    buffer_load_dwordx4 v[140:143], v5, s[20:23], s38 offen
    s_add_u32 s38, s38, 20480
    s_add_u32 s37, s37, 1024
    s_waitcnt vmcnt(12)
    v_mfma_f32_32x32x16_bf16 v[16:31], v[148:151], v[144:147], v[16:31]
    v_mfma_f32_32x32x16_bf16 v[32:47], v[152:155], v[144:147], v[32:47]
    v_mfma_f32_32x32x16_bf16 v[48:63], v[156:159], v[144:147], v[48:63]
    v_mfma_f32_32x32x16_bf16 v[64:79], v[160:163], v[144:147], v[64:79]
    v_mfma_f32_32x32x16_bf16 v[80:95], v[164:167], v[144:147], v[80:95]
    s_barrier
    buffer_load_dwordx4 v[144:147], v4, s[20:23], s37 offen
    buffer_load_dwordx4 v[148:151], v4, s[20:23], s38 offen offset:0
    buffer_load_dwordx4 v[152:155], v4, s[20:23], s38 offen offset:1024
    buffer_load_dwordx4 v[156:159], v4, s[20:23], s38 offen offset:2048
    buffer_load_dwordx4 v[160:163], v4, s[20:23], s38 offen offset:3072
    buffer_load_dwordx4 v[164:167], v5, s[20:23], s38 offen
    s_add_u32 s38, s38, 20480
    s_add_u32 s37, s37, 1024
    s_waitcnt vmcnt(12)
    v_mfma_f32_32x32x16_bf16 v[16:31], v[100:103], v[96:99], v[16:31]
    v_mfma_f32_32x32x16_bf16 v[32:47], v[104:107], v[96:99], v[32:47]
    v_mfma_f32_32x32x16_bf16 v[48:63], v[108:111], v[96:99], v[48:63]
    v_mfma_f32_32x32x16_bf16 v[64:79], v[112:115], v[96:99], v[64:79]
    v_mfma_f32_32x32x16_bf16 v[80:95], v[116:119], v[96:99], v[80:95]
    buffer_load_dwordx4 v[96:99], v4, s[20:23], s37 offen
    buffer_load_dwordx4 v[100:103], v4, s[20:23], s38 offen offset:0
    buffer_load_dwordx4 v[104:107], v4, s[20:23], s38 offen offset:1024
    buffer_load_dwordx4 v[108:111], v4, s[20:23], s38 offen offset:2048
    buffer_load_dwordx4 v[112:115], v4, s[20:23], s38 offen offset:3072
    buffer_load_dwordx4 v[116:119], v5, s[20:23], s38 offen
    s_add_u32 s38, s38, 20480
    s_add_u32 s37, s37, 1024
    s_waitcnt vmcnt(12)
    v_mfma_f32_32x32x16_bf16 v[16:31], v[124:127], v[120:123], v[16:31]
    v_mfma_f32_32x32x16_bf16 v[32:47], v[128:131], v[120:123], v[32:47]
    v_mfma_f32_32x32x16_bf16 v[48:63], v[132:135], v[120:123], v[48:63]
    v_mfma_f32_32x32x16_bf16 v[64:79], v[136:139], v[120:123], v[64:79]
    v_mfma_f32_32x32x16_bf16 v[80:95], v[140:143], v[120:123], v[80:95]
    s_barrier
    buffer_load_dwordx4 v[120:123], v4, s[20:23], s37 offen
    buffer_load_dwordx4 v[124:127], v4, s[20:23], s38 offen offset:0
    buffer_load_dwordx4 v[128:131], v4, s[20:23], s38 offen offset:1024
    buffer_load_dwordx4 v[132:135], v4, s[20:23], s38 offen offset:2048
    buffer_load_dwordx4 v[136:139], v4, s[20:23], s38 offen offset:3072
    buffer_load_dwordx4 v[140:143], v5, s[20:23], s38 offen
    s_add_u32 s38, s38, 20480
    s_add_u32 s37, s37, 1024
    s_waitcnt vmcnt(12)
    v_mfma_f32_32x32x16_bf16 v[16:31], v[148:151], v[144:147], v[16:31]
    v_mfma_f32_32x32x16_bf16 v[32:47], v[152:155], v[144:147], v[32:47]
    v_mfma_f32_32x32x16_bf16 v[48:63], v[156:159], v[144:147], v[48:63]
    v_mfma_f32_32x32x16_bf16 v[64:79], v[160:163], v[144:147], v[64:79]
    v_mfma_f32_32x32x16_bf16 v[80:95], v[164:167], v[144:147], v[80:95]
    s_barrier
    buffer_load_dwordx4 v[144:147], v4, s[20:23], s37 offen
    buffer_load_dwordx4 v[148:151], v4, s[20:23], s38 offen offset:0
    buffer_load_dwordx4 v[152:155], v4, s[20:23], s38 offen offset:1024
    buffer_load_dwordx4 v[156:159], v4, s[20:23], s38 offen offset:2048
    buffer_load_dwordx4 v[160:163], v4, s[20:23], s38 offen offset:3072
    buffer_load_dwordx4 v[164:167], v5, s[20:23], s38 offen
    s_add_u32 s38, s38, 20480
    s_add_u32 s37, s37, 1024
    s_waitcnt vmcnt(12)
    v_mfma_f32_32x32x16_bf16 v[16:31], v[100:103], v[96:99], v[16:31]
    v_mfma_f32_32x32x16_bf16 v[32:47], v[104:107], v[96:99], v[32:47]
    v_mfma_f32_32x32x16_bf16 v[48:63], v[108:111], v[96:99], v[48:63]
    v_mfma_f32_32x32x16_bf16 v[64:79], v[112:115], v[96:99], v[64:79]
    v_mfma_f32_32x32x16_bf16 v[80:95], v[116:119], v[96:99], v[80:95]
    s_barrier
    buffer_load_dwordx4 v[96:99], v4, s[20:23], s37 offen
    buffer_load_dwordx4 v[100:103], v4, s[20:23], s38 offen offset:0
    buffer_load_dwordx4 v[104:107], v4, s[20:23], s38 offen offset:1024
    buffer_load_dwordx4 v[108:111], v4, s[20:23], s38 offen offset:2048
    buffer_load_dwordx4 v[112:115], v4, s[20:23], s38 offen offset:3072
    buffer_load_dwordx4 v[116:119], v5, s[20:23], s38 offen
    s_add_u32 s38, s38, 20480
    s_add_u32 s37, s37, 1024
    s_waitcnt vmcnt(12)
    v_mfma_f32_32x32x16_bf16 v[16:31], v[124:127], v[120:123], v[16:31]
    v_mfma_f32_32x32x16_bf16 v[32:47], v[128:131], v[120:123], v[32:47]
    v_mfma_f32_32x32x16_bf16 v[48:63], v[132:135], v[120:123], v[48:63]
    v_mfma_f32_32x32x16_bf16 v[64:79], v[136:139], v[120:123], v[64:79]
    v_mfma_f32_32x32x16_bf16 v[80:95], v[140:143], v[120:123], v[80:95]
    s_barrier
    buffer_load_dwordx4 v[120:123], v4, s[20:23], s37 offen
    buffer_load_dwordx4 v[124:127], v4, s[20:23], s38 offen offset:0
    buffer_load_dwordx4 v[128:131], v4, s[20:23], s38 offen offset:1024
    buffer_load_dwordx4 v[132:135], v4, s[20:23], s38 offen offset:2048
    buffer_load_dwordx4 v[136:139], v4, s[20:23], s38 offen offset:3072
    buffer_load_dwordx4 v[140:143], v5, s[20:23], s38 offen
    s_add_u32 s38, s38, 20480
    s_add_u32 s37, s37, 1024
    s_waitcnt vmcnt(12)
    v_mfma_f32_32x32x16_bf16 v[16:31], v[148:151], v[144:147], v[16:31]
    v_mfma_f32_32x32x16_bf16 v[32:47], v[152:155], v[144:147], v[32:47]
    v_mfma_f32_32x32x16_bf16 v[48:63], v[156:159], v[144:147], v[48:63]
    v_mfma_f32_32x32x16_bf16 v[64:79], v[160:163], v[144:147], v[64:79]
    v_mfma_f32_32x32x16_bf16 v[80:95], v[164:167], v[144:147], v[80:95]
    buffer_load_dwordx4 v[144:147], v4, s[20:23], s37 offen
    buffer_load_dwordx4 v[148:151], v4, s[20:23], s38 offen offset:0
    buffer_load_dwordx4 v[152:155], v4, s[20:23], s38 offen offset:1024
    buffer_load_dwordx4 v[156:159], v4, s[20:23], s38 offen offset:2048
    buffer_load_dwordx4 v[160:163], v4, s[20:23], s38 offen offset:3072
    buffer_load_dwordx4 v[164:167], v5, s[20:23], s38 offen
    s_add_u32 s38, s38, 20480
    s_add_u32 s37, s37, 1024
    s_waitcnt vmcnt(12)
    v_mfma_f32_32x32x16_bf16 v[16:31], v[100:103], v[96:99], v[16:31]
    v_mfma_f32_32x32x16_bf16 v[32:47], v[104:107], v[96:99], v[32:47]
    v_mfma_f32_32x32x16_bf16 v[48:63], v[108:111], v[96:99], v[48:63]
    v_mfma_f32_32x32x16_bf16 v[64:79], v[112:115], v[96:99], v[64:79]
    v_mfma_f32_32x32x16_bf16 v[80:95], v[116:119], v[96:99], v[80:95]
    s_barrier
    buffer_load_dwordx4 v[96:99], v4, s[20:23], s37 offen
    buffer_load_dwordx4 v[100:103], v4, s[20:23], s38 offen offset:0
    buffer_load_dwordx4 v[104:107], v4, s[20:23], s38 offen offset:1024
    buffer_load_dwordx4 v[108:111], v4, s[20:23], s38 offen offset:2048
    buffer_load_dwordx4 v[112:115], v4, s[20:23], s38 offen offset:3072
    buffer_load_dwordx4 v[116:119], v5, s[20:23], s38 offen
    s_add_u32 s38, s38, 20480
    s_add_u32 s37, s37, 1024
    s_waitcnt vmcnt(12)
    v_mfma_f32_32x32x16_bf16 v[16:31], v[124:127], v[120:123], v[16:31]
    v_mfma_f32_32x32x16_bf16 v[32:47], v[128:131], v[120:123], v[32:47]
    v_mfma_f32_32x32x16_bf16 v[48:63], v[132:135], v[120:123], v[48:63]
    v_mfma_f32_32x32x16_bf16 v[64:79], v[136:139], v[120:123], v[64:79]
    v_mfma_f32_32x32x16_bf16 v[80:95], v[140:143], v[120:123], v[80:95]
    s_barrier
    buffer_load_dwordx4 v[120:123], v4, s[20:23], s37 offen
    buffer_load_dwordx4 v[124:127], v4, s[20:23], s38 offen offset:0
    buffer_load_dwordx4 v[128:131], v4, s[20:23], s38 offen offset:1024
    buffer_load_dwordx4 v[132:135], v4, s[20:23], s38 offen offset:2048
    buffer_load_dwordx4 v[136:139], v4, s[20:23], s38 offen offset:3072
    buffer_load_dwordx4 v[140:143], v5, s[20:23], s38 offen
    s_add_u32 s38, s38, 20480
    s_add_u32 s37, s37, 1024
    s_waitcnt vmcnt(12)
    v_mfma_f32_32x32x16_bf16 v[16:31], v[148:151], v[144:147], v[16:31]
    v_mfma_f32_32x32x16_bf16 v[32:47], v[152:155], v[144:147], v[32:47]
    v_mfma_f32_32x32x16_bf16 v[48:63], v[156:159], v[144:147], v[48:63]
    v_mfma_f32_32x32x16_bf16 v[64:79], v[160:163], v[144:147], v[64:79]
    v_mfma_f32_32x32x16_bf16 v[80:95], v[164:167], v[144:147], v[80:95]
    s_barrier
    buffer_load_dwordx4 v[144:147], v4, s[20:23], s37 offen
    buffer_load_dwordx4 v[148:151], v4, s[20:23], s38 offen offset:0
    buffer_load_dwordx4 v[152:155], v4, s[20:23], s38 offen offset:1024
    buffer_load_dwordx4 v[156:159], v4, s[20:23], s38 offen offset:2048
    buffer_load_dwordx4 v[160:163], v4, s[20:23], s38 offen offset:3072
    buffer_load_dwordx4 v[164:167], v5, s[20:23], s38 offen
    s_add_u32 s38, s38, 20480
    s_add_u32 s37, s37, 1024
    s_waitcnt vmcnt(12)
    v_mfma_f32_32x32x16_bf16 v[16:31], v[100:103], v[96:99], v[16:31]
    v_mfma_f32_32x32x16_bf16 v[32:47], v[104:107], v[96:99], v[32:47]
    v_mfma_f32_32x32x16_bf16 v[48:63], v[108:111], v[96:99], v[48:63]
    v_mfma_f32_32x32x16_bf16 v[64:79], v[112:115], v[96:99], v[64:79]
    v_mfma_f32_32x32x16_bf16 v[80:95], v[116:119], v[96:99], v[80:95]
    s_barrier
    buffer_load_dwordx4 v[96:99], v4, s[20:23], s37 offen
    buffer_load_dwordx4 v[100:103], v4, s[20:23], s38 offen offset:0
    buffer_load_dwordx4 v[104:107], v4, s[20:23], s38 offen offset:1024
    buffer_load_dwordx4 v[108:111], v4, s[20:23], s38 offen offset:2048
    buffer_load_dwordx4 v[112:115], v4, s[20:23], s38 offen offset:3072
    buffer_load_dwordx4 v[116:119], v5, s[20:23], s38 offen
    s_add_u32 s38, s38, 20480
    s_add_u32 s37, s37, 1024
    s_waitcnt vmcnt(12)
    v_mfma_f32_32x32x16_bf16 v[16:31], v[124:127], v[120:123], v[16:31]
    v_mfma_f32_32x32x16_bf16 v[32:47], v[128:131], v[120:123], v[32:47]
    v_mfma_f32_32x32x16_bf16 v[48:63], v[132:135], v[120:123], v[48:63]
    v_mfma_f32_32x32x16_bf16 v[64:79], v[136:139], v[120:123], v[64:79]
    v_mfma_f32_32x32x16_bf16 v[80:95], v[140:143], v[120:123], v[80:95]
    buffer_load_dwordx4 v[120:123], v4, s[20:23], s37 offen
    buffer_load_dwordx4 v[124:127], v4, s[20:23], s38 offen offset:0
    buffer_load_dwordx4 v[128:131], v4, s[20:23], s38 offen offset:1024
    buffer_load_dwordx4 v[132:135], v4, s[20:23], s38 offen offset:2048
    buffer_load_dwordx4 v[136:139], v4, s[20:23], s38 offen offset:3072
    buffer_load_dwordx4 v[140:143], v5, s[20:23], s38 offen
    s_add_u32 s38, s38, 20480
    s_add_u32 s37, s37, 1024
    s_waitcnt vmcnt(12)
    v_mfma_f32_32x32x16_bf16 v[16:31], v[148:151], v[144:147], v[16:31]
    v_mfma_f32_32x32x16_bf16 v[32:47], v[152:155], v[144:147], v[32:47]
    v_mfma_f32_32x32x16_bf16 v[48:63], v[156:159], v[144:147], v[48:63]
    v_mfma_f32_32x32x16_bf16 v[64:79], v[160:163], v[144:147], v[64:79]
    v_mfma_f32_32x32x16_bf16 v[80:95], v[164:167], v[144:147], v[80:95]
    s_barrier
    buffer_load_dwordx4 v[144:147], v4, s[20:23], s37 offen
    buffer_load_dwordx4 v[148:151], v4, s[20:23], s38 offen offset:0
    buffer_load_dwordx4 v[152:155], v4, s[20:23], s38 offen offset:1024
    buffer_load_dwordx4 v[156:159], v4, s[20:23], s38 offen offset:2048
    buffer_load_dwordx4 v[160:163], v4, s[20:23], s38 offen offset:3072
    buffer_load_dwordx4 v[164:167], v5, s[20:23], s38 offen
    s_add_u32 s38, s38, 20480
    s_add_u32 s37, s37, 1024
    s_waitcnt vmcnt(12)
    v_mfma_f32_32x32x16_bf16 v[16:31], v[100:103], v[96:99], v[16:31]
    v_mfma_f32_32x32x16_bf16 v[32:47], v[104:107], v[96:99], v[32:47]
    v_mfma_f32_32x32x16_bf16 v[48:63], v[108:111], v[96:99], v[48:63]
    v_mfma_f32_32x32x16_bf16 v[64:79], v[112:115], v[96:99], v[64:79]
    v_mfma_f32_32x32x16_bf16 v[80:95], v[116:119], v[96:99], v[80:95]
    s_barrier
    buffer_load_dwordx4 v[96:99], v4, s[20:23], s37 offen
    buffer_load_dwordx4 v[100:103], v4, s[20:23], s38 offen offset:0
    buffer_load_dwordx4 v[104:107], v4, s[20:23], s38 offen offset:1024
    buffer_load_dwordx4 v[108:111], v4, s[20:23], s38 offen offset:2048
    buffer_load_dwordx4 v[112:115], v4, s[20:23], s38 offen offset:3072
    buffer_load_dwordx4 v[116:119], v5, s[20:23], s38 offen
    s_add_u32 s38, s38, 20480
    s_add_u32 s37, s37, 1024
    s_waitcnt vmcnt(12)
    v_mfma_f32_32x32x16_bf16 v[16:31], v[124:127], v[120:123], v[16:31]
    v_mfma_f32_32x32x16_bf16 v[32:47], v[128:131], v[120:123], v[32:47]
    v_mfma_f32_32x32x16_bf16 v[48:63], v[132:135], v[120:123], v[48:63]
    v_mfma_f32_32x32x16_bf16 v[64:79], v[136:139], v[120:123], v[64:79]
    v_mfma_f32_32x32x16_bf16 v[80:95], v[140:143], v[120:123], v[80:95]
    s_barrier
    buffer_load_dwordx4 v[120:123], v4, s[20:23], s37 offen
    buffer_load_dwordx4 v[124:127], v4, s[20:23], s38 offen offset:0
    buffer_load_dwordx4 v[128:131], v4, s[20:23], s38 offen offset:1024
    buffer_load_dwordx4 v[132:135], v4, s[20:23], s38 offen offset:2048
    buffer_load_dwordx4 v[136:139], v4, s[20:23], s38 offen offset:3072
    buffer_load_dwordx4 v[140:143], v5, s[20:23], s38 offen
    s_add_u32 s38, s38, 20480
    s_add_u32 s37, s37, 1024
    s_waitcnt vmcnt(12)
    v_mfma_f32_32x32x16_bf16 v[16:31], v[148:151], v[144:147], v[16:31]
    v_mfma_f32_32x32x16_bf16 v[32:47], v[152:155], v[144:147], v[32:47]
    v_mfma_f32_32x32x16_bf16 v[48:63], v[156:159], v[144:147], v[48:63]
    v_mfma_f32_32x32x16_bf16 v[64:79], v[160:163], v[144:147], v[64:79]
    v_mfma_f32_32x32x16_bf16 v[80:95], v[164:167], v[144:147], v[80:95]
    s_barrier
    buffer_load_dwordx4 v[144:147], v4, s[20:23], s37 offen
    buffer_load_dwordx4 v[148:151], v4, s[20:23], s38 offen offset:0
    buffer_load_dwordx4 v[152:155], v4, s[20:23], s38 offen offset:1024
    buffer_load_dwordx4 v[156:159], v4, s[20:23], s38 offen offset:2048
    buffer_load_dwordx4 v[160:163], v4, s[20:23], s38 offen offset:3072
    buffer_load_dwordx4 v[164:167], v5, s[20:23], s38 offen
    s_add_u32 s38, s38, 20480
    s_add_u32 s37, s37, 1024
    s_waitcnt vmcnt(12)
    v_mfma_f32_32x32x16_bf16 v[16:31], v[100:103], v[96:99], v[16:31]
    v_mfma_f32_32x32x16_bf16 v[32:47], v[104:107], v[96:99], v[32:47]
    v_mfma_f32_32x32x16_bf16 v[48:63], v[108:111], v[96:99], v[48:63]
    v_mfma_f32_32x32x16_bf16 v[64:79], v[112:115], v[96:99], v[64:79]
    v_mfma_f32_32x32x16_bf16 v[80:95], v[116:119], v[96:99], v[80:95]
    buffer_load_dwordx4 v[96:99], v4, s[20:23], s37 offen
    buffer_load_dwordx4 v[100:103], v4, s[20:23], s38 offen offset:0
    buffer_load_dwordx4 v[104:107], v4, s[20:23], s38 offen offset:1024
    buffer_load_dwordx4 v[108:111], v4, s[20:23], s38 offen offset:2048
    buffer_load_dwordx4 v[112:115], v4, s[20:23], s38 offen offset:3072
    buffer_load_dwordx4 v[116:119], v5, s[20:23], s38 offen
    s_add_u32 s38, s38, 20480
    s_add_u32 s37, s37, 1024
    s_waitcnt vmcnt(12)
    v_mfma_f32_32x32x16_bf16 v[16:31], v[124:127], v[120:123], v[16:31]
    v_mfma_f32_32x32x16_bf16 v[32:47], v[128:131], v[120:123], v[32:47]
    v_mfma_f32_32x32x16_bf16 v[48:63], v[132:135], v[120:123], v[48:63]
    v_mfma_f32_32x32x16_bf16 v[64:79], v[136:139], v[120:123], v[64:79]
    v_mfma_f32_32x32x16_bf16 v[80:95], v[140:143], v[120:123], v[80:95]
    s_barrier
    buffer_load_dwordx4 v[120:123], v4, s[20:23], s37 offen
    buffer_load_dwordx4 v[124:127], v4, s[20:23], s38 offen offset:0
    buffer_load_dwordx4 v[128:131], v4, s[20:23], s38 offen offset:1024
    buffer_load_dwordx4 v[132:135], v4, s[20:23], s38 offen offset:2048
    buffer_load_dwordx4 v[136:139], v4, s[20:23], s38 offen offset:3072
    buffer_load_dwordx4 v[140:143], v5, s[20:23], s38 offen
    s_add_u32 s38, s38, 20480
    s_add_u32 s37, s37, 1024
    s_waitcnt vmcnt(12)
    v_mfma_f32_32x32x16_bf16 v[16:31], v[148:151], v[144:147], v[16:31]
    v_mfma_f32_32x32x16_bf16 v[32:47], v[152:155], v[144:147], v[32:47]
    v_mfma_f32_32x32x16_bf16 v[48:63], v[156:159], v[144:147], v[48:63]
    v_mfma_f32_32x32x16_bf16 v[64:79], v[160:163], v[144:147], v[64:79]
    v_mfma_f32_32x32x16_bf16 v[80:95], v[164:167], v[144:147], v[80:95]
    s_barrier
    buffer_load_dwordx4 v[144:147], v4, s[20:23], s37 offen
    buffer_load_dwordx4 v[148:151], v4, s[20:23], s38 offen offset:0
    buffer_load_dwordx4 v[152:155], v4, s[20:23], s38 offen offset:1024
    buffer_load_dwordx4 v[156:159], v4, s[20:23], s38 offen offset:2048
    buffer_load_dwordx4 v[160:163], v4, s[20:23], s38 offen offset:3072
    buffer_load_dwordx4 v[164:167], v5, s[20:23], s38 offen
    s_add_u32 s38, s38, 20480
    s_add_u32 s37, s37, 1024
    s_waitcnt vmcnt(12)
    v_mfma_f32_32x32x16_bf16 v[16:31], v[100:103], v[96:99], v[16:31]
    v_mfma_f32_32x32x16_bf16 v[32:47], v[104:107], v[96:99], v[32:47]
    v_mfma_f32_32x32x16_bf16 v[48:63], v[108:111], v[96:99], v[48:63]
    v_mfma_f32_32x32x16_bf16 v[64:79], v[112:115], v[96:99], v[64:79]
    v_mfma_f32_32x32x16_bf16 v[80:95], v[116:119], v[96:99], v[80:95]
    s_waitcnt vmcnt(6)
    v_mfma_f32_32x32x16_bf16 v[16:31], v[124:127], v[120:123], v[16:31]
    v_mfma_f32_32x32x16_bf16 v[32:47], v[128:131], v[120:123], v[32:47]
    v_mfma_f32_32x32x16_bf16 v[48:63], v[132:135], v[120:123], v[48:63]
    v_mfma_f32_32x32x16_bf16 v[64:79], v[136:139], v[120:123], v[64:79]
    v_mfma_f32_32x32x16_bf16 v[80:95], v[140:143], v[120:123], v[80:95]
    s_barrier
    s_waitcnt vmcnt(0)
    v_mfma_f32_32x32x16_bf16 v[16:31], v[148:151], v[144:147], v[16:31]
    v_mfma_f32_32x32x16_bf16 v[32:47], v[152:155], v[144:147], v[32:47]
    v_mfma_f32_32x32x16_bf16 v[48:63], v[156:159], v[144:147], v[48:63]
    v_mfma_f32_32x32x16_bf16 v[64:79], v[160:163], v[144:147], v[64:79]
    v_mfma_f32_32x32x16_bf16 v[80:95], v[164:167], v[144:147], v[80:95]
    s_barrier
    s_mul_i32 s40, s36, 25600
    s_add_u32 s40, s40, 41984
    v_add_u32 v8, s40, v4

    s_add_u32 m0, s40, 0
    s_nop 0
    buffer_load_dwordx4 v4, s[20:23], s56 offen offset:0 lds
    buffer_load_dwordx4 v4, s[20:23], s56 offen offset:1024 lds
    buffer_load_dwordx4 v4, s[20:23], s56 offen offset:2048 lds
    buffer_load_dwordx4 v4, s[20:23], s56 offen offset:3072 lds
    s_add_u32 m0, s40, 4096
    s_nop 0
    buffer_load_dwordx4 v5, s[20:23], s56 offen lds
    s_add_u32 s56, s56, 20480
    s_add_u32 m0, s40, 5120
    s_nop 0
    buffer_load_dwordx4 v4, s[20:23], s56 offen offset:0 lds
    buffer_load_dwordx4 v4, s[20:23], s56 offen offset:1024 lds
    buffer_load_dwordx4 v4, s[20:23], s56 offen offset:2048 lds
    buffer_load_dwordx4 v4, s[20:23], s56 offen offset:3072 lds
    s_add_u32 m0, s40, 9216
    s_nop 0
    buffer_load_dwordx4 v5, s[20:23], s56 offen lds
    s_add_u32 s56, s56, 20480
    s_add_u32 m0, s40, 10240
    s_nop 0
    buffer_load_dwordx4 v4, s[20:23], s56 offen offset:0 lds
    buffer_load_dwordx4 v4, s[20:23], s56 offen offset:1024 lds
    buffer_load_dwordx4 v4, s[20:23], s56 offen offset:2048 lds
    buffer_load_dwordx4 v4, s[20:23], s56 offen offset:3072 lds
    s_add_u32 m0, s40, 14336
    s_nop 0
    buffer_load_dwordx4 v5, s[20:23], s56 offen lds
    s_add_u32 s56, s56, 20480
    s_add_u32 m0, s40, 15360
    s_nop 0
    buffer_load_dwordx4 v4, s[20:23], s56 offen offset:0 lds
    buffer_load_dwordx4 v4, s[20:23], s56 offen offset:1024 lds
    buffer_load_dwordx4 v4, s[20:23], s56 offen offset:2048 lds
    buffer_load_dwordx4 v4, s[20:23], s56 offen offset:3072 lds
    s_add_u32 m0, s40, 19456
    s_nop 0
    buffer_load_dwordx4 v5, s[20:23], s56 offen lds
    s_add_u32 s56, s56, 20480
    s_add_u32 m0, s40, 20480
    s_nop 0
    buffer_load_dwordx4 v4, s[20:23], s56 offen offset:0 lds
    buffer_load_dwordx4 v4, s[20:23], s56 offen offset:1024 lds
    buffer_load_dwordx4 v4, s[20:23], s56 offen offset:2048 lds
    buffer_load_dwordx4 v4, s[20:23], s56 offen offset:3072 lds
    s_add_u32 m0, s40, 24576
    s_nop 0
    buffer_load_dwordx4 v5, s[20:23], s56 offen lds
    s_add_u32 s56, s56, 20480
    buffer_load_dwordx4 v[100:103], v4, s[20:23], s56 offen offset:0
    buffer_load_dwordx4 v[104:107], v4, s[20:23], s56 offen offset:1024
    buffer_load_dwordx4 v[108:111], v4, s[20:23], s56 offen offset:2048
    buffer_load_dwordx4 v[112:115], v4, s[20:23], s56 offen offset:3072
    buffer_load_dwordx4 v[116:119], v5, s[20:23], s56 offen
    s_add_u32 s56, s56, 20480
    buffer_load_dwordx4 v[124:127], v4, s[20:23], s56 offen offset:0
    buffer_load_dwordx4 v[128:131], v4, s[20:23], s56 offen offset:1024
    buffer_load_dwordx4 v[132:135], v4, s[20:23], s56 offen offset:2048
    buffer_load_dwordx4 v[136:139], v4, s[20:23], s56 offen offset:3072
    buffer_load_dwordx4 v[140:143], v5, s[20:23], s56 offen
    s_add_u32 s56, s56, 20480
    s_mov_b32 s12, s8
    s_and_b32 s13, s9, 0xffff
    s_mov_b32 s14, 2621440
    s_mov_b32 s15, 0x20000
    s_mov_b32 s16, s10
    s_and_b32 s17, s11, 0xffff
    s_mov_b32 s18, 1280
    s_mov_b32 s19, 0x20000
    s_mov_b32 s24, s4
    s_and_b32 s25, s5, 0xffff
    s_mov_b32 s26, 2621440
    s_mov_b32 s27, 0x20000
    s_mul_i32 s39, s35, 320
    s_mul_i32 s41, s36, 80
    s_add_u32 s39, s39, s41
    v_lshlrev_b32 v6, 3, v3
    v_add_u32 v6, s39, v6
    s_lshl_b32 s41, s34, 5
    v_add_u32 v7, s41, v2
    s_movk_i32 s41, 1280
    v_mul_lo_u32 v7, v7, s41
    v_add_u32 v7, v7, v6

    buffer_load_dwordx2 v[148:149], v7, s[12:15], 0 offen offset:0
    buffer_load_dwordx2 v[150:151], v6, s[16:19], 0 offen offset:0
    buffer_load_dwordx2 v[152:153], v7, s[12:15], 0 offen offset:16
    buffer_load_dwordx2 v[154:155], v6, s[16:19], 0 offen offset:16
    buffer_load_dwordx2 v[156:157], v7, s[12:15], 0 offen offset:32
    buffer_load_dwordx2 v[158:159], v6, s[16:19], 0 offen offset:32
    buffer_load_dwordx2 v[160:161], v7, s[12:15], 0 offen offset:48
    buffer_load_dwordx2 v[162:163], v6, s[16:19], 0 offen offset:48
    buffer_load_dwordx2 v[164:165], v7, s[12:15], 0 offen offset:64
    buffer_load_dwordx2 v[166:167], v6, s[16:19], 0 offen offset:64
    v_mov_b32 v9, 40960
    s_barrier
    s_barrier
    ds_read_b32 v10, v9
    s_waitcnt lgkmcnt(0)
    v_readfirstlane_b32 s41, v10
    s_cmp_eq_u32 s41, 0
    s_cbranch_scc1 K2_G_NOFB
    s_mov_b32 s41, 0
K2_G_FB:
    s_barrier
    s_add_u32 s41, s41, 1
    s_cmp_lt_u32 s41, 23
    s_cbranch_scc1 K2_G_FB
K2_G_NOFB:
    s_cmp_lg_u32 s36, 0
    s_cbranch_scc1 K2_G_GO
    s_lshl_b32 s54, s34, 7
    s_add_u32 s54, s54, 32768
    v_mov_b32 v9, s54
    s_mov_b32 s41, 0
K2_G_SPIN:
    s_sleep 6
    global_load_dword v10, v9, s[6:7] sc1
    s_waitcnt vmcnt(0)
    v_readfirstlane_b32 s42, v10
    s_cmp_ge_u32 s42, 32
    s_cbranch_scc1 K2_G_GO
    s_add_u32 s41, s41, 1
    s_cmp_lt_u32 s41, 0x100000
    s_cbranch_scc1 K2_G_SPIN
K2_G_GO:
    s_waitcnt vmcnt(0)
    s_barrier

    s_mul_i32 s43, s36, 10240
    v_add_u32 v11, s43, v4
    s_lshl_b32 s44, s36, 11
    s_add_u32 s44, s44, 144384
    v_add_u32 v12, s44, v4

    s_add_u32 s57, s55, 5120
    s_add_u32 m0, s43, 5120
    s_nop 0
    buffer_load_dwordx4 v4, s[20:23], s57 offen sc1 lds
    s_add_u32 s57, s55, 6144
    s_add_u32 m0, s43, 6144
    s_nop 0
    buffer_load_dwordx4 v4, s[20:23], s57 offen sc1 lds
    s_add_u32 s57, s55, 0
    s_add_u32 m0, s43, 0
    s_nop 0
    buffer_load_dwordx4 v4, s[20:23], s57 offen sc1 lds
    s_add_u32 s57, s55, 1024
    s_add_u32 m0, s43, 1024
    s_nop 0
    buffer_load_dwordx4 v4, s[20:23], s57 offen sc1 lds
    s_add_u32 s57, s55, 7168
    s_add_u32 m0, s43, 7168
    s_nop 0
    buffer_load_dwordx4 v4, s[20:23], s57 offen sc1 lds
    s_add_u32 s57, s55, 2048
    s_add_u32 m0, s43, 2048
    s_nop 0
    buffer_load_dwordx4 v4, s[20:23], s57 offen sc1 lds
    s_add_u32 s57, s55, 8192
    s_add_u32 m0, s43, 8192
    s_nop 0
    buffer_load_dwordx4 v4, s[20:23], s57 offen sc1 lds
    s_add_u32 s57, s55, 3072
    s_add_u32 m0, s43, 3072
    s_nop 0
    buffer_load_dwordx4 v4, s[20:23], s57 offen sc1 lds
    s_add_u32 s57, s55, 9216
    s_add_u32 m0, s43, 9216
    s_nop 0
    buffer_load_dwordx4 v4, s[20:23], s57 offen sc1 lds
    s_add_u32 s57, s55, 4096
    s_add_u32 m0, s43, 4096
    s_nop 0
    buffer_load_dwordx4 v4, s[20:23], s57 offen sc1 lds
    s_add_u32 s57, s55, 10240
    s_add_u32 m0, s44, 0
    s_nop 0
    buffer_load_dwordx4 v4, s[20:23], s57 offen sc1 lds
    s_add_u32 s57, s55, 11264
    s_add_u32 m0, s44, 1024
    s_nop 0
    buffer_load_dwordx4 v4, s[20:23], s57 offen sc1 lds
    s_waitcnt vmcnt(11)
    ds_read_b128 v[96:99], v11 offset:5120
    s_waitcnt vmcnt(10)
    ds_read_b128 v[120:123], v11 offset:6144
    s_waitcnt lgkmcnt(1)
    v_mfma_f32_32x32x16_bf16 v[16:31], v[100:103], v[96:99], v[16:31]
    v_mfma_f32_32x32x16_bf16 v[32:47], v[104:107], v[96:99], v[32:47]
    v_mfma_f32_32x32x16_bf16 v[48:63], v[108:111], v[96:99], v[48:63]
    v_mfma_f32_32x32x16_bf16 v[64:79], v[112:115], v[96:99], v[64:79]
    v_mfma_f32_32x32x16_bf16 v[80:95], v[116:119], v[96:99], v[80:95]
    buffer_load_dwordx4 v[100:103], v4, s[20:23], s56 offen offset:0
    buffer_load_dwordx4 v[104:107], v4, s[20:23], s56 offen offset:1024
    buffer_load_dwordx4 v[108:111], v4, s[20:23], s56 offen offset:2048
    buffer_load_dwordx4 v[112:115], v4, s[20:23], s56 offen offset:3072
    buffer_load_dwordx4 v[116:119], v5, s[20:23], s56 offen
    s_add_u32 s56, s56, 20480
    s_waitcnt vmcnt(14)
    ds_read_b128 v[144:147], v11 offset:0
    s_waitcnt lgkmcnt(1)
    v_mfma_f32_32x32x16_bf16 v[16:31], v[124:127], v[120:123], v[16:31]
    v_mfma_f32_32x32x16_bf16 v[32:47], v[128:131], v[120:123], v[32:47]
    v_mfma_f32_32x32x16_bf16 v[48:63], v[132:135], v[120:123], v[48:63]
    v_mfma_f32_32x32x16_bf16 v[64:79], v[136:139], v[120:123], v[64:79]
    v_mfma_f32_32x32x16_bf16 v[80:95], v[140:143], v[120:123], v[80:95]
    ds_read_b128 v[124:127], v8 offset:0
    ds_read_b128 v[128:131], v8 offset:1024
    ds_read_b128 v[132:135], v8 offset:2048
    ds_read_b128 v[136:139], v8 offset:3072
    ds_read_b128 v[140:143], v8 offset:4096
    s_waitcnt vmcnt(13)
    ds_read_b128 v[96:99], v11 offset:1024
    s_waitcnt lgkmcnt(1)
    v_mfma_f32_32x32x16_bf16 v[16:31], v[124:127], v[144:147], v[16:31]
    v_mfma_f32_32x32x16_bf16 v[32:47], v[128:131], v[144:147], v[32:47]
    v_mfma_f32_32x32x16_bf16 v[48:63], v[132:135], v[144:147], v[48:63]
    v_mfma_f32_32x32x16_bf16 v[64:79], v[136:139], v[144:147], v[64:79]
    v_mfma_f32_32x32x16_bf16 v[80:95], v[140:143], v[144:147], v[80:95]
    ds_read_b128 v[124:127], v8 offset:5120
    ds_read_b128 v[128:131], v8 offset:6144
    ds_read_b128 v[132:135], v8 offset:7168
    ds_read_b128 v[136:139], v8 offset:8192
    ds_read_b128 v[140:143], v8 offset:9216
    s_waitcnt vmcnt(12)
    ds_read_b128 v[120:123], v11 offset:7168
    s_waitcnt lgkmcnt(1)
    v_mfma_f32_32x32x16_bf16 v[16:31], v[124:127], v[96:99], v[16:31]
    v_mfma_f32_32x32x16_bf16 v[32:47], v[128:131], v[96:99], v[32:47]
    v_mfma_f32_32x32x16_bf16 v[48:63], v[132:135], v[96:99], v[48:63]
    v_mfma_f32_32x32x16_bf16 v[64:79], v[136:139], v[96:99], v[64:79]
    v_mfma_f32_32x32x16_bf16 v[80:95], v[140:143], v[96:99], v[80:95]
    ds_read_b128 v[124:127], v8 offset:10240
    ds_read_b128 v[128:131], v8 offset:11264
    ds_read_b128 v[132:135], v8 offset:12288
    ds_read_b128 v[136:139], v8 offset:13312
    ds_read_b128 v[140:143], v8 offset:14336
    s_waitcnt vmcnt(11)
    ds_read_b128 v[144:147], v11 offset:2048
    s_waitcnt vmcnt(0)
    s_waitcnt lgkmcnt(1)
    v_mfma_f32_32x32x16_bf16 v[16:31], v[100:103], v[120:123], v[16:31]
    v_mfma_f32_32x32x16_bf16 v[32:47], v[104:107], v[120:123], v[32:47]
    v_mfma_f32_32x32x16_bf16 v[48:63], v[108:111], v[120:123], v[48:63]
    v_mfma_f32_32x32x16_bf16 v[64:79], v[112:115], v[120:123], v[64:79]
    v_mfma_f32_32x32x16_bf16 v[80:95], v[116:119], v[120:123], v[80:95]
    buffer_load_dwordx4 v[100:103], v4, s[20:23], s56 offen offset:0
    buffer_load_dwordx4 v[104:107], v4, s[20:23], s56 offen offset:1024
    buffer_load_dwordx4 v[108:111], v4, s[20:23], s56 offen offset:2048
    buffer_load_dwordx4 v[112:115], v4, s[20:23], s56 offen offset:3072
    buffer_load_dwordx4 v[116:119], v5, s[20:23], s56 offen
    s_add_u32 s56, s56, 20480
    ds_read_b128 v[96:99], v11 offset:8192
    s_waitcnt lgkmcnt(1)
    v_mfma_f32_32x32x16_bf16 v[16:31], v[124:127], v[144:147], v[16:31]
    v_mfma_f32_32x32x16_bf16 v[32:47], v[128:131], v[144:147], v[32:47]
    v_mfma_f32_32x32x16_bf16 v[48:63], v[132:135], v[144:147], v[48:63]
    v_mfma_f32_32x32x16_bf16 v[64:79], v[136:139], v[144:147], v[64:79]
    v_mfma_f32_32x32x16_bf16 v[80:95], v[140:143], v[144:147], v[80:95]
    ds_read_b128 v[124:127], v8 offset:15360
    ds_read_b128 v[128:131], v8 offset:16384
    ds_read_b128 v[132:135], v8 offset:17408
    ds_read_b128 v[136:139], v8 offset:18432
    ds_read_b128 v[140:143], v8 offset:19456
    ds_read_b128 v[120:123], v11 offset:3072
    s_waitcnt vmcnt(0)
    s_waitcnt lgkmcnt(1)
    v_mfma_f32_32x32x16_bf16 v[16:31], v[100:103], v[96:99], v[16:31]
    v_mfma_f32_32x32x16_bf16 v[32:47], v[104:107], v[96:99], v[32:47]
    v_mfma_f32_32x32x16_bf16 v[48:63], v[108:111], v[96:99], v[48:63]
    v_mfma_f32_32x32x16_bf16 v[64:79], v[112:115], v[96:99], v[64:79]
    v_mfma_f32_32x32x16_bf16 v[80:95], v[116:119], v[96:99], v[80:95]
    buffer_load_dwordx4 v[100:103], v4, s[20:23], s56 offen offset:0
    buffer_load_dwordx4 v[104:107], v4, s[20:23], s56 offen offset:1024
    buffer_load_dwordx4 v[108:111], v4, s[20:23], s56 offen offset:2048
    buffer_load_dwordx4 v[112:115], v4, s[20:23], s56 offen offset:3072
    buffer_load_dwordx4 v[116:119], v5, s[20:23], s56 offen
    s_add_u32 s56, s56, 20480
    ds_read_b128 v[144:147], v11 offset:9216
    s_waitcnt lgkmcnt(1)
    v_mfma_f32_32x32x16_bf16 v[16:31], v[124:127], v[120:123], v[16:31]
    v_mfma_f32_32x32x16_bf16 v[32:47], v[128:131], v[120:123], v[32:47]
    v_mfma_f32_32x32x16_bf16 v[48:63], v[132:135], v[120:123], v[48:63]
    v_mfma_f32_32x32x16_bf16 v[64:79], v[136:139], v[120:123], v[64:79]
    v_mfma_f32_32x32x16_bf16 v[80:95], v[140:143], v[120:123], v[80:95]
    ds_read_b128 v[124:127], v8 offset:20480
    ds_read_b128 v[128:131], v8 offset:21504
    ds_read_b128 v[132:135], v8 offset:22528
    ds_read_b128 v[136:139], v8 offset:23552
    ds_read_b128 v[140:143], v8 offset:24576
    ds_read_b128 v[96:99], v11 offset:4096
    s_waitcnt vmcnt(0)
    s_waitcnt lgkmcnt(1)
    v_mfma_f32_32x32x16_bf16 v[16:31], v[100:103], v[144:147], v[16:31]
    v_mfma_f32_32x32x16_bf16 v[32:47], v[104:107], v[144:147], v[32:47]
    v_mfma_f32_32x32x16_bf16 v[48:63], v[108:111], v[144:147], v[48:63]
    v_mfma_f32_32x32x16_bf16 v[64:79], v[112:115], v[144:147], v[64:79]
    v_mfma_f32_32x32x16_bf16 v[80:95], v[116:119], v[144:147], v[80:95]
    buffer_load_dwordx4 v[100:103], v4, s[20:23], s56 offen offset:0
    buffer_load_dwordx4 v[104:107], v4, s[20:23], s56 offen offset:1024
    buffer_load_dwordx4 v[108:111], v4, s[20:23], s56 offen offset:2048
    buffer_load_dwordx4 v[112:115], v4, s[20:23], s56 offen offset:3072
    buffer_load_dwordx4 v[116:119], v5, s[20:23], s56 offen
    s_add_u32 s56, s56, 20480
    ds_read_b128 v[120:123], v12 offset:0
    s_waitcnt lgkmcnt(1)
    v_mfma_f32_32x32x16_bf16 v[16:31], v[124:127], v[96:99], v[16:31]
    v_mfma_f32_32x32x16_bf16 v[32:47], v[128:131], v[96:99], v[32:47]
    v_mfma_f32_32x32x16_bf16 v[48:63], v[132:135], v[96:99], v[48:63]
    v_mfma_f32_32x32x16_bf16 v[64:79], v[136:139], v[96:99], v[64:79]
    v_mfma_f32_32x32x16_bf16 v[80:95], v[140:143], v[96:99], v[80:95]
    buffer_load_dwordx4 v[124:127], v4, s[20:23], s56 offen offset:0
    buffer_load_dwordx4 v[128:131], v4, s[20:23], s56 offen offset:1024
    buffer_load_dwordx4 v[132:135], v4, s[20:23], s56 offen offset:2048
    buffer_load_dwordx4 v[136:139], v4, s[20:23], s56 offen offset:3072
    buffer_load_dwordx4 v[140:143], v5, s[20:23], s56 offen
    s_add_u32 s56, s56, 20480
    ds_read_b128 v[144:147], v12 offset:1024
    s_waitcnt vmcnt(5)
    s_waitcnt lgkmcnt(1)
    v_mfma_f32_32x32x16_bf16 v[16:31], v[100:103], v[120:123], v[16:31]
    v_mfma_f32_32x32x16_bf16 v[32:47], v[104:107], v[120:123], v[32:47]
    v_mfma_f32_32x32x16_bf16 v[48:63], v[108:111], v[120:123], v[48:63]
    v_mfma_f32_32x32x16_bf16 v[64:79], v[112:115], v[120:123], v[64:79]
    v_mfma_f32_32x32x16_bf16 v[80:95], v[116:119], v[120:123], v[80:95]
    s_waitcnt vmcnt(0)
    s_waitcnt lgkmcnt(0)
    v_mfma_f32_32x32x16_bf16 v[16:31], v[124:127], v[144:147], v[16:31]
    v_mfma_f32_32x32x16_bf16 v[32:47], v[128:131], v[144:147], v[32:47]
    v_mfma_f32_32x32x16_bf16 v[48:63], v[132:135], v[144:147], v[48:63]
    v_mfma_f32_32x32x16_bf16 v[64:79], v[136:139], v[144:147], v[64:79]
    v_mfma_f32_32x32x16_bf16 v[80:95], v[140:143], v[144:147], v[80:95]
    s_nop 15
    ds_write_b128 v8, v[16:19] offset:0
    ds_write_b128 v8, v[20:23] offset:1024
    ds_write_b128 v8, v[24:27] offset:2048
    ds_write_b128 v8, v[28:31] offset:3072
    ds_write_b128 v8, v[32:35] offset:4096
    ds_write_b128 v8, v[36:39] offset:5120
    ds_write_b128 v8, v[40:43] offset:6144
    ds_write_b128 v8, v[44:47] offset:7168
    ds_write_b128 v8, v[48:51] offset:8192
    ds_write_b128 v8, v[52:55] offset:9216
    ds_write_b128 v8, v[56:59] offset:10240
    ds_write_b128 v8, v[60:63] offset:11264
    ds_write_b128 v8, v[64:67] offset:12288
    ds_write_b128 v8, v[68:71] offset:13312
    ds_write_b128 v8, v[72:75] offset:14336
    ds_write_b128 v8, v[76:79] offset:15360
    ds_write_b128 v8, v[80:83] offset:16384
    ds_write_b128 v8, v[84:87] offset:17408
    ds_write_b128 v8, v[88:91] offset:18432
    ds_write_b128 v8, v[92:95] offset:19456
    s_mul_i32 s40, s36, 5120
    s_add_u32 s40, s40, 41984
    v_add_u32 v9, s40, v4
    v_add_u32 v10, 51200, v9
    s_waitcnt lgkmcnt(0)
    s_barrier

    ds_read_b128 v[16:19], v9 offset:0
    ds_read_b128 v[20:23], v9 offset:25600
    ds_read_b128 v[24:27], v10 offset:0
    ds_read_b128 v[28:31], v10 offset:25600
    ds_read_b128 v[32:35], v9 offset:1024
    ds_read_b128 v[36:39], v9 offset:26624
    ds_read_b128 v[40:43], v10 offset:1024
    ds_read_b128 v[44:47], v10 offset:26624
    ds_read_b128 v[48:51], v9 offset:2048
    ds_read_b128 v[52:55], v9 offset:27648
    ds_read_b128 v[56:59], v10 offset:2048
    ds_read_b128 v[60:63], v10 offset:27648
    ds_read_b128 v[64:67], v9 offset:3072
    ds_read_b128 v[68:71], v9 offset:28672
    ds_read_b128 v[72:75], v10 offset:3072
    ds_read_b128 v[76:79], v10 offset:28672
    ds_read_b128 v[80:83], v9 offset:4096
    ds_read_b128 v[84:87], v9 offset:29696
    ds_read_b128 v[88:91], v10 offset:4096
    ds_read_b128 v[92:95], v10 offset:29696
    v_lshlrev_b32 v96, 16, v148
    v_and_b32 v97, 0xffff0000, v148
    v_lshlrev_b32 v100, 16, v150
    v_and_b32 v101, 0xffff0000, v150
    v_lshlrev_b32 v98, 16, v149
    v_and_b32 v99, 0xffff0000, v149
    v_lshlrev_b32 v102, 16, v151
    v_and_b32 v103, 0xffff0000, v151
    v_add_f32 v96, v96, v100
    v_add_f32 v97, v97, v101
    v_add_f32 v98, v98, v102
    v_add_f32 v99, v99, v103
    s_waitcnt lgkmcnt(15)
    v_add_f32 v16, v16, v20
    v_add_f32 v24, v24, v28
    v_add_f32 v17, v17, v21
    v_add_f32 v25, v25, v29
    v_add_f32 v18, v18, v22
    v_add_f32 v26, v26, v30
    v_add_f32 v19, v19, v23
    v_add_f32 v27, v27, v31
    v_add_f32 v16, v16, v24
    v_add_f32 v17, v17, v25
    v_add_f32 v18, v18, v26
    v_add_f32 v19, v19, v27
    v_add_f32 v16, v16, v96
    v_add_f32 v17, v17, v97
    v_add_f32 v18, v18, v98
    v_add_f32 v19, v19, v99
    v_cvt_pk_bf16_f32 v28, v16, v17
    v_cvt_pk_bf16_f32 v29, v18, v19
    buffer_store_dwordx2 v[28:29], v7, s[24:27], 0 offen offset:0
    v_lshlrev_b32 v96, 16, v152
    v_and_b32 v97, 0xffff0000, v152
    v_lshlrev_b32 v100, 16, v154
    v_and_b32 v101, 0xffff0000, v154
    v_lshlrev_b32 v98, 16, v153
    v_and_b32 v99, 0xffff0000, v153
    v_lshlrev_b32 v102, 16, v155
    v_and_b32 v103, 0xffff0000, v155
    v_add_f32 v96, v96, v100
    v_add_f32 v97, v97, v101
    v_add_f32 v98, v98, v102
    v_add_f32 v99, v99, v103
    s_waitcnt lgkmcnt(12)
    v_add_f32 v32, v32, v36
    v_add_f32 v40, v40, v44
    v_add_f32 v33, v33, v37
    v_add_f32 v41, v41, v45
    v_add_f32 v34, v34, v38
    v_add_f32 v42, v42, v46
    v_add_f32 v35, v35, v39
    v_add_f32 v43, v43, v47
    v_add_f32 v32, v32, v40
    v_add_f32 v33, v33, v41
    v_add_f32 v34, v34, v42
    v_add_f32 v35, v35, v43
    v_add_f32 v32, v32, v96
    v_add_f32 v33, v33, v97
    v_add_f32 v34, v34, v98
    v_add_f32 v35, v35, v99
    v_cvt_pk_bf16_f32 v44, v32, v33
    v_cvt_pk_bf16_f32 v45, v34, v35
    buffer_store_dwordx2 v[44:45], v7, s[24:27], 0 offen offset:16
    v_lshlrev_b32 v96, 16, v156
    v_and_b32 v97, 0xffff0000, v156
    v_lshlrev_b32 v100, 16, v158
    v_and_b32 v101, 0xffff0000, v158
    v_lshlrev_b32 v98, 16, v157
    v_and_b32 v99, 0xffff0000, v157
    v_lshlrev_b32 v102, 16, v159
    v_and_b32 v103, 0xffff0000, v159
    v_add_f32 v96, v96, v100
    v_add_f32 v97, v97, v101
    v_add_f32 v98, v98, v102
    v_add_f32 v99, v99, v103
    s_waitcnt lgkmcnt(8)
    v_add_f32 v48, v48, v52
    v_add_f32 v56, v56, v60
    v_add_f32 v49, v49, v53
    v_add_f32 v57, v57, v61
    v_add_f32 v50, v50, v54
    v_add_f32 v58, v58, v62
    v_add_f32 v51, v51, v55
    v_add_f32 v59, v59, v63
    v_add_f32 v48, v48, v56
    v_add_f32 v49, v49, v57
    v_add_f32 v50, v50, v58
    v_add_f32 v51, v51, v59
    v_add_f32 v48, v48, v96
    v_add_f32 v49, v49, v97
    v_add_f32 v50, v50, v98
    v_add_f32 v51, v51, v99
    v_cvt_pk_bf16_f32 v60, v48, v49
    v_cvt_pk_bf16_f32 v61, v50, v51
    buffer_store_dwordx2 v[60:61], v7, s[24:27], 0 offen offset:32
    v_lshlrev_b32 v96, 16, v160
    v_and_b32 v97, 0xffff0000, v160
    v_lshlrev_b32 v100, 16, v162
    v_and_b32 v101, 0xffff0000, v162
    v_lshlrev_b32 v98, 16, v161
    v_and_b32 v99, 0xffff0000, v161
    v_lshlrev_b32 v102, 16, v163
    v_and_b32 v103, 0xffff0000, v163
    v_add_f32 v96, v96, v100
    v_add_f32 v97, v97, v101
    v_add_f32 v98, v98, v102
    v_add_f32 v99, v99, v103
    s_waitcnt lgkmcnt(4)
    v_add_f32 v64, v64, v68
    v_add_f32 v72, v72, v76
    v_add_f32 v65, v65, v69
    v_add_f32 v73, v73, v77
    v_add_f32 v66, v66, v70
    v_add_f32 v74, v74, v78
    v_add_f32 v67, v67, v71
    v_add_f32 v75, v75, v79
    v_add_f32 v64, v64, v72
    v_add_f32 v65, v65, v73
    v_add_f32 v66, v66, v74
    v_add_f32 v67, v67, v75
    v_add_f32 v64, v64, v96
    v_add_f32 v65, v65, v97
    v_add_f32 v66, v66, v98
    v_add_f32 v67, v67, v99
    v_cvt_pk_bf16_f32 v76, v64, v65
    v_cvt_pk_bf16_f32 v77, v66, v67
    buffer_store_dwordx2 v[76:77], v7, s[24:27], 0 offen offset:48
    v_lshlrev_b32 v96, 16, v164
    v_and_b32 v97, 0xffff0000, v164
    v_lshlrev_b32 v100, 16, v166
    v_and_b32 v101, 0xffff0000, v166
    v_lshlrev_b32 v98, 16, v165
    v_and_b32 v99, 0xffff0000, v165
    v_lshlrev_b32 v102, 16, v167
    v_and_b32 v103, 0xffff0000, v167
    v_add_f32 v96, v96, v100
    v_add_f32 v97, v97, v101
    v_add_f32 v98, v98, v102
    v_add_f32 v99, v99, v103
    s_waitcnt lgkmcnt(0)
    v_add_f32 v80, v80, v84
    v_add_f32 v88, v88, v92
    v_add_f32 v81, v81, v85
    v_add_f32 v89, v89, v93
    v_add_f32 v82, v82, v86
    v_add_f32 v90, v90, v94
    v_add_f32 v83, v83, v87
    v_add_f32 v91, v91, v95
    v_add_f32 v80, v80, v88
    v_add_f32 v81, v81, v89
    v_add_f32 v82, v82, v90
    v_add_f32 v83, v83, v91
    v_add_f32 v80, v80, v96
    v_add_f32 v81, v81, v97
    v_add_f32 v82, v82, v98
    v_add_f32 v83, v83, v99
    v_cvt_pk_bf16_f32 v92, v80, v81
    v_cvt_pk_bf16_f32 v93, v82, v83
    buffer_store_dwordx2 v[92:93], v7, s[24:27], 0 offen offset:64
K2_END:
    s_endpgm
.section .rodata,"a"
.p2align 6
.amdhsa_kernel k1_gemm_kernel
  .amdhsa_next_free_vgpr 224
  .amdhsa_next_free_sgpr 72
  .amdhsa_accum_offset 224
  .amdhsa_group_segment_fixed_size 0
  .amdhsa_kernarg_size 88
  .amdhsa_user_sgpr_count 2
  .amdhsa_user_sgpr_kernarg_segment_ptr 1
  .amdhsa_system_sgpr_workgroup_id_x 1
.end_amdhsa_kernel
.p2align 6
.amdhsa_kernel k2_attn_kernel
  .amdhsa_next_free_vgpr 168
  .amdhsa_next_free_sgpr 64
  .amdhsa_accum_offset 168
  .amdhsa_group_segment_fixed_size 0
  .amdhsa_kernarg_size 88
  .amdhsa_user_sgpr_count 2
  .amdhsa_user_sgpr_kernarg_segment_ptr 1
  .amdhsa_system_sgpr_workgroup_id_x 1
.end_amdhsa_kernel
```
